```python
import torch

def _softmax(x, axis=-1):
    return torch.softmax(x, dim=axis)
def _gelu(x):
    return torch.nn.functional.gelu(x, approximate="tanh")
def _silu(x):
    return torch.nn.functional.silu(x)
def _sigmoid(x):
    return torch.sigmoid(x)
def _layernorm(x, axis=-1, eps=1e-5):
    m = x.mean(dim=axis, keepdim=True)
    v = x.var(dim=axis, keepdim=True, unbiased=False)
    return (x - m) / torch.sqrt(v + eps)
def _scatter_add(tgt, idx, src, axis=0):
    return tgt.clone().index_add_(axis, idx, src)
def _segment_sum(src, seg, n):
    out = torch.zeros((n,) + src.shape[1:], dtype=src.dtype)
    return out.index_add_(0, seg, src)
def _pad(x, pw):
    flat = tuple(v for pair in reversed(pw) for v in pair)
    return torch.nn.functional.pad(x, flat)

kernel_name = 'interleave_layers__linear_attn_block__glu_gated_geglu__prompt'

def setup_inputs():

    _w = (lambda a: (lambda t: t.to(torch.bfloat16) if t.is_floating_point() else t)(torch.as_tensor(a)))
    def _A_setup():
        B, S, D = 1, 2048, 512
        return {
            "x": _w((lambda *s: torch.randn(*s, dtype=torch.bfloat16) * 0.05)(B, S, D)),
            "wqkv": _w((lambda *s: torch.randn(*s, dtype=torch.bfloat16) * 0.05)(D, 3 * D)),
            "wo": _w((lambda *s: torch.randn(*s, dtype=torch.bfloat16) * 0.05)(D, D)),
        }
    _A_in = _A_setup()

    def _B_setup():
        B, S, Dm, Df = 1, 2048, 512, 1376
        return {
            "x": _w((lambda *s: torch.randn(*s, dtype=torch.bfloat16) * 0.05)(B, S, Dm)),
            "w_gate": _w((lambda *s: torch.randn(*s, dtype=torch.bfloat16) * 0.8)(Dm, Df) * (Dm ** -0.5)),
            "w_up": _w((lambda *s: torch.randn(*s, dtype=torch.bfloat16) * 0.8)(Dm, Df) * (Dm ** -0.5)),
            "w_down": _w((lambda *s: torch.randn(*s, dtype=torch.bfloat16) * 0.8)(Df, Dm) * (Df ** -0.5)),
        }
    _B_in = _B_setup()

    return {
        "A_x": _A_in["x"],
        "A_wqkv": _A_in["wqkv"],
        "A_wo": _A_in["wo"],
        "B_x": _B_in["x"],
        "B_w_gate": _B_in["w_gate"],
        "B_w_up": _B_in["w_up"],
        "B_w_down": _B_in["w_down"],
    }

def reference(A_x, A_wqkv, A_wo, B_x, B_w_gate, B_w_up, B_w_down):
    def _A_ref(x, wqkv, wo):
        B, S, D = x.shape
        H = 32; Dh = D // H
        qkv = (lambda x, *d: x.permute(*d))((x @ wqkv).reshape(B, S, 3, H, Dh), 2, 0, 3, 1, 4)
        q, k, v = qkv[0], qkv[1], qkv[2]
        phi = lambda t: torch.where(t > 0, t + 1, torch.exp(t)) + 1e-6
        pq, pk = phi(q), phi(k)
        kv = torch.einsum("bhsd,bhse->bhde", pk, v)
        z = torch.einsum("bhsd->bhd", pk)
        num = torch.einsum("bhqd,bhde->bhqe", pq, kv)
        den = torch.einsum("bhqd,bhd->bhq", pq, z)[..., None] + 1e-6
        o = num / den
        return (lambda x, *d: x.permute(*d))(o, 0, 2, 1, 3).reshape(B, S, D) @ wo

    def _B_ref(x, w_gate, w_up, w_down):
        g = torch.einsum("bsd,df->bsf", x, w_gate)
        u = torch.einsum("bsd,df->bsf", x, w_up)
        h = _gelu(g) * u
        return torch.einsum("bsf,fd->bsd", h, w_down)

    x = A_x
    x = x + _A_ref(_layernorm(x, axis=-1), A_wqkv, A_wo)
    x = x + _B_ref(_layernorm(x, axis=-1), B_w_gate, B_w_up, B_w_down)
    x = x + _A_ref(_layernorm(x, axis=-1), A_wqkv, A_wo)
    x = x + _B_ref(_layernorm(x, axis=-1), B_w_gate, B_w_up, B_w_down)
    return x
```

```asm
; @launch grid=(256,1,1) block=(256,1,1) lds=163840
.amdgcn_target "amdgcn-amd-amdhsa--gfx950"
.text
.globl interleave_layers__linear_attn_block__glu_gated_geglu__prompt_kernel
.p2align 8
.type interleave_layers__linear_attn_block__glu_gated_geglu__prompt_kernel,@function
interleave_layers__linear_attn_block__glu_gated_geglu__prompt_kernel:
    s_cmp_ge_u32 s2, 256
    s_cbranch_scc1 main_exit
    s_getpc_b64 s[50:51]
main_pc0:
    s_sub_u32 s50, s50, main_pc0-interleave_layers__linear_attn_block__glu_gated_geglu__prompt_kernel
    s_subb_u32 s51, s51, 0
    s_lshr_b32 s40, s2, 3
    s_lshl_b32 s40, s40, 11
    v_lshrrev_b32 v28, 6, v0
    v_lshlrev_b32 v28, 9, v28
    v_and_b32 v29, 63, v0
    v_lshlrev_b32 v30, 7, v29
    v_add3_u32 v28, v28, v30, s40
    v_cmp_gt_u32 vcc, main_end-interleave_layers__linear_attn_block__glu_gated_geglu__prompt_kernel, v28
    s_and_b64 vcc, vcc, 15
    s_and_saveexec_b64 s[58:59], vcc
    s_cbranch_execz main_nopf
    global_load_dword v152, v28, s[50:51]
main_nopf:
    s_mov_b64 exec, s[58:59]
    s_memtime s[74:75]
    s_load_dwordx2 s[76:77], s[0:1], 0
    s_load_dwordx2 s[80:81], s[0:1], 8
    s_load_dwordx2 s[84:85], s[0:1], 16
    s_load_dwordx2 s[86:87], s[0:1], 32
    s_load_dwordx2 s[88:89], s[0:1], 40
    s_load_dwordx2 s[90:91], s[0:1], 48
    s_load_dwordx2 s[12:13], s[0:1], 56
    s_load_dwordx2 s[4:5], s[0:1], 64
    s_load_dwordx2 s[8:9], s[0:1], 72
    s_getreg_b32 s3, hwreg(HW_REG_XCC_ID, 0, 4)
    v_lshrrev_b32 v6, 6, v0
    v_and_b32 v7, 63, v0
    s_nop 0
    v_readfirstlane_b32 s18, v6
    s_and_b32 s16, s2, 7
    s_lshl_b32 s16, s16, 1
    s_lshr_b32 s17, s2, 3
    s_lshr_b32 s40, s17, 4
    s_add_u32 s16, s16, s40
    s_and_b32 s17, s17, 15
    s_lshl_b32 s19, s16, 2
    s_add_u32 s19, s19, s18
    s_lshl_b32 s40, s19, 15
    s_add_u32 s20, s40, 8388608
    s_add_u32 s21, s40, 10485760
    s_mul_i32 s22, s19, 98304
    s_add_u32 s22, s22, 12582912
    s_lshl_b32 s23, s19, 12
    s_add_u32 s23, s23, 18874368
    s_bfe_u32 s40, s17, 0x20001
    s_lshl_b32 s40, s40, 10
    s_add_u32 s73, s23, s40
    s_lshr_b32 s40, s17, 3
    s_lshl_b32 s40, s40, 9
    s_add_u32 s73, s73, s40
    s_and_b32 s40, s17, 1
    s_lshl_b32 s40, s40, 3
    s_add_u32 s73, s73, s40
    s_lshl_b32 s24, s19, 7
    s_add_u32 s24, s24, 22020096
    s_lshl_b32 s40, s17, 2
    s_add_u32 s25, s24, s40
    s_mul_i32 s26, s17, 425984
    s_add_u32 s26, s26, 0
    s_mov_b32 s27, 0
    s_mov_b32 s28, 0
    s_mov_b32 s30, 0xffff0000
    s_mov_b32 s31, 0xffff0000
    s_mov_b32 s32, 0
    s_mov_b32 s33, -1
    s_mov_b32 s34, 100000
    s_lshl_b32 s40, s17, 4
    s_add_u32 s35, s40, s16
    s_lshl_b32 s35, s35, 12
    s_add_u32 s35, s35, 19922944
    s_lshl_b32 s41, s18, 2
    s_add_u32 s36, s40, s41
    s_lshl_b32 s36, s36, 12
    s_add_u32 s36, s36, 19922944
    s_mov_b32 s37, 0x3f317218
    s_mov_b32 s38, 0x358637bd
    s_lshl_b32 s40, s18, 13
    s_add_u32 s60, s40, 101376
    s_add_u32 s61, s40, s26
    s_lshl_b32 s65, s18, 10
    s_add_u32 s65, s65, s26
    s_add_u32 s65, s65, 195584
    s_lshl_b32 s63, s2, 2
    s_add_u32 s63, s63, s18
    s_lshl_b32 s63, s63, 8
    s_add_u32 s63, s63, 23068672
    v_lshlrev_b32 v0, 4, v7
    v_add_u32 v1, 0x10000, v0
    v_and_b32 v2, 15, v7
    v_lshlrev_b32 v2, 2, v2
    v_and_b32 v6, 31, v7
    v_lshrrev_b32 v20, 5, v7
    v_lshlrev_b32 v21, 6, v20
    v_add_u32 v4, 101376, v0
    s_lshl_b32 s40, s18, 10
    v_add_u32 v5, s40, v4
    v_lshlrev_b32 v22, 10, v6
    v_lshlrev_b32 v21, 4, v20
    v_add_u32 v22, v22, v21
    v_bfe_u32 v21, v7, 4, 1
    v_lshlrev_b32 v21, 6, v21
    v_lshlrev_b32 v23, 4, v20
    v_add_u32 v23, v23, v21
    v_add_u32 v23, 101376, v23
    s_lshl_b32 s40, s18, 7
    s_add_u32 s40, s40, 162816
    v_lshlrev_b32 v21, 2, v6
    v_add_u32 v21, s40, v21
    v_lshlrev_b32 v20, 4, v20
    v_add_u32 v20, s40, v20
    s_lshl_b32 s70, s19, 15
    s_lshl_b32 s40, s17, 6
    s_add_u32 s70, s70, s40
    s_lshl_b32 s40, s16, 7
    s_add_u32 s72, s40, 22085632
    s_add_u32 s3, s3, 1
    s_or_b32 s3, s3, 0
    s_sub_u32 s3, s3, 1
    s_or_b32 s3, s3, 0x80
    s_and_b32 s40, s17, 1
    s_lshl_b32 s40, s40, 1
    s_and_b32 s41, s16, 1
    s_lshl_b32 s41, s41, 2
    s_add_u32 s40, s40, s41
    s_lshr_b32 s41, s17, 1
    s_add_u32 s40, s40, s41
    s_and_b32 s69, s40, 7
    s_add_u32 s40, s69, 0
    s_and_b32 s40, s40, 7
    s_lshl_b32 s96, s40, 12
    s_add_u32 s40, s69, 1
    s_and_b32 s40, s40, 7
    s_lshl_b32 s97, s40, 12
    s_add_u32 s40, s69, 2
    s_and_b32 s40, s40, 7
    s_lshl_b32 s98, s40, 12
    s_add_u32 s40, s69, 3
    s_and_b32 s40, s40, 7
    s_lshl_b32 s99, s40, 12
    s_add_u32 s40, s69, 4
    s_and_b32 s40, s40, 7
    s_lshl_b32 s100, s40, 12
    s_add_u32 s40, s69, 5
    s_and_b32 s40, s40, 7
    s_lshl_b32 s101, s40, 12
    s_add_u32 s40, s69, 6
    s_and_b32 s40, s40, 7
    s_lshl_b32 s29, s40, 12
    s_add_u32 s40, s69, 7
    s_and_b32 s40, s40, 7
    s_lshl_b32 s39, s40, 12
    v_lshrrev_b32 v28, 5, v7
    v_lshlrev_b32 v28, 2, v28
    v_bfe_u32 v29, v7, 2, 2
    v_add_u32 v28, v28, v29
    v_lshlrev_b32 v3, 6, v28
    v_bfe_u32 v29, v7, 4, 1
    v_lshlrev_b32 v29, 5, v29
    v_and_b32 v30, 3, v7
    v_lshlrev_b32 v30, 3, v30
    v_add3_u32 v3, v3, v29, v30
    s_waitcnt lgkmcnt(0)
    s_mov_b32 s10, 33554432
    s_mov_b32 s11, 0x00020000
    s_mov_b32 s14, 2097152
    s_mov_b32 s15, 0x00020000
    s_mov_b32 s6, 256
    s_mov_b32 s7, 0x00020000
    s_mov_b32 s71, 0
    v_lshrrev_b32 v28, 4, v0
    v_lshrrev_b32 v144, 2, v28
    v_mul_u32_u24 v144, 3072, v144
    v_and_b32 v29, 3, v28
    v_lshlrev_b32 v29, 4, v29
    v_add_u32 v144, v144, v29
    v_lshrrev_b32 v29, 3, v28
    v_lshlrev_b32 v29, 10, v29
    v_lshrrev_b32 v30, 4, v28
    v_and_b32 v31, 7, v28
    v_xor_b32 v32, v30, v31
    v_lshlrev_b32 v32, 4, v32
    v_add_u32 v142, v29, v32
    v_or_b32 v30, 4, v30
    v_xor_b32 v32, v30, v31
    v_lshlrev_b32 v32, 4, v32
    v_add_u32 v143, v29, v32
    s_mul_i32 s57, s18, 12288
    s_add_u32 s57, s57, 101376
    v_and_b32 v29, 31, v28
    v_lshrrev_b32 v30, 5, v28
    v_lshlrev_b32 v31, 7, v29
    v_lshlrev_b32 v30, 3, v30
    v_add_u32 v31, v31, v30
    v_add_u32 v31, s57, v31
    v_bfe_u32 v32, v29, 1, 3
    v_xor_b32 v33, 0, v32
    v_lshlrev_b32 v33, 4, v33
    v_add_u32 v132, v31, v33
    v_xor_b32 v33, 1, v32
    v_lshlrev_b32 v33, 4, v33
    v_add_u32 v133, v31, v33
    v_xor_b32 v33, 2, v32
    v_lshlrev_b32 v33, 4, v33
    v_add_u32 v134, v31, v33
    v_xor_b32 v33, 3, v32
    v_lshlrev_b32 v33, 4, v33
    v_add_u32 v135, v31, v33
    v_xor_b32 v33, 4, v32
    v_lshlrev_b32 v33, 4, v33
    v_add_u32 v136, v31, v33
    v_xor_b32 v33, 5, v32
    v_lshlrev_b32 v33, 4, v33
    v_add_u32 v137, v31, v33
    v_xor_b32 v33, 6, v32
    v_lshlrev_b32 v33, 4, v33
    v_add_u32 v138, v31, v33
    v_xor_b32 v33, 7, v32
    v_lshlrev_b32 v33, 4, v33
    v_add_u32 v139, v31, v33
    v_mov_b32 v145, v31
    v_mov_b32 v146, v32
    s_cmp_ge_u32 s18, 2
    s_cbranch_scc1 ar1
    v_mov_b32 v96, -1
    v_mov_b32 v97, -1
    v_mov_b32 v98, -1
    v_mov_b32 v99, -1
    s_mul_i32 s40, s18, 1048576
    s_add_u32 s40, s40, s35
    buffer_store_dwordx4 v[96:99], v0, s[8:11], s40 offen offset:0 sc1
    buffer_store_dwordx4 v[96:99], v0, s[8:11], s40 offen offset:1024 sc1
ar1:
    v_mov_b32 v7, 0
    buffer_store_dword v7, off, s[8:11], s25 sc1
    s_lshl_b32 s40, s16, 4
    s_add_u32 s40, s40, s17
    s_lshl_b32 s40, s40, 7
    s_add_u32 s40, s40, 22085632
    buffer_store_dword v7, off, s[8:11], s40 sc1
    s_mov_b32 s78, 2097152
    s_mov_b32 s79, 0x00020000
    s_mov_b32 s82, 1572864
    s_mov_b32 s83, 0x00020000
    s_lshl_b32 s54, s17, 6
    s_mul_i32 s52, s18, 49152
    s_add_u32 s54, s54, s52
    s_lshl_b32 s55, s19, 15
    s_lshl_b32 s56, s16, 4
    s_add_u32 s56, s56, s17
    s_mov_b32 s64, s56
    s_lshl_b32 s52, s18, 8
    s_add_u32 s56, s56, s52
    s_getpc_b64 s[50:51]
main_pc:
    s_add_u32 s50, s50, main_tab-main_pc
    s_addc_u32 s51, s51, 0
    s_lshl_b32 s58, s18, 13
    s_add_u32 s58, s58, 65536
    s_mov_b32 s49, 2
    s_cmp_ge_u32 s56, 952
    s_cbranch_scc1 fp86
    v_lshrrev_b32 v30, 4, v0
    v_lshrrev_b32 v31, 5, v30
    v_lshlrev_b32 v31, 2, v31
    v_bfe_u32 v32, v30, 2, 2
    v_add_u32 v31, v31, v32
    v_lshlrev_b32 v149, 8, v31
    v_and_b32 v33, 3, v30
    v_lshlrev_b32 v33, 3, v33
    v_add_u32 v149, v149, v33
    v_add_u32 v149, s58, v149
    v_bfe_u32 v32, v30, 4, 1
    v_lshrrev_b32 v28, 8, v0
    v_and_b32 v34, 0xf0, v0
    s_cmp_ge_u32 s56, 608
    s_cbranch_scc1 fd3
    s_cmp_ge_u32 s56, 128
    s_cbranch_scc1 fg2
    s_lshr_b32 s40, s56, 2
    s_and_b32 s41, s56, 3
    s_mov_b32 s92, s84
    s_mov_b32 s93, s85
    s_mov_b32 s94, 524288
    s_mov_b32 s95, 0x00020000
    s_add_u32 s62, s40, 99
    s_branch fs4
fd3:
    s_sub_u32 s52, s56, 608
    s_lshr_b32 s40, s52, 2
    s_and_b32 s41, s52, 3
    s_mov_b32 s92, s90
    s_mov_b32 s93, s91
    s_mov_b32 s94, 1409024
    s_mov_b32 s95, 0x00020000
    s_lshl_b32 s52, s40, 2
    s_add_u32 s52, s52, 792
    s_load_dword s62, s[50:51], s52
fs4:
    s_mov_b32 s49, 0
    s_lshl_b32 s48, s41, 2
    v_lshlrev_b32 v28, 10, v28
    v_add_u32 v28, v28, v34
    v_lshlrev_b32 v32, 5, v32
    v_add_u32 v149, v149, v32
    s_lshl_b32 s52, s40, 14
    s_lshl_b32 s53, s41, 8
    s_add_u32 s52, s52, s53
    s_add_u32 m0, s58, 0
    s_nop 0
    buffer_load_dwordx4 v28, s[92:95], s52 offen lds
    s_add_u32 s52, s52, 4096
    s_add_u32 m0, s58, 1024
    s_nop 0
    buffer_load_dwordx4 v28, s[92:95], s52 offen lds
    s_add_u32 s52, s52, 4096
    s_add_u32 m0, s58, 2048
    s_nop 0
    buffer_load_dwordx4 v28, s[92:95], s52 offen lds
    s_add_u32 s52, s52, 4096
    s_add_u32 m0, s58, 3072
    s_nop 0
    buffer_load_dwordx4 v28, s[92:95], s52 offen lds
    s_branch fp47
fp86:
    buffer_load_dword v212, off, s[8:11], s25
    buffer_load_dword v212, off, s[8:11], s25
    buffer_load_dword v212, off, s[8:11], s25
    buffer_load_dword v212, off, s[8:11], s25
fp47:
    buffer_load_dword v212, off, s[8:11], s25
    buffer_load_dword v212, off, s[8:11], s25
    buffer_load_dword v212, off, s[8:11], s25
    buffer_load_dword v212, off, s[8:11], s25
    s_branch fe5
fg2:
    s_mov_b32 s49, 1
    s_sub_u32 s52, s56, 128
    s_mul_hi_u32 s40, s52, 286331154
    s_mul_i32 s41, s40, 15
    s_sub_u32 s41, s52, s41
    s_mov_b32 s92, s86
    s_mov_b32 s93, s87
    s_mov_b32 s94, 1409024
    s_mov_b32 s95, 0x00020000
    s_mov_b32 s44, s88
    s_mov_b32 s45, s89
    s_mov_b32 s46, 1409024
    s_mov_b32 s47, 0x00020000
    v_mul_u32_u24 v28, 2752, v28
    v_add_u32 v28, v28, v34
    v_lshlrev_b32 v32, 12, v32
    v_add_u32 v149, v149, v32
    s_mul_i32 s52, s40, 44032
    s_mul_i32 s53, s41, 192
    s_add_u32 s52, s52, s53
    s_add_u32 m0, s58, 0
    s_nop 0
    buffer_load_dwordx4 v28, s[92:95], s52 offen lds
    s_add_u32 m0, s58, 4096
    s_nop 0
    buffer_load_dwordx4 v28, s[44:47], s52 offen lds
    s_add_u32 s52, s52, 11008
    s_add_u32 m0, s58, 1024
    s_nop 0
    buffer_load_dwordx4 v28, s[92:95], s52 offen lds
    s_add_u32 m0, s58, 5120
    s_nop 0
    buffer_load_dwordx4 v28, s[44:47], s52 offen lds
    s_add_u32 s52, s52, 11008
    s_add_u32 m0, s58, 2048
    s_nop 0
    buffer_load_dwordx4 v28, s[92:95], s52 offen lds
    s_add_u32 m0, s58, 6144
    s_nop 0
    buffer_load_dwordx4 v28, s[44:47], s52 offen lds
    s_add_u32 s52, s52, 11008
    s_add_u32 m0, s58, 3072
    s_nop 0
    buffer_load_dwordx4 v28, s[92:95], s52 offen lds
    s_add_u32 m0, s58, 7168
    s_nop 0
    buffer_load_dwordx4 v28, s[44:47], s52 offen lds
    s_mul_i32 s48, s41, 6
fe5:
    s_mov_b32 s72, s40
    v_lshlrev_b32 v36, 3, v0
    s_lshr_b32 s53, s2, 3
    s_and_b32 s41, s16, 14
    s_lshl_b32 s41, s41, 7
    s_lshl_b32 s42, s53, 3
    s_add_u32 s41, s41, s42
    s_lshl_b32 s42, s18, 1
    s_add_u32 s41, s41, s42
    s_lshl_b32 s41, s41, 10
    s_mov_b64 exec, 0xffff
    buffer_load_dword v209, v36, s[76:79], s41 offen
    s_mov_b64 exec, -1
    v_lshrrev_b32 v213, 8, v0
    v_mul_u32_u24 v213, 3072, v213
    v_and_b32 v214, 0xf0, v0
    v_lshlrev_b32 v214, 3, v214
    v_add_u32 v213, v213, v214
    s_mul_i32 s43, s53, 49152
    s_mul_i32 s42, s18, 12288
    s_add_u32 s43, s43, s42
    s_mov_b32 s68, s43
    s_add_u32 s43, s43, 1024
    buffer_load_dword v210, v213, s[80:83], s43 offen
    s_waitcnt vmcnt(1)
    s_add_u32 s40, s69, 0
    s_and_b32 s40, s40, 7
    s_lshl_b32 s40, s40, 7
    s_add_u32 s40, s40, s55
    s_add_u32 m0, s57, 0
    s_nop 0
    buffer_load_dwordx4 v142, s[76:79], s40 offen lds
    s_add_u32 s40, s40, 8192
    s_add_u32 m0, s57, 1024
    s_nop 0
    buffer_load_dwordx4 v143, s[76:79], s40 offen lds
    s_add_u32 s40, s40, 8192
    s_add_u32 m0, s57, 2048
    s_nop 0
    buffer_load_dwordx4 v142, s[76:79], s40 offen lds
    s_add_u32 s40, s40, 8192
    s_add_u32 m0, s57, 3072
    s_nop 0
    buffer_load_dwordx4 v143, s[76:79], s40 offen lds
    s_add_u32 s40, s69, 1
    s_and_b32 s40, s40, 7
    s_lshl_b32 s40, s40, 7
    s_add_u32 s40, s40, s55
    s_add_u32 m0, s57, 4096
    s_nop 0
    buffer_load_dwordx4 v142, s[76:79], s40 offen lds
    s_add_u32 s40, s40, 8192
    s_add_u32 m0, s57, 5120
    s_nop 0
    buffer_load_dwordx4 v143, s[76:79], s40 offen lds
    s_add_u32 s40, s40, 8192
    s_add_u32 m0, s57, 6144
    s_nop 0
    buffer_load_dwordx4 v142, s[76:79], s40 offen lds
    s_add_u32 s40, s40, 8192
    s_add_u32 m0, s57, 7168
    s_nop 0
    buffer_load_dwordx4 v143, s[76:79], s40 offen lds
    s_add_u32 s40, s69, 2
    s_and_b32 s40, s40, 7
    s_lshl_b32 s40, s40, 7
    s_add_u32 s40, s40, s55
    s_add_u32 m0, s57, 8192
    s_nop 0
    buffer_load_dwordx4 v142, s[76:79], s40 offen lds
    s_add_u32 s40, s40, 8192
    s_add_u32 m0, s57, 9216
    s_nop 0
    buffer_load_dwordx4 v143, s[76:79], s40 offen lds
    s_add_u32 s40, s40, 8192
    s_add_u32 m0, s57, 10240
    s_nop 0
    buffer_load_dwordx4 v142, s[76:79], s40 offen lds
    s_add_u32 s40, s40, 8192
    s_add_u32 m0, s57, 11264
    s_nop 0
    buffer_load_dwordx4 v143, s[76:79], s40 offen lds
    s_lshl_b32 s42, s18, 10
    s_add_u32 s40, s69, 0
    s_and_b32 s40, s40, 7
    s_mul_i32 s40, s40, 196608
    s_add_u32 s40, s40, s54
    s_add_u32 m0, s42, 0
    s_add_u32 s40, s40, 1024
    buffer_load_dwordx4 v144, s[80:83], s40 offen lds
    s_add_u32 s40, s69, 1
    s_and_b32 s40, s40, 7
    s_mul_i32 s40, s40, 196608
    s_add_u32 s40, s40, s54
    s_add_u32 m0, s42, 4096
    s_add_u32 s40, s40, 1024
    buffer_load_dwordx4 v144, s[80:83], s40 offen lds
    s_add_u32 s40, s69, 2
    s_and_b32 s40, s40, 7
    s_mul_i32 s40, s40, 196608
    s_add_u32 s40, s40, s54
    s_add_u32 m0, s42, 8192
    s_add_u32 s40, s40, 1024
    buffer_load_dwordx4 v144, s[80:83], s40 offen lds
    s_add_u32 s40, s69, 3
    s_and_b32 s40, s40, 7
    s_mul_i32 s40, s40, 196608
    s_add_u32 s40, s40, s54
    s_add_u32 m0, s42, 12288
    s_add_u32 s40, s40, 1024
    buffer_load_dwordx4 v144, s[80:83], s40 offen lds
    s_add_u32 s40, s69, 4
    s_and_b32 s40, s40, 7
    s_mul_i32 s40, s40, 196608
    s_add_u32 s40, s40, s54
    s_add_u32 m0, s42, 16384
    s_add_u32 s40, s40, 1024
    buffer_load_dwordx4 v144, s[80:83], s40 offen lds
    s_add_u32 s40, s69, 5
    s_and_b32 s40, s40, 7
    s_mul_i32 s40, s40, 196608
    s_add_u32 s40, s40, s54
    s_add_u32 m0, s42, 20480
    s_add_u32 s40, s40, 1024
    buffer_load_dwordx4 v144, s[80:83], s40 offen lds
    s_add_u32 s40, s69, 6
    s_and_b32 s40, s40, 7
    s_mul_i32 s40, s40, 196608
    s_add_u32 s40, s40, s54
    s_add_u32 m0, s42, 24576
    s_add_u32 s40, s40, 1024
    buffer_load_dwordx4 v144, s[80:83], s40 offen lds
    s_add_u32 s40, s69, 7
    s_and_b32 s40, s40, 7
    s_mul_i32 s40, s40, 196608
    s_add_u32 s40, s40, s54
    s_add_u32 m0, s42, 28672
    s_add_u32 s40, s40, 1024
    buffer_load_dwordx4 v144, s[80:83], s40 offen lds
    s_add_u32 s40, s69, 0
    s_and_b32 s40, s40, 7
    s_mul_i32 s40, s40, 196608
    s_add_u32 s40, s40, s54
    s_add_u32 m0, s42, 32768
    s_add_u32 s40, s40, 2048
    buffer_load_dwordx4 v144, s[80:83], s40 offen lds
    s_add_u32 s40, s69, 1
    s_and_b32 s40, s40, 7
    s_mul_i32 s40, s40, 196608
    s_add_u32 s40, s40, s54
    s_add_u32 m0, s42, 36864
    s_add_u32 s40, s40, 2048
    buffer_load_dwordx4 v144, s[80:83], s40 offen lds
    s_add_u32 s40, s69, 2
    s_and_b32 s40, s40, 7
    s_mul_i32 s40, s40, 196608
    s_add_u32 s40, s40, s54
    s_add_u32 m0, s42, 40960
    s_add_u32 s40, s40, 2048
    buffer_load_dwordx4 v144, s[80:83], s40 offen lds
    s_add_u32 s40, s69, 3
    s_and_b32 s40, s40, 7
    s_mul_i32 s40, s40, 196608
    s_add_u32 s40, s40, s54
    s_add_u32 m0, s42, 45056
    s_add_u32 s40, s40, 2048
    buffer_load_dwordx4 v144, s[80:83], s40 offen lds
    s_add_u32 s40, s69, 4
    s_and_b32 s40, s40, 7
    s_mul_i32 s40, s40, 196608
    s_add_u32 s40, s40, s54
    s_add_u32 m0, s42, 49152
    s_add_u32 s40, s40, 2048
    buffer_load_dwordx4 v144, s[80:83], s40 offen lds
    s_add_u32 s40, s69, 5
    s_and_b32 s40, s40, 7
    s_mul_i32 s40, s40, 196608
    s_add_u32 s40, s40, s54
    s_add_u32 m0, s42, 53248
    s_add_u32 s40, s40, 2048
    buffer_load_dwordx4 v144, s[80:83], s40 offen lds
    s_add_u32 s40, s69, 6
    s_and_b32 s40, s40, 7
    s_mul_i32 s40, s40, 196608
    s_add_u32 s40, s40, s54
    s_add_u32 m0, s42, 57344
    s_add_u32 s40, s40, 2048
    buffer_load_dwordx4 v144, s[80:83], s40 offen lds
    s_add_u32 s40, s69, 7
    s_and_b32 s40, s40, 7
    s_mul_i32 s40, s40, 196608
    s_add_u32 s40, s40, s54
    s_add_u32 m0, s42, 61440
    s_add_u32 s40, s40, 2048
    buffer_load_dwordx4 v144, s[80:83], s40 offen lds
    s_waitcnt lgkmcnt(0)
    s_cmp_eq_u32 s49, 2
    s_cbranch_scc1 f1210
    s_cmp_eq_u32 s49, 1
    s_cbranch_scc1 ffg8
    ds_read_b64_tr_b16 v[160:161], v149 offset:0
    ds_read_b64_tr_b16 v[162:163], v149 offset:2048
    ds_read_b64_tr_b16 v[164:165], v149 offset:64
    ds_read_b64_tr_b16 v[166:167], v149 offset:2112
    ds_read_b64_tr_b16 v[168:169], v149 offset:128
    ds_read_b64_tr_b16 v[170:171], v149 offset:2176
    ds_read_b64_tr_b16 v[172:173], v149 offset:192
    ds_read_b64_tr_b16 v[174:175], v149 offset:2240
    s_waitcnt lgkmcnt(0)
    s_add_u32 s40, s69, 3
    s_and_b32 s40, s40, 7
    s_lshl_b32 s40, s40, 7
    s_add_u32 s40, s40, s55
    s_add_u32 m0, s58, 0
    s_nop 0
    buffer_load_dwordx4 v142, s[76:79], s40 offen lds
    s_add_u32 s40, s40, 8192
    s_add_u32 m0, s58, 1024
    s_nop 0
    buffer_load_dwordx4 v143, s[76:79], s40 offen lds
    s_add_u32 s40, s40, 8192
    s_add_u32 m0, s58, 2048
    s_nop 0
    buffer_load_dwordx4 v142, s[76:79], s40 offen lds
    s_add_u32 s40, s40, 8192
    s_add_u32 m0, s58, 3072
    s_nop 0
    buffer_load_dwordx4 v143, s[76:79], s40 offen lds
    s_add_u32 s40, s69, 4
    s_and_b32 s40, s40, 7
    s_lshl_b32 s40, s40, 7
    s_add_u32 s40, s40, s55
    s_add_u32 m0, s58, 4096
    s_nop 0
    buffer_load_dwordx4 v142, s[76:79], s40 offen lds
    s_add_u32 s40, s40, 8192
    s_add_u32 m0, s58, 5120
    s_nop 0
    buffer_load_dwordx4 v143, s[76:79], s40 offen lds
    s_add_u32 s40, s40, 8192
    s_add_u32 m0, s58, 6144
    s_nop 0
    buffer_load_dwordx4 v142, s[76:79], s40 offen lds
    s_add_u32 s40, s40, 8192
    s_add_u32 m0, s58, 7168
    s_nop 0
    buffer_load_dwordx4 v143, s[76:79], s40 offen lds
    s_mul_i32 s52, s48, 425984
    s_lshl_b32 s53, s62, 10
    s_add_u32 s52, s52, s53
    buffer_store_dwordx4 v[160:163], v0, s[8:11], s52 offen sc1
    s_add_u32 s52, s52, 425984
    buffer_store_dwordx4 v[164:167], v0, s[8:11], s52 offen sc1
    s_add_u32 s52, s52, 425984
    buffer_store_dwordx4 v[168:171], v0, s[8:11], s52 offen sc1
    s_add_u32 s52, s52, 425984
    buffer_store_dwordx4 v[172:175], v0, s[8:11], s52 offen sc1
    s_branch f811
f1210:
    s_add_u32 s40, s69, 3
    s_and_b32 s40, s40, 7
    s_lshl_b32 s40, s40, 7
    s_add_u32 s40, s40, s55
    s_add_u32 m0, s58, 0
    s_nop 0
    buffer_load_dwordx4 v142, s[76:79], s40 offen lds
    s_add_u32 s40, s40, 8192
    s_add_u32 m0, s58, 1024
    s_nop 0
    buffer_load_dwordx4 v143, s[76:79], s40 offen lds
    s_add_u32 s40, s40, 8192
    s_add_u32 m0, s58, 2048
    s_nop 0
    buffer_load_dwordx4 v142, s[76:79], s40 offen lds
    s_add_u32 s40, s40, 8192
    s_add_u32 m0, s58, 3072
    s_nop 0
    buffer_load_dwordx4 v143, s[76:79], s40 offen lds
    s_add_u32 s40, s69, 4
    s_and_b32 s40, s40, 7
    s_lshl_b32 s40, s40, 7
    s_add_u32 s40, s40, s55
    s_add_u32 m0, s58, 4096
    s_nop 0
    buffer_load_dwordx4 v142, s[76:79], s40 offen lds
    s_add_u32 s40, s40, 8192
    s_add_u32 m0, s58, 5120
    s_nop 0
    buffer_load_dwordx4 v143, s[76:79], s40 offen lds
    s_add_u32 s40, s40, 8192
    s_add_u32 m0, s58, 6144
    s_nop 0
    buffer_load_dwordx4 v142, s[76:79], s40 offen lds
    s_add_u32 s40, s40, 8192
    s_add_u32 m0, s58, 7168
    s_nop 0
    buffer_load_dwordx4 v143, s[76:79], s40 offen lds
    buffer_load_dword v212, off, s[8:11], s25
    buffer_load_dword v212, off, s[8:11], s25
    buffer_load_dword v212, off, s[8:11], s25
    buffer_load_dword v212, off, s[8:11], s25
f811:
    buffer_load_dword v212, off, s[8:11], s25
    buffer_load_dword v212, off, s[8:11], s25
    buffer_load_dword v212, off, s[8:11], s25
    buffer_load_dword v212, off, s[8:11], s25
    buffer_load_dword v212, off, s[8:11], s25
    buffer_load_dword v212, off, s[8:11], s25
    buffer_load_dword v212, off, s[8:11], s25
    buffer_load_dword v212, off, s[8:11], s25
    s_branch ffe9
ffg8:
    ds_read_b64_tr_b16 v[160:161], v149 offset:0
    ds_read_b64_tr_b16 v[162:163], v149 offset:2048
    ds_read_b64_tr_b16 v[164:165], v149 offset:32
    ds_read_b64_tr_b16 v[166:167], v149 offset:2080
    ds_read_b64_tr_b16 v[168:169], v149 offset:64
    ds_read_b64_tr_b16 v[170:171], v149 offset:2112
    ds_read_b64_tr_b16 v[172:173], v149 offset:96
    ds_read_b64_tr_b16 v[174:175], v149 offset:2144
    ds_read_b64_tr_b16 v[176:177], v149 offset:128
    ds_read_b64_tr_b16 v[178:179], v149 offset:2176
    ds_read_b64_tr_b16 v[180:181], v149 offset:160
    ds_read_b64_tr_b16 v[182:183], v149 offset:2208
    s_add_u32 s52, s48, 0
    s_lshr_b32 s52, s52, 4
    s_min_u32 s52, s52, 5
    s_mul_i32 s52, s52, 33
    s_add_u32 s52, s52, s72
    s_lshl_b32 s52, s52, 2
    s_load_dword s84, s[50:51], s52
    s_add_u32 s52, s48, 1
    s_lshr_b32 s52, s52, 4
    s_min_u32 s52, s52, 5
    s_mul_i32 s52, s52, 33
    s_add_u32 s52, s52, s72
    s_lshl_b32 s52, s52, 2
    s_load_dword s85, s[50:51], s52
    s_add_u32 s52, s48, 2
    s_lshr_b32 s52, s52, 4
    s_min_u32 s52, s52, 5
    s_mul_i32 s52, s52, 33
    s_add_u32 s52, s52, s72
    s_lshl_b32 s52, s52, 2
    s_load_dword s86, s[50:51], s52
    s_add_u32 s52, s48, 3
    s_lshr_b32 s52, s52, 4
    s_min_u32 s52, s52, 5
    s_mul_i32 s52, s52, 33
    s_add_u32 s52, s52, s72
    s_lshl_b32 s52, s52, 2
    s_load_dword s87, s[50:51], s52
    s_add_u32 s52, s48, 4
    s_lshr_b32 s52, s52, 4
    s_min_u32 s52, s52, 5
    s_mul_i32 s52, s52, 33
    s_add_u32 s52, s52, s72
    s_lshl_b32 s52, s52, 2
    s_load_dword s88, s[50:51], s52
    s_add_u32 s52, s48, 5
    s_lshr_b32 s52, s52, 4
    s_min_u32 s52, s52, 5
    s_mul_i32 s52, s52, 33
    s_add_u32 s52, s52, s72
    s_lshl_b32 s52, s52, 2
    s_load_dword s89, s[50:51], s52
    v_and_b32 v186, 0x1ff, v0
    v_mov_b32 v187, 0x3f803f80
    s_bfe_u32 s53, s72, 0x20002
    s_lshl_b32 s41, s53, 10
    s_lshr_b32 s53, s72, 4
    s_lshl_b32 s53, s53, 9
    s_add_u32 s41, s41, s53
    s_and_b32 s53, s72, 3
    s_lshl_b32 s53, s53, 2
    s_add_u32 s41, s41, s53
    s_add_u32 s41, s41, 7352320
    s_waitcnt lgkmcnt(0)
    s_mov_b32 s91, s41
    s_add_u32 s40, s69, 3
    s_and_b32 s40, s40, 7
    s_lshl_b32 s40, s40, 7
    s_add_u32 s40, s40, s55
    s_add_u32 m0, s58, 0
    s_nop 0
    buffer_load_dwordx4 v142, s[76:79], s40 offen lds
    s_add_u32 s40, s40, 8192
    s_add_u32 m0, s58, 1024
    s_nop 0
    buffer_load_dwordx4 v143, s[76:79], s40 offen lds
    s_add_u32 s40, s40, 8192
    s_add_u32 m0, s58, 2048
    s_nop 0
    buffer_load_dwordx4 v142, s[76:79], s40 offen lds
    s_add_u32 s40, s40, 8192
    s_add_u32 m0, s58, 3072
    s_nop 0
    buffer_load_dwordx4 v143, s[76:79], s40 offen lds
    s_add_u32 s40, s69, 4
    s_and_b32 s40, s40, 7
    s_lshl_b32 s40, s40, 7
    s_add_u32 s40, s40, s55
    s_add_u32 m0, s58, 4096
    s_nop 0
    buffer_load_dwordx4 v142, s[76:79], s40 offen lds
    s_add_u32 s40, s40, 8192
    s_add_u32 m0, s58, 5120
    s_nop 0
    buffer_load_dwordx4 v143, s[76:79], s40 offen lds
    s_add_u32 s40, s40, 8192
    s_add_u32 m0, s58, 6144
    s_nop 0
    buffer_load_dwordx4 v142, s[76:79], s40 offen lds
    s_add_u32 s40, s40, 8192
    s_add_u32 m0, s58, 7168
    s_nop 0
    buffer_load_dwordx4 v143, s[76:79], s40 offen lds
    s_mov_b32 s41, s91
    s_add_u32 s52, s48, 0
    s_cmp_ge_u32 s52, 86
    s_cbranch_scc1 ft12
    s_and_b32 s53, s52, 15
    s_mul_i32 s42, s53, 425984
    s_lshl_b32 s43, s84, 10
    s_add_u32 s42, s42, s43
    buffer_store_dwordx4 v[160:163], v0, s[8:11], s42 offen sc1
    v_mov_b32 v188, 0
    v_dot2_f32_bf16 v188, v160, v187, v188
    v_dot2_f32_bf16 v188, v161, v187, v188
    v_dot2_f32_bf16 v188, v162, v187, v188
    v_dot2_f32_bf16 v188, v163, v187, v188
    s_nop 2
    v_mov_b32 v189, v188
    s_nop 1
    v_permlane32_swap_b32 v188, v189
    s_nop 0
    v_add_f32 v188, v188, v189
    s_mul_i32 s42, s53, 36864
    s_lshr_b32 s43, s52, 4
    s_lshl_b32 s43, s43, 12
    s_add_u32 s42, s42, s43
    s_add_u32 s42, s42, s41
    buffer_store_dword v188, v186, s[8:11], s42 offen sc1
    s_branch fu13
ft12:
    buffer_load_dword v212, off, s[8:11], s25
    buffer_load_dword v212, off, s[8:11], s25
fu13:
    s_add_u32 s52, s48, 1
    s_cmp_ge_u32 s52, 86
    s_cbranch_scc1 ft14
    s_and_b32 s53, s52, 15
    s_mul_i32 s42, s53, 425984
    s_lshl_b32 s43, s85, 10
    s_add_u32 s42, s42, s43
    buffer_store_dwordx4 v[164:167], v0, s[8:11], s42 offen sc1
    v_mov_b32 v188, 0
    v_dot2_f32_bf16 v188, v164, v187, v188
    v_dot2_f32_bf16 v188, v165, v187, v188
    v_dot2_f32_bf16 v188, v166, v187, v188
    v_dot2_f32_bf16 v188, v167, v187, v188
    s_nop 2
    v_mov_b32 v189, v188
    s_nop 1
    v_permlane32_swap_b32 v188, v189
    s_nop 0
    v_add_f32 v188, v188, v189
    s_mul_i32 s42, s53, 36864
    s_lshr_b32 s43, s52, 4
    s_lshl_b32 s43, s43, 12
    s_add_u32 s42, s42, s43
    s_add_u32 s42, s42, s41
    buffer_store_dword v188, v186, s[8:11], s42 offen sc1
    s_branch fu15
ft14:
    buffer_load_dword v212, off, s[8:11], s25
    buffer_load_dword v212, off, s[8:11], s25
fu15:
    s_add_u32 s52, s48, 2
    s_cmp_ge_u32 s52, 86
    s_cbranch_scc1 ft16
    s_and_b32 s53, s52, 15
    s_mul_i32 s42, s53, 425984
    s_lshl_b32 s43, s86, 10
    s_add_u32 s42, s42, s43
    buffer_store_dwordx4 v[168:171], v0, s[8:11], s42 offen sc1
    v_mov_b32 v188, 0
    v_dot2_f32_bf16 v188, v168, v187, v188
    v_dot2_f32_bf16 v188, v169, v187, v188
    v_dot2_f32_bf16 v188, v170, v187, v188
    v_dot2_f32_bf16 v188, v171, v187, v188
    s_nop 2
    v_mov_b32 v189, v188
    s_nop 1
    v_permlane32_swap_b32 v188, v189
    s_nop 0
    v_add_f32 v188, v188, v189
    s_mul_i32 s42, s53, 36864
    s_lshr_b32 s43, s52, 4
    s_lshl_b32 s43, s43, 12
    s_add_u32 s42, s42, s43
    s_add_u32 s42, s42, s41
    buffer_store_dword v188, v186, s[8:11], s42 offen sc1
    s_branch fu17
ft16:
    buffer_load_dword v212, off, s[8:11], s25
    buffer_load_dword v212, off, s[8:11], s25
fu17:
    s_add_u32 s52, s48, 3
    s_cmp_ge_u32 s52, 86
    s_cbranch_scc1 ft18
    s_and_b32 s53, s52, 15
    s_mul_i32 s42, s53, 425984
    s_lshl_b32 s43, s87, 10
    s_add_u32 s42, s42, s43
    buffer_store_dwordx4 v[172:175], v0, s[8:11], s42 offen sc1
    v_mov_b32 v188, 0
    v_dot2_f32_bf16 v188, v172, v187, v188
    v_dot2_f32_bf16 v188, v173, v187, v188
    v_dot2_f32_bf16 v188, v174, v187, v188
    v_dot2_f32_bf16 v188, v175, v187, v188
    s_nop 2
    v_mov_b32 v189, v188
    s_nop 1
    v_permlane32_swap_b32 v188, v189
    s_nop 0
    v_add_f32 v188, v188, v189
    s_mul_i32 s42, s53, 36864
    s_lshr_b32 s43, s52, 4
    s_lshl_b32 s43, s43, 12
    s_add_u32 s42, s42, s43
    s_add_u32 s42, s42, s41
    buffer_store_dword v188, v186, s[8:11], s42 offen sc1
    s_branch fu19
ft18:
    buffer_load_dword v212, off, s[8:11], s25
    buffer_load_dword v212, off, s[8:11], s25
fu19:
    s_add_u32 s52, s48, 4
    s_cmp_ge_u32 s52, 86
    s_cbranch_scc1 ft20
    s_and_b32 s53, s52, 15
    s_mul_i32 s42, s53, 425984
    s_lshl_b32 s43, s88, 10
    s_add_u32 s42, s42, s43
    buffer_store_dwordx4 v[176:179], v0, s[8:11], s42 offen sc1
    v_mov_b32 v188, 0
    v_dot2_f32_bf16 v188, v176, v187, v188
    v_dot2_f32_bf16 v188, v177, v187, v188
    v_dot2_f32_bf16 v188, v178, v187, v188
    v_dot2_f32_bf16 v188, v179, v187, v188
    s_nop 2
    v_mov_b32 v189, v188
    s_nop 1
    v_permlane32_swap_b32 v188, v189
    s_nop 0
    v_add_f32 v188, v188, v189
    s_mul_i32 s42, s53, 36864
    s_lshr_b32 s43, s52, 4
    s_lshl_b32 s43, s43, 12
    s_add_u32 s42, s42, s43
    s_add_u32 s42, s42, s41
    buffer_store_dword v188, v186, s[8:11], s42 offen sc1
    s_branch fu21
ft20:
    buffer_load_dword v212, off, s[8:11], s25
    buffer_load_dword v212, off, s[8:11], s25
fu21:
    s_add_u32 s52, s48, 5
    s_cmp_ge_u32 s52, 86
    s_cbranch_scc1 ft22
    s_and_b32 s53, s52, 15
    s_mul_i32 s42, s53, 425984
    s_lshl_b32 s43, s89, 10
    s_add_u32 s42, s42, s43
    buffer_store_dwordx4 v[180:183], v0, s[8:11], s42 offen sc1
    v_mov_b32 v188, 0
    v_dot2_f32_bf16 v188, v180, v187, v188
    v_dot2_f32_bf16 v188, v181, v187, v188
    v_dot2_f32_bf16 v188, v182, v187, v188
    v_dot2_f32_bf16 v188, v183, v187, v188
    s_nop 2
    v_mov_b32 v189, v188
    s_nop 1
    v_permlane32_swap_b32 v188, v189
    s_nop 0
    v_add_f32 v188, v188, v189
    s_mul_i32 s42, s53, 36864
    s_lshr_b32 s43, s52, 4
    s_lshl_b32 s43, s43, 12
    s_add_u32 s42, s42, s43
    s_add_u32 s42, s42, s41
    buffer_store_dword v188, v186, s[8:11], s42 offen sc1
    s_branch fu23
ft22:
    buffer_load_dword v212, off, s[8:11], s25
    buffer_load_dword v212, off, s[8:11], s25
fu23:
ffe9:
    v_lshrrev_b32 v213, 7, v0
    v_mul_u32_u24 v213, 3072, v213
    v_and_b32 v214, 0x70, v0
    v_lshlrev_b32 v214, 3, v214
    v_add_u32 v213, v213, v214
    s_mov_b64 exec, 0xffffffff
    buffer_load_dword v211, v213, s[80:83], s68 offen
    s_mov_b64 exec, -1
    v_mov_b32 v44, 0x3f803f80
    v_mov_b32 v45, 0x3f803f80
    v_mov_b32 v46, 0x3f803f80
    v_mov_b32 v47, 0x3f803f80
    v_mov_b32 v140, 0
    v_mov_b32 v141, 0
    v_mov_b32 v150, 0
    v_mov_b32 v151, 0
    s_lshr_b32 s56, s17, 1
    s_sub_u32 s56, s56, s69
    s_and_b32 s56, s56, 7
    s_sub_u32 s52, s58, s57
    v_add_u32 v200, s52, v132
    v_add_u32 v201, s52, v133
    v_add_u32 v202, s52, v134
    v_add_u32 v203, s52, v135
    v_add_u32 v204, s52, v136
    v_add_u32 v205, s52, v137
    v_add_u32 v206, s52, v138
    v_add_u32 v207, s52, v139
    v_add_u32 v208, s52, v145
    s_waitcnt vmcnt(45)
    ds_read_b64 v[28:29], v132 offset:0
    ds_read_b64 v[30:31], v133 offset:0
    ds_read_b64 v[32:33], v134 offset:0
    ds_read_b64 v[34:35], v135 offset:0
    ds_read_b64 v[36:37], v136 offset:0
    ds_read_b64 v[38:39], v137 offset:0
    ds_read_b64 v[40:41], v138 offset:0
    ds_read_b64 v[42:43], v139 offset:0
    ds_read_b64 a[0:1], v132 offset:0
    ds_read_b64 a[2:3], v133 offset:0
    ds_read_b64 a[4:5], v134 offset:0
    ds_read_b64 a[6:7], v135 offset:0
    ds_read_b64 a[8:9], v136 offset:0
    ds_read_b64 a[10:11], v137 offset:0
    ds_read_b64 a[12:13], v138 offset:0
    ds_read_b64 a[14:15], v139 offset:0
    s_cmp_eq_u32 s56, 0
    s_cbranch_scc1 ob24
or25:
    s_waitcnt lgkmcnt(14)
    v_dot2_f32_bf16 v140, v28, v44, v140
    v_dot2_f32_bf16 v141, v28, v28, v141
    v_dot2_f32_bf16 v150, v29, v44, v150
    v_dot2_f32_bf16 v151, v29, v29, v151
    v_dot2_f32_bf16 v140, v30, v44, v140
    v_dot2_f32_bf16 v141, v30, v30, v141
    v_dot2_f32_bf16 v150, v31, v44, v150
    v_dot2_f32_bf16 v151, v31, v31, v151
    s_waitcnt lgkmcnt(12)
    v_dot2_f32_bf16 v140, v32, v44, v140
    v_dot2_f32_bf16 v141, v32, v32, v141
    v_dot2_f32_bf16 v150, v33, v44, v150
    v_dot2_f32_bf16 v151, v33, v33, v151
    v_dot2_f32_bf16 v140, v34, v44, v140
    v_dot2_f32_bf16 v141, v34, v34, v141
    v_dot2_f32_bf16 v150, v35, v44, v150
    v_dot2_f32_bf16 v151, v35, v35, v151
    s_waitcnt lgkmcnt(10)
    v_dot2_f32_bf16 v140, v36, v44, v140
    v_dot2_f32_bf16 v141, v36, v36, v141
    v_dot2_f32_bf16 v150, v37, v44, v150
    v_dot2_f32_bf16 v151, v37, v37, v151
    v_dot2_f32_bf16 v140, v38, v44, v140
    v_dot2_f32_bf16 v141, v38, v38, v141
    v_dot2_f32_bf16 v150, v39, v44, v150
    v_dot2_f32_bf16 v151, v39, v39, v151
    s_waitcnt lgkmcnt(8)
    v_dot2_f32_bf16 v140, v40, v44, v140
    v_dot2_f32_bf16 v141, v40, v40, v141
    v_dot2_f32_bf16 v150, v41, v44, v150
    v_dot2_f32_bf16 v151, v41, v41, v151
    v_dot2_f32_bf16 v140, v42, v44, v140
    v_dot2_f32_bf16 v141, v42, v42, v141
    v_dot2_f32_bf16 v150, v43, v44, v150
    v_dot2_f32_bf16 v151, v43, v43, v151
    s_waitcnt lgkmcnt(0)
    s_add_u32 s40, s69, 5
    s_and_b32 s40, s40, 7
    s_lshl_b32 s40, s40, 7
    s_add_u32 s40, s40, s55
    s_add_u32 m0, s57, 0
    s_nop 0
    buffer_load_dwordx4 v142, s[76:79], s40 offen lds
    s_add_u32 s40, s40, 8192
    s_add_u32 m0, s57, 1024
    s_nop 0
    buffer_load_dwordx4 v143, s[76:79], s40 offen lds
    s_add_u32 s40, s40, 8192
    s_add_u32 m0, s57, 2048
    s_nop 0
    buffer_load_dwordx4 v142, s[76:79], s40 offen lds
    s_add_u32 s40, s40, 8192
    s_add_u32 m0, s57, 3072
    s_nop 0
    buffer_load_dwordx4 v143, s[76:79], s40 offen lds
    s_waitcnt vmcnt(45)
    ds_read_b64 v[28:29], v132 offset:4096
    ds_read_b64 v[30:31], v133 offset:4096
    ds_read_b64 v[32:33], v134 offset:4096
    ds_read_b64 v[34:35], v135 offset:4096
    ds_read_b64 v[36:37], v136 offset:4096
    ds_read_b64 v[38:39], v137 offset:4096
    ds_read_b64 v[40:41], v138 offset:4096
    ds_read_b64 v[42:43], v139 offset:4096
    ds_read_b64 a[16:17], v132 offset:4096
    ds_read_b64 a[18:19], v133 offset:4096
    ds_read_b64 a[20:21], v134 offset:4096
    ds_read_b64 a[22:23], v135 offset:4096
    ds_read_b64 a[24:25], v136 offset:4096
    ds_read_b64 a[26:27], v137 offset:4096
    ds_read_b64 a[28:29], v138 offset:4096
    ds_read_b64 a[30:31], v139 offset:4096
    s_cmp_eq_u32 s56, 1
    s_cbranch_scc1 ob26
or27:
    s_waitcnt lgkmcnt(14)
    v_dot2_f32_bf16 v140, v28, v44, v140
    v_dot2_f32_bf16 v141, v28, v28, v141
    v_dot2_f32_bf16 v150, v29, v44, v150
    v_dot2_f32_bf16 v151, v29, v29, v151
    v_dot2_f32_bf16 v140, v30, v44, v140
    v_dot2_f32_bf16 v141, v30, v30, v141
    v_dot2_f32_bf16 v150, v31, v44, v150
    v_dot2_f32_bf16 v151, v31, v31, v151
    s_waitcnt lgkmcnt(12)
    v_dot2_f32_bf16 v140, v32, v44, v140
    v_dot2_f32_bf16 v141, v32, v32, v141
    v_dot2_f32_bf16 v150, v33, v44, v150
    v_dot2_f32_bf16 v151, v33, v33, v151
    v_dot2_f32_bf16 v140, v34, v44, v140
    v_dot2_f32_bf16 v141, v34, v34, v141
    v_dot2_f32_bf16 v150, v35, v44, v150
    v_dot2_f32_bf16 v151, v35, v35, v151
    s_waitcnt lgkmcnt(10)
    v_dot2_f32_bf16 v140, v36, v44, v140
    v_dot2_f32_bf16 v141, v36, v36, v141
    v_dot2_f32_bf16 v150, v37, v44, v150
    v_dot2_f32_bf16 v151, v37, v37, v151
    v_dot2_f32_bf16 v140, v38, v44, v140
    v_dot2_f32_bf16 v141, v38, v38, v141
    v_dot2_f32_bf16 v150, v39, v44, v150
    v_dot2_f32_bf16 v151, v39, v39, v151
    s_waitcnt lgkmcnt(8)
    v_dot2_f32_bf16 v140, v40, v44, v140
    v_dot2_f32_bf16 v141, v40, v40, v141
    v_dot2_f32_bf16 v150, v41, v44, v150
    v_dot2_f32_bf16 v151, v41, v41, v151
    v_dot2_f32_bf16 v140, v42, v44, v140
    v_dot2_f32_bf16 v141, v42, v42, v141
    v_dot2_f32_bf16 v150, v43, v44, v150
    v_dot2_f32_bf16 v151, v43, v43, v151
    s_waitcnt lgkmcnt(0)
    s_add_u32 s40, s69, 6
    s_and_b32 s40, s40, 7
    s_lshl_b32 s40, s40, 7
    s_add_u32 s40, s40, s55
    s_add_u32 m0, s57, 4096
    s_nop 0
    buffer_load_dwordx4 v142, s[76:79], s40 offen lds
    s_add_u32 s40, s40, 8192
    s_add_u32 m0, s57, 5120
    s_nop 0
    buffer_load_dwordx4 v143, s[76:79], s40 offen lds
    s_add_u32 s40, s40, 8192
    s_add_u32 m0, s57, 6144
    s_nop 0
    buffer_load_dwordx4 v142, s[76:79], s40 offen lds
    s_add_u32 s40, s40, 8192
    s_add_u32 m0, s57, 7168
    s_nop 0
    buffer_load_dwordx4 v143, s[76:79], s40 offen lds
    s_waitcnt vmcnt(45)
    ds_read_b64 v[28:29], v132 offset:8192
    ds_read_b64 v[30:31], v133 offset:8192
    ds_read_b64 v[32:33], v134 offset:8192
    ds_read_b64 v[34:35], v135 offset:8192
    ds_read_b64 v[36:37], v136 offset:8192
    ds_read_b64 v[38:39], v137 offset:8192
    ds_read_b64 v[40:41], v138 offset:8192
    ds_read_b64 v[42:43], v139 offset:8192
    ds_read_b64 a[32:33], v132 offset:8192
    ds_read_b64 a[34:35], v133 offset:8192
    ds_read_b64 a[36:37], v134 offset:8192
    ds_read_b64 a[38:39], v135 offset:8192
    ds_read_b64 a[40:41], v136 offset:8192
    ds_read_b64 a[42:43], v137 offset:8192
    ds_read_b64 a[44:45], v138 offset:8192
    ds_read_b64 a[46:47], v139 offset:8192
    s_cmp_eq_u32 s56, 2
    s_cbranch_scc1 ob28
or29:
    s_waitcnt lgkmcnt(14)
    v_dot2_f32_bf16 v140, v28, v44, v140
    v_dot2_f32_bf16 v141, v28, v28, v141
    v_dot2_f32_bf16 v150, v29, v44, v150
    v_dot2_f32_bf16 v151, v29, v29, v151
    v_dot2_f32_bf16 v140, v30, v44, v140
    v_dot2_f32_bf16 v141, v30, v30, v141
    v_dot2_f32_bf16 v150, v31, v44, v150
    v_dot2_f32_bf16 v151, v31, v31, v151
    s_waitcnt lgkmcnt(12)
    v_dot2_f32_bf16 v140, v32, v44, v140
    v_dot2_f32_bf16 v141, v32, v32, v141
    v_dot2_f32_bf16 v150, v33, v44, v150
    v_dot2_f32_bf16 v151, v33, v33, v151
    v_dot2_f32_bf16 v140, v34, v44, v140
    v_dot2_f32_bf16 v141, v34, v34, v141
    v_dot2_f32_bf16 v150, v35, v44, v150
    v_dot2_f32_bf16 v151, v35, v35, v151
    s_waitcnt lgkmcnt(10)
    v_dot2_f32_bf16 v140, v36, v44, v140
    v_dot2_f32_bf16 v141, v36, v36, v141
    v_dot2_f32_bf16 v150, v37, v44, v150
    v_dot2_f32_bf16 v151, v37, v37, v151
    v_dot2_f32_bf16 v140, v38, v44, v140
    v_dot2_f32_bf16 v141, v38, v38, v141
    v_dot2_f32_bf16 v150, v39, v44, v150
    v_dot2_f32_bf16 v151, v39, v39, v151
    s_waitcnt lgkmcnt(8)
    v_dot2_f32_bf16 v140, v40, v44, v140
    v_dot2_f32_bf16 v141, v40, v40, v141
    v_dot2_f32_bf16 v150, v41, v44, v150
    v_dot2_f32_bf16 v151, v41, v41, v151
    v_dot2_f32_bf16 v140, v42, v44, v140
    v_dot2_f32_bf16 v141, v42, v42, v141
    v_dot2_f32_bf16 v150, v43, v44, v150
    v_dot2_f32_bf16 v151, v43, v43, v151
    s_waitcnt lgkmcnt(0)
    s_add_u32 s40, s69, 7
    s_and_b32 s40, s40, 7
    s_lshl_b32 s40, s40, 7
    s_add_u32 s40, s40, s55
    s_add_u32 m0, s57, 8192
    s_nop 0
    buffer_load_dwordx4 v142, s[76:79], s40 offen lds
    s_add_u32 s40, s40, 8192
    s_add_u32 m0, s57, 9216
    s_nop 0
    buffer_load_dwordx4 v143, s[76:79], s40 offen lds
    s_add_u32 s40, s40, 8192
    s_add_u32 m0, s57, 10240
    s_nop 0
    buffer_load_dwordx4 v142, s[76:79], s40 offen lds
    s_add_u32 s40, s40, 8192
    s_add_u32 m0, s57, 11264
    s_nop 0
    buffer_load_dwordx4 v143, s[76:79], s40 offen lds
    s_waitcnt vmcnt(29)
    ds_read_b64 v[28:29], v200 offset:0
    ds_read_b64 v[30:31], v201 offset:0
    ds_read_b64 v[32:33], v202 offset:0
    ds_read_b64 v[34:35], v203 offset:0
    ds_read_b64 v[36:37], v204 offset:0
    ds_read_b64 v[38:39], v205 offset:0
    ds_read_b64 v[40:41], v206 offset:0
    ds_read_b64 v[42:43], v207 offset:0
    ds_read_b64 a[48:49], v200 offset:0
    ds_read_b64 a[50:51], v201 offset:0
    ds_read_b64 a[52:53], v202 offset:0
    ds_read_b64 a[54:55], v203 offset:0
    ds_read_b64 a[56:57], v204 offset:0
    ds_read_b64 a[58:59], v205 offset:0
    ds_read_b64 a[60:61], v206 offset:0
    ds_read_b64 a[62:63], v207 offset:0
    s_cmp_eq_u32 s56, 3
    s_cbranch_scc1 ob30
or31:
    s_waitcnt lgkmcnt(14)
    v_dot2_f32_bf16 v140, v28, v44, v140
    v_dot2_f32_bf16 v141, v28, v28, v141
    v_dot2_f32_bf16 v150, v29, v44, v150
    v_dot2_f32_bf16 v151, v29, v29, v151
    v_dot2_f32_bf16 v140, v30, v44, v140
    v_dot2_f32_bf16 v141, v30, v30, v141
    v_dot2_f32_bf16 v150, v31, v44, v150
    v_dot2_f32_bf16 v151, v31, v31, v151
    s_waitcnt lgkmcnt(12)
    v_dot2_f32_bf16 v140, v32, v44, v140
    v_dot2_f32_bf16 v141, v32, v32, v141
    v_dot2_f32_bf16 v150, v33, v44, v150
    v_dot2_f32_bf16 v151, v33, v33, v151
    v_dot2_f32_bf16 v140, v34, v44, v140
    v_dot2_f32_bf16 v141, v34, v34, v141
    v_dot2_f32_bf16 v150, v35, v44, v150
    v_dot2_f32_bf16 v151, v35, v35, v151
    s_waitcnt lgkmcnt(10)
    v_dot2_f32_bf16 v140, v36, v44, v140
    v_dot2_f32_bf16 v141, v36, v36, v141
    v_dot2_f32_bf16 v150, v37, v44, v150
    v_dot2_f32_bf16 v151, v37, v37, v151
    v_dot2_f32_bf16 v140, v38, v44, v140
    v_dot2_f32_bf16 v141, v38, v38, v141
    v_dot2_f32_bf16 v150, v39, v44, v150
    v_dot2_f32_bf16 v151, v39, v39, v151
    s_waitcnt lgkmcnt(8)
    v_dot2_f32_bf16 v140, v40, v44, v140
    v_dot2_f32_bf16 v141, v40, v40, v141
    v_dot2_f32_bf16 v150, v41, v44, v150
    v_dot2_f32_bf16 v151, v41, v41, v151
    v_dot2_f32_bf16 v140, v42, v44, v140
    v_dot2_f32_bf16 v141, v42, v42, v141
    v_dot2_f32_bf16 v150, v43, v44, v150
    v_dot2_f32_bf16 v151, v43, v43, v151
    s_waitcnt lgkmcnt(0)
    s_waitcnt vmcnt(25)
    ds_read_b64 v[28:29], v200 offset:4096
    ds_read_b64 v[30:31], v201 offset:4096
    ds_read_b64 v[32:33], v202 offset:4096
    ds_read_b64 v[34:35], v203 offset:4096
    ds_read_b64 v[36:37], v204 offset:4096
    ds_read_b64 v[38:39], v205 offset:4096
    ds_read_b64 v[40:41], v206 offset:4096
    ds_read_b64 v[42:43], v207 offset:4096
    ds_read_b64 a[64:65], v200 offset:4096
    ds_read_b64 a[66:67], v201 offset:4096
    ds_read_b64 a[68:69], v202 offset:4096
    ds_read_b64 a[70:71], v203 offset:4096
    ds_read_b64 a[72:73], v204 offset:4096
    ds_read_b64 a[74:75], v205 offset:4096
    ds_read_b64 a[76:77], v206 offset:4096
    ds_read_b64 a[78:79], v207 offset:4096
    s_cmp_eq_u32 s56, 4
    s_cbranch_scc1 ob32
or33:
    s_waitcnt lgkmcnt(14)
    v_dot2_f32_bf16 v140, v28, v44, v140
    v_dot2_f32_bf16 v141, v28, v28, v141
    v_dot2_f32_bf16 v150, v29, v44, v150
    v_dot2_f32_bf16 v151, v29, v29, v151
    v_dot2_f32_bf16 v140, v30, v44, v140
    v_dot2_f32_bf16 v141, v30, v30, v141
    v_dot2_f32_bf16 v150, v31, v44, v150
    v_dot2_f32_bf16 v151, v31, v31, v151
    s_waitcnt lgkmcnt(12)
    v_dot2_f32_bf16 v140, v32, v44, v140
    v_dot2_f32_bf16 v141, v32, v32, v141
    v_dot2_f32_bf16 v150, v33, v44, v150
    v_dot2_f32_bf16 v151, v33, v33, v151
    v_dot2_f32_bf16 v140, v34, v44, v140
    v_dot2_f32_bf16 v141, v34, v34, v141
    v_dot2_f32_bf16 v150, v35, v44, v150
    v_dot2_f32_bf16 v151, v35, v35, v151
    s_waitcnt lgkmcnt(10)
    v_dot2_f32_bf16 v140, v36, v44, v140
    v_dot2_f32_bf16 v141, v36, v36, v141
    v_dot2_f32_bf16 v150, v37, v44, v150
    v_dot2_f32_bf16 v151, v37, v37, v151
    v_dot2_f32_bf16 v140, v38, v44, v140
    v_dot2_f32_bf16 v141, v38, v38, v141
    v_dot2_f32_bf16 v150, v39, v44, v150
    v_dot2_f32_bf16 v151, v39, v39, v151
    s_waitcnt lgkmcnt(8)
    v_dot2_f32_bf16 v140, v40, v44, v140
    v_dot2_f32_bf16 v141, v40, v40, v141
    v_dot2_f32_bf16 v150, v41, v44, v150
    v_dot2_f32_bf16 v151, v41, v41, v151
    v_dot2_f32_bf16 v140, v42, v44, v140
    v_dot2_f32_bf16 v141, v42, v42, v141
    v_dot2_f32_bf16 v150, v43, v44, v150
    v_dot2_f32_bf16 v151, v43, v43, v151
    s_waitcnt lgkmcnt(0)
    s_waitcnt vmcnt(8)
    s_barrier
    s_cmp_lg_u32 s18, 0
    s_cbranch_scc1 db34
    v_mov_b32 v7, s3
    buffer_store_byte v7, off, s[4:7], s64 sc1
db34:
    s_or_b32 s40, s17, s18
    s_cmp_eq_u32 s40, 0
    s_cselect_b32 s72, 1, 0
    ds_read_b64 v[28:29], v132 offset:0
    ds_read_b64 v[30:31], v133 offset:0
    ds_read_b64 v[32:33], v134 offset:0
    ds_read_b64 v[34:35], v135 offset:0
    ds_read_b64 v[36:37], v136 offset:0
    ds_read_b64 v[38:39], v137 offset:0
    ds_read_b64 v[40:41], v138 offset:0
    ds_read_b64 v[42:43], v139 offset:0
    ds_read_b64 a[80:81], v132 offset:0
    ds_read_b64 a[82:83], v133 offset:0
    ds_read_b64 a[84:85], v134 offset:0
    ds_read_b64 a[86:87], v135 offset:0
    ds_read_b64 a[88:89], v136 offset:0
    ds_read_b64 a[90:91], v137 offset:0
    ds_read_b64 a[92:93], v138 offset:0
    ds_read_b64 a[94:95], v139 offset:0
    s_cmp_eq_u32 s56, 5
    s_cbranch_scc1 ob35
or36:
    s_waitcnt lgkmcnt(14)
    v_dot2_f32_bf16 v140, v28, v44, v140
    v_dot2_f32_bf16 v141, v28, v28, v141
    v_dot2_f32_bf16 v150, v29, v44, v150
    v_dot2_f32_bf16 v151, v29, v29, v151
    v_dot2_f32_bf16 v140, v30, v44, v140
    v_dot2_f32_bf16 v141, v30, v30, v141
    v_dot2_f32_bf16 v150, v31, v44, v150
    v_dot2_f32_bf16 v151, v31, v31, v151
    s_waitcnt lgkmcnt(12)
    v_dot2_f32_bf16 v140, v32, v44, v140
    v_dot2_f32_bf16 v141, v32, v32, v141
    v_dot2_f32_bf16 v150, v33, v44, v150
    v_dot2_f32_bf16 v151, v33, v33, v151
    v_dot2_f32_bf16 v140, v34, v44, v140
    v_dot2_f32_bf16 v141, v34, v34, v141
    v_dot2_f32_bf16 v150, v35, v44, v150
    v_dot2_f32_bf16 v151, v35, v35, v151
    s_waitcnt lgkmcnt(10)
    v_dot2_f32_bf16 v140, v36, v44, v140
    v_dot2_f32_bf16 v141, v36, v36, v141
    v_dot2_f32_bf16 v150, v37, v44, v150
    v_dot2_f32_bf16 v151, v37, v37, v151
    v_dot2_f32_bf16 v140, v38, v44, v140
    v_dot2_f32_bf16 v141, v38, v38, v141
    v_dot2_f32_bf16 v150, v39, v44, v150
    v_dot2_f32_bf16 v151, v39, v39, v151
    s_waitcnt lgkmcnt(8)
    v_dot2_f32_bf16 v140, v40, v44, v140
    v_dot2_f32_bf16 v141, v40, v40, v141
    v_dot2_f32_bf16 v150, v41, v44, v150
    v_dot2_f32_bf16 v151, v41, v41, v151
    v_dot2_f32_bf16 v140, v42, v44, v140
    v_dot2_f32_bf16 v141, v42, v42, v141
    v_dot2_f32_bf16 v150, v43, v44, v150
    v_dot2_f32_bf16 v151, v43, v43, v151
    s_waitcnt lgkmcnt(0)
    s_lshl_b32 s42, s18, 10
    s_add_u32 s40, s69, 0
    s_and_b32 s40, s40, 7
    s_mul_i32 s40, s40, 196608
    s_add_u32 s40, s40, s54
    s_add_u32 m0, s42, 65536
    s_add_u32 s40, s40, 0
    buffer_load_dwordx4 v144, s[80:83], s40 offen lds
    s_add_u32 s40, s69, 1
    s_and_b32 s40, s40, 7
    s_mul_i32 s40, s40, 196608
    s_add_u32 s40, s40, s54
    s_add_u32 m0, s42, 69632
    s_add_u32 s40, s40, 0
    buffer_load_dwordx4 v144, s[80:83], s40 offen lds
    s_add_u32 s40, s69, 2
    s_and_b32 s40, s40, 7
    s_mul_i32 s40, s40, 196608
    s_add_u32 s40, s40, s54
    s_add_u32 m0, s42, 73728
    s_add_u32 s40, s40, 0
    buffer_load_dwordx4 v144, s[80:83], s40 offen lds
    s_add_u32 s40, s69, 3
    s_and_b32 s40, s40, 7
    s_mul_i32 s40, s40, 196608
    s_add_u32 s40, s40, s54
    s_add_u32 m0, s42, 77824
    s_add_u32 s40, s40, 0
    buffer_load_dwordx4 v144, s[80:83], s40 offen lds
    s_add_u32 s40, s69, 4
    s_and_b32 s40, s40, 7
    s_mul_i32 s40, s40, 196608
    s_add_u32 s40, s40, s54
    s_add_u32 m0, s42, 81920
    s_add_u32 s40, s40, 0
    buffer_load_dwordx4 v144, s[80:83], s40 offen lds
    s_add_u32 s40, s69, 5
    s_and_b32 s40, s40, 7
    s_mul_i32 s40, s40, 196608
    s_add_u32 s40, s40, s54
    s_add_u32 m0, s42, 86016
    s_add_u32 s40, s40, 0
    buffer_load_dwordx4 v144, s[80:83], s40 offen lds
    s_add_u32 s40, s69, 6
    s_and_b32 s40, s40, 7
    s_mul_i32 s40, s40, 196608
    s_add_u32 s40, s40, s54
    s_add_u32 m0, s42, 90112
    s_add_u32 s40, s40, 0
    buffer_load_dwordx4 v144, s[80:83], s40 offen lds
    s_add_u32 s40, s69, 7
    s_and_b32 s40, s40, 7
    s_mul_i32 s40, s40, 196608
    s_add_u32 s40, s40, s54
    s_add_u32 m0, s42, 94208
    s_add_u32 s40, s40, 0
    buffer_load_dwordx4 v144, s[80:83], s40 offen lds
    v_lshrrev_b32 v192, 2, v0
    s_cmp_eq_u32 s72, 1
    s_cbranch_scc1 ob37
or38:
    s_waitcnt vmcnt(12)
    ds_read_b64 v[28:29], v132 offset:4096
    ds_read_b64 v[30:31], v133 offset:4096
    ds_read_b64 v[32:33], v134 offset:4096
    ds_read_b64 v[34:35], v135 offset:4096
    ds_read_b64 v[36:37], v136 offset:4096
    ds_read_b64 v[38:39], v137 offset:4096
    ds_read_b64 v[40:41], v138 offset:4096
    ds_read_b64 v[42:43], v139 offset:4096
    ds_read_b64 a[96:97], v132 offset:4096
    ds_read_b64 a[98:99], v133 offset:4096
    ds_read_b64 a[100:101], v134 offset:4096
    ds_read_b64 a[102:103], v135 offset:4096
    ds_read_b64 a[104:105], v136 offset:4096
    ds_read_b64 a[106:107], v137 offset:4096
    ds_read_b64 a[108:109], v138 offset:4096
    ds_read_b64 a[110:111], v139 offset:4096
    s_cmp_eq_u32 s56, 6
    s_cbranch_scc1 ob39
or40:
    s_waitcnt lgkmcnt(14)
    v_dot2_f32_bf16 v140, v28, v44, v140
    v_dot2_f32_bf16 v141, v28, v28, v141
    v_dot2_f32_bf16 v150, v29, v44, v150
    v_dot2_f32_bf16 v151, v29, v29, v151
    v_dot2_f32_bf16 v140, v30, v44, v140
    v_dot2_f32_bf16 v141, v30, v30, v141
    v_dot2_f32_bf16 v150, v31, v44, v150
    v_dot2_f32_bf16 v151, v31, v31, v151
    s_waitcnt lgkmcnt(12)
    v_dot2_f32_bf16 v140, v32, v44, v140
    v_dot2_f32_bf16 v141, v32, v32, v141
    v_dot2_f32_bf16 v150, v33, v44, v150
    v_dot2_f32_bf16 v151, v33, v33, v151
    v_dot2_f32_bf16 v140, v34, v44, v140
    v_dot2_f32_bf16 v141, v34, v34, v141
    v_dot2_f32_bf16 v150, v35, v44, v150
    v_dot2_f32_bf16 v151, v35, v35, v151
    s_waitcnt lgkmcnt(10)
    v_dot2_f32_bf16 v140, v36, v44, v140
    v_dot2_f32_bf16 v141, v36, v36, v141
    v_dot2_f32_bf16 v150, v37, v44, v150
    v_dot2_f32_bf16 v151, v37, v37, v151
    v_dot2_f32_bf16 v140, v38, v44, v140
    v_dot2_f32_bf16 v141, v38, v38, v141
    v_dot2_f32_bf16 v150, v39, v44, v150
    v_dot2_f32_bf16 v151, v39, v39, v151
    s_waitcnt lgkmcnt(8)
    v_dot2_f32_bf16 v140, v40, v44, v140
    v_dot2_f32_bf16 v141, v40, v40, v141
    v_dot2_f32_bf16 v150, v41, v44, v150
    v_dot2_f32_bf16 v151, v41, v41, v151
    v_dot2_f32_bf16 v140, v42, v44, v140
    v_dot2_f32_bf16 v141, v42, v42, v141
    v_dot2_f32_bf16 v150, v43, v44, v150
    v_dot2_f32_bf16 v151, v43, v43, v151
    s_waitcnt lgkmcnt(0)
    s_cmp_eq_u32 s72, 1
    s_cbranch_scc1 ob41
or42:
    s_waitcnt vmcnt(8)
    ds_read_b64 v[28:29], v132 offset:8192
    ds_read_b64 v[30:31], v133 offset:8192
    ds_read_b64 v[32:33], v134 offset:8192
    ds_read_b64 v[34:35], v135 offset:8192
    ds_read_b64 v[36:37], v136 offset:8192
    ds_read_b64 v[38:39], v137 offset:8192
    ds_read_b64 v[40:41], v138 offset:8192
    ds_read_b64 v[42:43], v139 offset:8192
    ds_read_b64 a[112:113], v132 offset:8192
    ds_read_b64 a[114:115], v133 offset:8192
    ds_read_b64 a[116:117], v134 offset:8192
    ds_read_b64 a[118:119], v135 offset:8192
    ds_read_b64 a[120:121], v136 offset:8192
    ds_read_b64 a[122:123], v137 offset:8192
    ds_read_b64 a[124:125], v138 offset:8192
    ds_read_b64 a[126:127], v139 offset:8192
    s_cmp_eq_u32 s56, 7
    s_cbranch_scc1 ob43
or44:
    s_waitcnt lgkmcnt(14)
    v_dot2_f32_bf16 v140, v28, v44, v140
    v_dot2_f32_bf16 v141, v28, v28, v141
    v_dot2_f32_bf16 v150, v29, v44, v150
    v_dot2_f32_bf16 v151, v29, v29, v151
    v_dot2_f32_bf16 v140, v30, v44, v140
    v_dot2_f32_bf16 v141, v30, v30, v141
    v_dot2_f32_bf16 v150, v31, v44, v150
    v_dot2_f32_bf16 v151, v31, v31, v151
    s_waitcnt lgkmcnt(12)
    v_dot2_f32_bf16 v140, v32, v44, v140
    v_dot2_f32_bf16 v141, v32, v32, v141
    v_dot2_f32_bf16 v150, v33, v44, v150
    v_dot2_f32_bf16 v151, v33, v33, v151
    v_dot2_f32_bf16 v140, v34, v44, v140
    v_dot2_f32_bf16 v141, v34, v34, v141
    v_dot2_f32_bf16 v150, v35, v44, v150
    v_dot2_f32_bf16 v151, v35, v35, v151
    s_waitcnt lgkmcnt(10)
    v_dot2_f32_bf16 v140, v36, v44, v140
    v_dot2_f32_bf16 v141, v36, v36, v141
    v_dot2_f32_bf16 v150, v37, v44, v150
    v_dot2_f32_bf16 v151, v37, v37, v151
    v_dot2_f32_bf16 v140, v38, v44, v140
    v_dot2_f32_bf16 v141, v38, v38, v141
    v_dot2_f32_bf16 v150, v39, v44, v150
    v_dot2_f32_bf16 v151, v39, v39, v151
    s_waitcnt lgkmcnt(8)
    v_dot2_f32_bf16 v140, v40, v44, v140
    v_dot2_f32_bf16 v141, v40, v40, v141
    v_dot2_f32_bf16 v150, v41, v44, v150
    v_dot2_f32_bf16 v151, v41, v41, v151
    v_dot2_f32_bf16 v140, v42, v44, v140
    v_dot2_f32_bf16 v141, v42, v42, v141
    v_dot2_f32_bf16 v150, v43, v44, v150
    v_dot2_f32_bf16 v151, v43, v43, v151
    s_waitcnt lgkmcnt(0)
    s_cmp_eq_u32 s72, 1
    s_cbranch_scc1 ob45
or46:
    s_lshl_b32 s44, s64, 7
    s_add_u32 s44, s44, 22085632
    buffer_load_dword v6, off, s[8:11], s44 sc1
    s_barrier
    v_add_f32 v28, v140, v150
    v_add_f32 v29, v141, v151
    v_mov_b32 v30, v28
    v_mov_b32 v31, v29
    s_waitcnt vmcnt(1)
    s_barrier
    s_lshl_b32 s40, s18, 15
    v_add_u32 v153, s40, v3
    ds_read_b64_tr_b16 v[112:113], v153 offset:0
    ds_read_b64_tr_b16 v[114:115], v153 offset:512
    ds_read_b64_tr_b16 v[116:117], v153 offset:1024
    ds_read_b64_tr_b16 v[118:119], v153 offset:1536
    ds_read_b64_tr_b16 v[120:121], v153 offset:2048
    ds_read_b64_tr_b16 v[122:123], v153 offset:2560
    ds_read_b64_tr_b16 v[124:125], v153 offset:3072
    ds_read_b64_tr_b16 v[126:127], v153 offset:3584
    s_waitcnt lgkmcnt(4)
    v_mfma_f32_32x32x16_bf16 v[80:95], v[44:47], v[112:115], 0
    ds_read_b64_tr_b16 v[128:129], v153 offset:4096
    ds_read_b64_tr_b16 v[130:131], v153 offset:4608
    v_mov_b32 v18, 0
    v_mov_b32 v19, 0
    v_permlane32_swap_b32 v28, v30
    v_mfma_f32_32x32x16_bf16 v[80:95], v[44:47], v[116:119], v[80:95]
    ds_read_b64_tr_b16 v[112:113], v153 offset:5120
    ds_read_b64_tr_b16 v[114:115], v153 offset:5632
    v_permlane32_swap_b32 v29, v31
    v_mov_b32 v32, 0
    v_add_f32 v28, v28, v30
    s_waitcnt lgkmcnt(4)
    v_mfma_f32_32x32x16_bf16 v[80:95], v[44:47], v[120:123], v[80:95]
    ds_read_b64_tr_b16 v[116:117], v153 offset:6144
    ds_read_b64_tr_b16 v[118:119], v153 offset:6656
    v_add_f32 v29, v29, v31
    v_mul_f32 v28, 0x3b000000, v28
    v_mul_f32 v29, 0x3b000000, v29
    v_mfma_f32_32x32x16_bf16 v[80:95], v[44:47], v[124:127], v[80:95]
    ds_read_b64_tr_b16 v[120:121], v153 offset:7168
    ds_read_b64_tr_b16 v[122:123], v153 offset:7680
    v_fma_f32 v29, -v28, v28, v29
    v_cvt_pk_bf16_f32 v16, v28, v28
    v_max_f32 v29, 0, v29
    s_waitcnt lgkmcnt(4)
    v_mfma_f32_32x32x16_bf16 v[80:95], v[44:47], v[128:131], v[80:95]
    ds_read_b64_tr_b16 v[124:125], v153 offset:8192
    ds_read_b64_tr_b16 v[126:127], v153 offset:8704
    v_and_b32 v30, 0xffff0000, v16
    v_add_f32 v27, 0x3727c5ac, v29
    v_sub_f32 v30, v28, v30
    v_mfma_f32_32x32x16_bf16 v[80:95], v[44:47], v[112:115], v[80:95]
    ds_read_b64_tr_b16 v[128:129], v153 offset:9216
    ds_read_b64_tr_b16 v[130:131], v153 offset:9728
    v_rsq_f32 v24, v27
    v_cvt_pk_bf16_f32 v17, v30, v32
    v_cndmask_b32_e64 v16, v16, 0, s[32:33]
    s_waitcnt lgkmcnt(4)
    v_mfma_f32_32x32x16_bf16 v[80:95], v[44:47], v[116:119], v[80:95]
    ds_read_b64_tr_b16 v[112:113], v153 offset:10240
    ds_read_b64_tr_b16 v[114:115], v153 offset:10752
    v_cndmask_b32_e64 v17, v17, 0, s[32:33]
    v_mfma_f32_32x32x16_bf16 v[80:95], v[44:47], v[120:123], v[80:95]
    ds_read_b64_tr_b16 v[116:117], v153 offset:11264
    ds_read_b64_tr_b16 v[118:119], v153 offset:11776
    s_waitcnt lgkmcnt(4)
    v_mfma_f32_32x32x16_bf16 v[80:95], v[44:47], v[124:127], v[80:95]
    ds_read_b64_tr_b16 v[120:121], v153 offset:12288
    ds_read_b64_tr_b16 v[122:123], v153 offset:12800
    v_mfma_f32_32x32x16_bf16 v[80:95], v[44:47], v[128:131], v[80:95]
    ds_read_b64_tr_b16 v[124:125], v153 offset:13312
    ds_read_b64_tr_b16 v[126:127], v153 offset:13824
    s_waitcnt lgkmcnt(4)
    v_mfma_f32_32x32x16_bf16 v[80:95], v[44:47], v[112:115], v[80:95]
    ds_read_b64_tr_b16 v[128:129], v153 offset:14336
    ds_read_b64_tr_b16 v[130:131], v153 offset:14848
    v_mfma_f32_32x32x16_bf16 v[80:95], v[44:47], v[116:119], v[80:95]
    ds_read_b64_tr_b16 v[112:113], v153 offset:15360
    ds_read_b64_tr_b16 v[114:115], v153 offset:15872
    s_waitcnt lgkmcnt(4)
    v_mfma_f32_32x32x16_bf16 v[80:95], v[44:47], v[120:123], v[80:95]
    ds_read_b64_tr_b16 v[116:117], v153 offset:16384
    ds_read_b64_tr_b16 v[118:119], v153 offset:16896
    v_mfma_f32_32x32x16_bf16 v[80:95], v[44:47], v[124:127], v[80:95]
    ds_read_b64_tr_b16 v[120:121], v153 offset:17408
    ds_read_b64_tr_b16 v[122:123], v153 offset:17920
    s_waitcnt lgkmcnt(4)
    v_mfma_f32_32x32x16_bf16 v[80:95], v[44:47], v[128:131], v[80:95]
    ds_read_b64_tr_b16 v[124:125], v153 offset:18432
    ds_read_b64_tr_b16 v[126:127], v153 offset:18944
    v_mfma_f32_32x32x16_bf16 v[80:95], v[44:47], v[112:115], v[80:95]
    ds_read_b64_tr_b16 v[128:129], v153 offset:19456
    ds_read_b64_tr_b16 v[130:131], v153 offset:19968
    s_waitcnt lgkmcnt(4)
    v_mfma_f32_32x32x16_bf16 v[80:95], v[44:47], v[116:119], v[80:95]
    ds_read_b64_tr_b16 v[112:113], v153 offset:20480
    ds_read_b64_tr_b16 v[114:115], v153 offset:20992
    v_mfma_f32_32x32x16_bf16 v[80:95], v[44:47], v[120:123], v[80:95]
    ds_read_b64_tr_b16 v[116:117], v153 offset:21504
    ds_read_b64_tr_b16 v[118:119], v153 offset:22016
    s_waitcnt lgkmcnt(4)
    v_mfma_f32_32x32x16_bf16 v[80:95], v[44:47], v[124:127], v[80:95]
    ds_read_b64_tr_b16 v[120:121], v153 offset:22528
    ds_read_b64_tr_b16 v[122:123], v153 offset:23040
    v_mfma_f32_32x32x16_bf16 v[80:95], v[44:47], v[128:131], v[80:95]
    ds_read_b64_tr_b16 v[124:125], v153 offset:23552
    ds_read_b64_tr_b16 v[126:127], v153 offset:24064
    s_waitcnt lgkmcnt(4)
    v_mfma_f32_32x32x16_bf16 v[80:95], v[44:47], v[112:115], v[80:95]
    ds_read_b64_tr_b16 v[128:129], v153 offset:24576
    ds_read_b64_tr_b16 v[130:131], v153 offset:25088
    v_mfma_f32_32x32x16_bf16 v[80:95], v[44:47], v[116:119], v[80:95]
    ds_read_b64_tr_b16 v[112:113], v153 offset:25600
    ds_read_b64_tr_b16 v[114:115], v153 offset:26112
    s_waitcnt lgkmcnt(4)
    v_mfma_f32_32x32x16_bf16 v[80:95], v[44:47], v[120:123], v[80:95]
    ds_read_b64_tr_b16 v[116:117], v153 offset:26624
    ds_read_b64_tr_b16 v[118:119], v153 offset:27136
    v_mfma_f32_32x32x16_bf16 v[80:95], v[44:47], v[124:127], v[80:95]
    ds_read_b64_tr_b16 v[120:121], v153 offset:27648
    ds_read_b64_tr_b16 v[122:123], v153 offset:28160
    s_waitcnt lgkmcnt(4)
    v_mfma_f32_32x32x16_bf16 v[80:95], v[44:47], v[128:131], v[80:95]
    ds_read_b64_tr_b16 v[124:125], v153 offset:28672
    ds_read_b64_tr_b16 v[126:127], v153 offset:29184
    v_mfma_f32_32x32x16_bf16 v[80:95], v[44:47], v[112:115], v[80:95]
    ds_read_b64_tr_b16 v[128:129], v153 offset:29696
    ds_read_b64_tr_b16 v[130:131], v153 offset:30208
    s_waitcnt lgkmcnt(4)
    v_mfma_f32_32x32x16_bf16 v[80:95], v[44:47], v[116:119], v[80:95]
    ds_read_b64_tr_b16 v[112:113], v153 offset:30720
    ds_read_b64_tr_b16 v[114:115], v153 offset:31232
    v_mfma_f32_32x32x16_bf16 v[80:95], v[44:47], v[120:123], v[80:95]
    ds_read_b64_tr_b16 v[116:117], v153 offset:31744
    ds_read_b64_tr_b16 v[118:119], v153 offset:32256
    s_waitcnt lgkmcnt(4)
    v_mfma_f32_32x32x16_bf16 v[80:95], v[44:47], v[124:127], v[80:95]
    v_mfma_f32_32x32x16_bf16 v[80:95], v[44:47], v[128:131], v[80:95]
    s_waitcnt lgkmcnt(0)
    v_mfma_f32_32x32x16_bf16 v[80:95], v[44:47], v[112:115], v[80:95]
    v_mfma_f32_32x32x16_bf16 v[80:95], v[44:47], v[116:119], v[80:95]
    s_nop 11
    v_sub_f32 v39, 0, v80
    v_cvt_pk_bf16_f32 v38, v39, v39
    v_and_b32 v38, 0xffff0000, v38
    v_sub_f32 v39, v39, v38
    v_cvt_pk_bf16_f32 v36, v38, v39
    v_mov_b32 v39, 0
    v_cvt_pk_bf16_f32 v37, v38, v39
    v_cndmask_b32_e64 v36, v36, 0, s[32:33]
    v_cndmask_b32_e64 v37, v37, 0, s[32:33]
    v_mov_b32 v38, 0
    s_cmp_eq_u32 s18, 3
    s_cbranch_scc1 xw48
    s_lshl_b32 s40, s18, 10
    v_add_u32 v40, s40, v1
    ds_write_b128 v40, v[36:39] offset:32768
xw48:
    s_waitcnt lgkmcnt(0)
    s_barrier
    ds_read_b64_tr_b16 v[112:113], v3 offset:0
    ds_read_b64_tr_b16 v[114:115], v3 offset:512
    ds_read_b64_tr_b16 v[116:117], v3 offset:32768
    ds_read_b64_tr_b16 v[118:119], v3 offset:33280
    ds_read_b64_tr_b16 v[120:121], v3 offset:1024
    ds_read_b64_tr_b16 v[122:123], v3 offset:1536
    ds_read_b64_tr_b16 v[124:125], v3 offset:33792
    ds_read_b64_tr_b16 v[126:127], v3 offset:34304
    s_waitcnt lgkmcnt(4)
    v_mfma_f32_32x32x16_bf16 v[48:63], a[0:3], v[112:115], 0
    ds_read_b64_tr_b16 v[128:129], v3 offset:2048
    ds_read_b64_tr_b16 v[130:131], v3 offset:2560
    v_mul_f32 v32, 0x3fb8aa3b, v24
    ds_write_b32 v21, v32
    s_waitcnt lgkmcnt(0)
    v_mfma_f32_32x32x16_bf16 v[64:79], a[0:3], v[116:119], 0
    ds_read_b64_tr_b16 v[112:113], v3 offset:34816
    ds_read_b64_tr_b16 v[114:115], v3 offset:35328
    ds_read_b128 v[80:83], v20 offset:0
    ds_read_b128 v[84:87], v20 offset:32
    ds_read_b128 v[88:91], v20 offset:64
    v_mfma_f32_32x32x16_bf16 v[48:63], a[4:7], v[120:123], v[48:63]
    ds_read_b64_tr_b16 v[116:117], v3 offset:3072
    ds_read_b64_tr_b16 v[118:119], v3 offset:3584
    ds_read_b128 v[92:95], v20 offset:96
    s_waitcnt vmcnt(0)
    v_cmp_eq_u32 vcc, 0, v6
    s_cbranch_vccnz ob50
or51:
    v_readfirstlane_b32 s71, v6
    s_nop 0
    s_sub_u32 s71, s71, 1
    v_mfma_f32_32x32x16_bf16 v[64:79], a[4:7], v[124:127], v[64:79]
    ds_read_b64_tr_b16 v[120:121], v3 offset:35840
    ds_read_b64_tr_b16 v[122:123], v3 offset:36352
    s_bitcmp1_b32 s16, 0
    s_cbranch_scc1 po52
    s_add_u32 m0, s60, 0
    s_add_u32 s42, s61, 101376
    buffer_load_dwordx4 v0, s[8:11], s42 offen offset:0 lds
    buffer_load_dwordx4 v0, s[8:11], s42 offen offset:1024 lds
    buffer_load_dwordx4 v0, s[8:11], s42 offen offset:2048 lds
    buffer_load_dwordx4 v0, s[8:11], s42 offen offset:3072 lds
    s_add_u32 m0, s60, 4096
    s_add_u32 s42, s61, 105472
    buffer_load_dwordx4 v0, s[8:11], s42 offen offset:0 lds
    buffer_load_dwordx4 v0, s[8:11], s42 offen offset:1024 lds
    buffer_load_dwordx4 v0, s[8:11], s42 offen offset:2048 lds
    buffer_load_dwordx4 v0, s[8:11], s42 offen offset:3072 lds
    s_lshl_b32 s43, s18, 12
    s_add_u32 s44, s43, 134144
    s_add_u32 s45, s43, s26
    s_add_u32 m0, s44, 0
    s_add_u32 s42, s45, 134144
    buffer_load_dwordx4 v0, s[8:11], s42 offen offset:0 lds
    buffer_load_dwordx4 v0, s[8:11], s42 offen offset:1024 lds
    buffer_load_dwordx4 v0, s[8:11], s42 offen offset:2048 lds
    buffer_load_dwordx4 v0, s[8:11], s42 offen offset:3072 lds
    s_branch pd53
po52:
    s_lshl_b32 s43, s18, 12
    s_add_u32 s44, s43, 134144
    s_add_u32 s45, s43, s26
    s_add_u32 m0, s44, 0
    s_add_u32 s42, s45, 134144
    buffer_load_dwordx4 v0, s[8:11], s42 offen offset:0 lds
    buffer_load_dwordx4 v0, s[8:11], s42 offen offset:1024 lds
    buffer_load_dwordx4 v0, s[8:11], s42 offen offset:2048 lds
    buffer_load_dwordx4 v0, s[8:11], s42 offen offset:3072 lds
    s_add_u32 m0, s60, 0
    s_add_u32 s42, s61, 101376
    buffer_load_dwordx4 v0, s[8:11], s42 offen offset:0 lds
    buffer_load_dwordx4 v0, s[8:11], s42 offen offset:1024 lds
    buffer_load_dwordx4 v0, s[8:11], s42 offen offset:2048 lds
    buffer_load_dwordx4 v0, s[8:11], s42 offen offset:3072 lds
    s_add_u32 m0, s60, 4096
    s_add_u32 s42, s61, 105472
    buffer_load_dwordx4 v0, s[8:11], s42 offen offset:0 lds
    buffer_load_dwordx4 v0, s[8:11], s42 offen offset:1024 lds
    buffer_load_dwordx4 v0, s[8:11], s42 offen offset:2048 lds
    buffer_load_dwordx4 v0, s[8:11], s42 offen offset:3072 lds
pd53:
    v_mfma_f32_32x32x16_bf16 v[48:63], a[8:11], v[128:131], v[48:63]
    ds_read_b64_tr_b16 v[124:125], v3 offset:4096
    ds_read_b64_tr_b16 v[126:127], v3 offset:4608
    s_waitcnt lgkmcnt(5)
    v_mfma_f32_32x32x16_bf16 v[64:79], a[8:11], v[112:115], v[64:79]
    ds_read_b64_tr_b16 v[128:129], v3 offset:36864
    ds_read_b64_tr_b16 v[130:131], v3 offset:37376
    v_mfma_f32_32x32x16_bf16 v[48:63], a[12:15], v[116:119], v[48:63]
    ds_read_b64_tr_b16 v[112:113], v3 offset:5120
    ds_read_b64_tr_b16 v[114:115], v3 offset:5632
    s_waitcnt lgkmcnt(4)
    v_mfma_f32_32x32x16_bf16 v[64:79], a[12:15], v[120:123], v[64:79]
    ds_read_b64_tr_b16 v[116:117], v3 offset:37888
    ds_read_b64_tr_b16 v[118:119], v3 offset:38400
    s_bitcmp1_b32 s16, 0
    s_cbranch_scc1 po54
    v_and_b32 v244, 0xf0, v0
    v_lshlrev_b32 v244, 3, v244
    s_lshl_b32 s49, s17, 11
    s_add_u32 s48, s49, s21
    s_mov_b64 exec, 0xffff
    buffer_load_dword v246, v244, s[8:11], s48 offen
    s_add_u32 s48, s49, s20
    buffer_load_dword v246, v244, s[8:11], s48 offen
    s_mov_b64 exec, 15
    buffer_load_dword v246, v244, s[8:11], s73 offen
    s_mov_b64 exec, -1
    s_branch pd55
po54:
    v_and_b32 v244, 0xf0, v0
    v_lshlrev_b32 v244, 3, v244
    s_lshl_b32 s49, s17, 11
    s_add_u32 s48, s49, s21
    s_mov_b64 exec, 0xffff
    buffer_load_dword v246, v244, s[8:11], s48 offen
    s_add_u32 s48, s49, s20
    buffer_load_dword v246, v244, s[8:11], s48 offen
    s_mov_b64 exec, 15
    buffer_load_dword v246, v244, s[8:11], s73 offen
    s_mov_b64 exec, -1
pd55:
    v_mfma_f32_32x32x16_bf16 v[48:63], a[16:19], v[124:127], v[48:63]
    ds_read_b64_tr_b16 v[120:121], v3 offset:6144
    ds_read_b64_tr_b16 v[122:123], v3 offset:6656
    s_waitcnt lgkmcnt(4)
    v_mfma_f32_32x32x16_bf16 v[64:79], a[16:19], v[128:131], v[64:79]
    ds_read_b64_tr_b16 v[124:125], v3 offset:38912
    ds_read_b64_tr_b16 v[126:127], v3 offset:39424
    v_mfma_f32_32x32x16_bf16 v[48:63], a[20:23], v[112:115], v[48:63]
    ds_read_b64_tr_b16 v[128:129], v3 offset:7168
    ds_read_b64_tr_b16 v[130:131], v3 offset:7680
    s_waitcnt lgkmcnt(4)
    v_mfma_f32_32x32x16_bf16 v[64:79], a[20:23], v[116:119], v[64:79]
    ds_read_b64_tr_b16 v[112:113], v3 offset:39936
    ds_read_b64_tr_b16 v[114:115], v3 offset:40448
    s_bitcmp1_b32 s16, 0
    s_cbranch_scc1 po56
    s_cmp_eq_u32 s18, 0
    s_cbranch_scc0 cs58
    s_mul_i32 s40, s17, 36864
    s_add_u32 s40, s40, 7352320
    buffer_load_dwordx4 v[196:199], v0, s[8:11], s40 offen offset:0
    buffer_load_dwordx4 v[200:203], v0, s[8:11], s40 offen offset:1024
    buffer_load_dwordx4 v[204:207], v0, s[8:11], s40 offen offset:2048
    buffer_load_dwordx4 v[208:211], v0, s[8:11], s40 offen offset:3072
cs58:
    s_branch pd57
po56:
    s_cmp_eq_u32 s18, 3
    s_cbranch_scc0 cs59
    s_mul_i32 s40, s17, 36864
    s_add_u32 s40, s40, 7364608
    buffer_load_dwordx4 v[196:199], v0, s[8:11], s40 offen offset:0
    buffer_load_dwordx4 v[200:203], v0, s[8:11], s40 offen offset:1024
    buffer_load_dwordx4 v[204:207], v0, s[8:11], s40 offen offset:2048
    buffer_load_dwordx4 v[208:211], v0, s[8:11], s40 offen offset:3072
cs59:
pd57:
    v_mfma_f32_32x32x16_bf16 v[48:63], a[24:27], v[120:123], v[48:63]
    ds_read_b64_tr_b16 v[116:117], v3 offset:8192
    ds_read_b64_tr_b16 v[118:119], v3 offset:8704
    s_waitcnt lgkmcnt(4)
    v_mfma_f32_32x32x16_bf16 v[64:79], a[24:27], v[124:127], v[64:79]
    ds_read_b64_tr_b16 v[120:121], v3 offset:40960
    ds_read_b64_tr_b16 v[122:123], v3 offset:41472
    v_mfma_f32_32x32x16_bf16 v[48:63], a[28:31], v[128:131], v[48:63]
    ds_read_b64_tr_b16 v[124:125], v3 offset:9216
    ds_read_b64_tr_b16 v[126:127], v3 offset:9728
    s_waitcnt lgkmcnt(4)
    v_mfma_f32_32x32x16_bf16 v[64:79], a[28:31], v[112:115], v[64:79]
    ds_read_b64_tr_b16 v[128:129], v3 offset:41984
    ds_read_b64_tr_b16 v[130:131], v3 offset:42496
    s_bitcmp1_b32 s16, 0
    s_cbranch_scc1 po60
    s_cmp_eq_u32 s18, 1
    s_cbranch_scc0 cs62
    s_mul_i32 s40, s17, 36864
    s_add_u32 s40, s40, 7356416
    buffer_load_dwordx4 v[196:199], v0, s[8:11], s40 offen offset:0
    buffer_load_dwordx4 v[200:203], v0, s[8:11], s40 offen offset:1024
    buffer_load_dwordx4 v[204:207], v0, s[8:11], s40 offen offset:2048
    buffer_load_dwordx4 v[208:211], v0, s[8:11], s40 offen offset:3072
cs62:
    s_branch pd61
po60:
    s_cmp_eq_u32 s18, 3
    s_cbranch_scc0 cs63
    s_mul_i32 s40, s17, 36864
    s_add_u32 s40, s40, 7368704
    buffer_load_dwordx4 v[212:215], v0, s[8:11], s40 offen offset:0
    buffer_load_dwordx4 v[216:219], v0, s[8:11], s40 offen offset:1024
    buffer_load_dwordx4 v[220:223], v0, s[8:11], s40 offen offset:2048
    buffer_load_dwordx4 v[224:227], v0, s[8:11], s40 offen offset:3072
cs63:
pd61:
    v_mfma_f32_32x32x16_bf16 v[48:63], a[32:35], v[116:119], v[48:63]
    ds_read_b64_tr_b16 v[112:113], v3 offset:10240
    ds_read_b64_tr_b16 v[114:115], v3 offset:10752
    s_waitcnt lgkmcnt(4)
    v_mfma_f32_32x32x16_bf16 v[64:79], a[32:35], v[120:123], v[64:79]
    ds_read_b64_tr_b16 v[116:117], v3 offset:43008
    ds_read_b64_tr_b16 v[118:119], v3 offset:43520
    v_mfma_f32_32x32x16_bf16 v[48:63], a[36:39], v[124:127], v[48:63]
    ds_read_b64_tr_b16 v[120:121], v3 offset:11264
    ds_read_b64_tr_b16 v[122:123], v3 offset:11776
    s_waitcnt lgkmcnt(4)
    v_mfma_f32_32x32x16_bf16 v[64:79], a[36:39], v[128:131], v[64:79]
    ds_read_b64_tr_b16 v[124:125], v3 offset:44032
    ds_read_b64_tr_b16 v[126:127], v3 offset:44544
    s_bitcmp1_b32 s16, 0
    s_cbranch_scc1 po64
    s_cmp_eq_u32 s18, 2
    s_cbranch_scc0 cs66
    s_mul_i32 s40, s17, 36864
    s_add_u32 s40, s40, 7360512
    buffer_load_dwordx4 v[196:199], v0, s[8:11], s40 offen offset:0
    buffer_load_dwordx4 v[200:203], v0, s[8:11], s40 offen offset:1024
    buffer_load_dwordx4 v[204:207], v0, s[8:11], s40 offen offset:2048
    buffer_load_dwordx4 v[208:211], v0, s[8:11], s40 offen offset:3072
cs66:
    s_branch pd65
po64:
    s_cmp_eq_u32 s18, 1
    s_cbranch_scc0 cs67
    s_mul_i32 s40, s17, 36864
    s_add_u32 s40, s40, 7372800
    buffer_load_dwordx4 v[212:215], v0, s[8:11], s40 offen offset:0
    buffer_load_dwordx4 v[216:219], v0, s[8:11], s40 offen offset:1024
    buffer_load_dwordx4 v[220:223], v0, s[8:11], s40 offen offset:2048
    buffer_load_dwordx4 v[224:227], v0, s[8:11], s40 offen offset:3072
cs67:
pd65:
    v_mfma_f32_32x32x16_bf16 v[48:63], a[40:43], v[112:115], v[48:63]
    ds_read_b64_tr_b16 v[128:129], v3 offset:12288
    ds_read_b64_tr_b16 v[130:131], v3 offset:12800
    s_waitcnt lgkmcnt(4)
    v_mfma_f32_32x32x16_bf16 v[64:79], a[40:43], v[116:119], v[64:79]
    ds_read_b64_tr_b16 v[112:113], v3 offset:45056
    ds_read_b64_tr_b16 v[114:115], v3 offset:45568
    v_mfma_f32_32x32x16_bf16 v[48:63], a[44:47], v[120:123], v[48:63]
    ds_read_b64_tr_b16 v[116:117], v3 offset:13312
    ds_read_b64_tr_b16 v[118:119], v3 offset:13824
    s_waitcnt lgkmcnt(4)
    v_mfma_f32_32x32x16_bf16 v[64:79], a[44:47], v[124:127], v[64:79]
    ds_read_b64_tr_b16 v[120:121], v3 offset:46080
    ds_read_b64_tr_b16 v[122:123], v3 offset:46592
    s_bitcmp1_b32 s16, 0
    s_cbranch_scc1 po68
    s_cmp_eq_u32 s18, 3
    s_cbranch_scc0 cs70
    s_mul_i32 s40, s17, 36864
    s_add_u32 s40, s40, 7364608
    buffer_load_dwordx4 v[196:199], v0, s[8:11], s40 offen offset:0
    buffer_load_dwordx4 v[200:203], v0, s[8:11], s40 offen offset:1024
    buffer_load_dwordx4 v[204:207], v0, s[8:11], s40 offen offset:2048
    buffer_load_dwordx4 v[208:211], v0, s[8:11], s40 offen offset:3072
cs70:
    s_branch pd69
po68:
    s_cmp_eq_u32 s18, 0
    s_cbranch_scc0 cs71
    s_mul_i32 s40, s17, 36864
    s_add_u32 s40, s40, 7352320
    buffer_load_dwordx4 v[196:199], v0, s[8:11], s40 offen offset:0
    buffer_load_dwordx4 v[200:203], v0, s[8:11], s40 offen offset:1024
    buffer_load_dwordx4 v[204:207], v0, s[8:11], s40 offen offset:2048
    buffer_load_dwordx4 v[208:211], v0, s[8:11], s40 offen offset:3072
cs71:
pd69:
    v_mfma_f32_32x32x16_bf16 v[48:63], a[48:51], v[128:131], v[48:63]
    ds_read_b64_tr_b16 v[124:125], v3 offset:14336
    ds_read_b64_tr_b16 v[126:127], v3 offset:14848
    s_waitcnt lgkmcnt(4)
    v_mfma_f32_32x32x16_bf16 v[64:79], a[48:51], v[112:115], v[64:79]
    ds_read_b64_tr_b16 v[128:129], v3 offset:47104
    ds_read_b64_tr_b16 v[130:131], v3 offset:47616
    v_mfma_f32_32x32x16_bf16 v[48:63], a[52:55], v[116:119], v[48:63]
    ds_read_b64_tr_b16 v[112:113], v3 offset:15360
    ds_read_b64_tr_b16 v[114:115], v3 offset:15872
    s_waitcnt lgkmcnt(4)
    v_mfma_f32_32x32x16_bf16 v[64:79], a[52:55], v[120:123], v[64:79]
    ds_read_b64_tr_b16 v[116:117], v3 offset:48128
    ds_read_b64_tr_b16 v[118:119], v3 offset:48640
    s_bitcmp1_b32 s16, 0
    s_cbranch_scc1 po72
    s_cmp_eq_u32 s18, 3
    s_cbranch_scc0 cs74
    s_mul_i32 s40, s17, 36864
    s_add_u32 s40, s40, 7368704
    buffer_load_dwordx4 v[212:215], v0, s[8:11], s40 offen offset:0
    buffer_load_dwordx4 v[216:219], v0, s[8:11], s40 offen offset:1024
    buffer_load_dwordx4 v[220:223], v0, s[8:11], s40 offen offset:2048
    buffer_load_dwordx4 v[224:227], v0, s[8:11], s40 offen offset:3072
cs74:
    s_branch pd73
po72:
    s_cmp_eq_u32 s18, 1
    s_cbranch_scc0 cs75
    s_mul_i32 s40, s17, 36864
    s_add_u32 s40, s40, 7356416
    buffer_load_dwordx4 v[196:199], v0, s[8:11], s40 offen offset:0
    buffer_load_dwordx4 v[200:203], v0, s[8:11], s40 offen offset:1024
    buffer_load_dwordx4 v[204:207], v0, s[8:11], s40 offen offset:2048
    buffer_load_dwordx4 v[208:211], v0, s[8:11], s40 offen offset:3072
cs75:
pd73:
    v_mfma_f32_32x32x16_bf16 v[48:63], a[56:59], v[124:127], v[48:63]
    ds_read_b64_tr_b16 v[120:121], v3 offset:16384
    ds_read_b64_tr_b16 v[122:123], v3 offset:16896
    s_waitcnt lgkmcnt(4)
    v_mfma_f32_32x32x16_bf16 v[64:79], a[56:59], v[128:131], v[64:79]
    ds_read_b64_tr_b16 v[124:125], v3 offset:49152
    ds_read_b64_tr_b16 v[126:127], v3 offset:49664
    v_mfma_f32_32x32x16_bf16 v[48:63], a[60:63], v[112:115], v[48:63]
    ds_read_b64_tr_b16 v[128:129], v3 offset:17408
    ds_read_b64_tr_b16 v[130:131], v3 offset:17920
    s_waitcnt lgkmcnt(4)
    v_mfma_f32_32x32x16_bf16 v[64:79], a[60:63], v[116:119], v[64:79]
    ds_read_b64_tr_b16 v[112:113], v3 offset:50176
    ds_read_b64_tr_b16 v[114:115], v3 offset:50688
    s_bitcmp1_b32 s16, 0
    s_cbranch_scc1 po76
    s_cmp_eq_u32 s18, 1
    s_cbranch_scc0 cs78
    s_mul_i32 s40, s17, 36864
    s_add_u32 s40, s40, 7372800
    buffer_load_dwordx4 v[212:215], v0, s[8:11], s40 offen offset:0
    buffer_load_dwordx4 v[216:219], v0, s[8:11], s40 offen offset:1024
    buffer_load_dwordx4 v[220:223], v0, s[8:11], s40 offen offset:2048
    buffer_load_dwordx4 v[224:227], v0, s[8:11], s40 offen offset:3072
cs78:
    s_branch pd77
po76:
    s_cmp_eq_u32 s18, 2
    s_cbranch_scc0 cs79
    s_mul_i32 s40, s17, 36864
    s_add_u32 s40, s40, 7360512
    buffer_load_dwordx4 v[196:199], v0, s[8:11], s40 offen offset:0
    buffer_load_dwordx4 v[200:203], v0, s[8:11], s40 offen offset:1024
    buffer_load_dwordx4 v[204:207], v0, s[8:11], s40 offen offset:2048
    buffer_load_dwordx4 v[208:211], v0, s[8:11], s40 offen offset:3072
cs79:
pd77:
    v_mfma_f32_32x32x16_bf16 v[48:63], a[64:67], v[120:123], v[48:63]
    ds_read_b64_tr_b16 v[116:117], v3 offset:18432
    ds_read_b64_tr_b16 v[118:119], v3 offset:18944
    s_waitcnt lgkmcnt(4)
    v_mfma_f32_32x32x16_bf16 v[64:79], a[64:67], v[124:127], v[64:79]
    ds_read_b64_tr_b16 v[120:121], v3 offset:51200
    ds_read_b64_tr_b16 v[122:123], v3 offset:51712
    v_mfma_f32_32x32x16_bf16 v[48:63], a[68:71], v[128:131], v[48:63]
    ds_read_b64_tr_b16 v[124:125], v3 offset:19456
    ds_read_b64_tr_b16 v[126:127], v3 offset:19968
    s_waitcnt lgkmcnt(4)
    v_mfma_f32_32x32x16_bf16 v[64:79], a[68:71], v[112:115], v[64:79]
    ds_read_b64_tr_b16 v[128:129], v3 offset:52224
    ds_read_b64_tr_b16 v[130:131], v3 offset:52736
    s_bitcmp1_b32 s16, 0
    s_cbranch_scc1 po80
    s_add_u32 s49, s65, 0
    buffer_load_dwordx4 a[128:131], v0, s[8:11], s49 offen
    s_branch pd81
po80:
    s_add_u32 s49, s65, 16384
    buffer_load_dwordx4 a[144:147], v0, s[8:11], s49 offen
pd81:
    v_mfma_f32_32x32x16_bf16 v[48:63], a[72:75], v[116:119], v[48:63]
    ds_read_b64_tr_b16 v[112:113], v3 offset:20480
    ds_read_b64_tr_b16 v[114:115], v3 offset:20992
    s_waitcnt lgkmcnt(4)
    v_mfma_f32_32x32x16_bf16 v[64:79], a[72:75], v[120:123], v[64:79]
    ds_read_b64_tr_b16 v[116:117], v3 offset:53248
    ds_read_b64_tr_b16 v[118:119], v3 offset:53760
    v_mfma_f32_32x32x16_bf16 v[48:63], a[76:79], v[124:127], v[48:63]
    ds_read_b64_tr_b16 v[120:121], v3 offset:21504
    ds_read_b64_tr_b16 v[122:123], v3 offset:22016
    s_waitcnt lgkmcnt(4)
    v_mfma_f32_32x32x16_bf16 v[64:79], a[76:79], v[128:131], v[64:79]
    ds_read_b64_tr_b16 v[124:125], v3 offset:54272
    ds_read_b64_tr_b16 v[126:127], v3 offset:54784
    s_bitcmp1_b32 s16, 0
    s_cbranch_scc1 po82
    s_cmp_eq_u32 s18, 0
    s_cbranch_scc1 bo84
    s_cmp_eq_u32 s18, 1
    s_cbranch_scc1 bo84
    s_add_u32 s49, s65, 4096
    buffer_load_dwordx4 a[132:135], v0, s[8:11], s49 offen
bo84:
    s_branch pd83
po82:
    s_add_u32 s49, s65, 20480
    buffer_load_dwordx4 a[148:151], v0, s[8:11], s49 offen
pd83:
    v_mfma_f32_32x32x16_bf16 v[48:63], a[80:83], v[112:115], v[48:63]
    ds_read_b64_tr_b16 v[128:129], v3 offset:22528
    ds_read_b64_tr_b16 v[130:131], v3 offset:23040
    s_waitcnt lgkmcnt(4)
    v_mfma_f32_32x32x16_bf16 v[64:79], a[80:83], v[116:119], v[64:79]
    ds_read_b64_tr_b16 v[112:113], v3 offset:55296
    ds_read_b64_tr_b16 v[114:115], v3 offset:55808
    v_mfma_f32_32x32x16_bf16 v[48:63], a[84:87], v[120:123], v[48:63]
    ds_read_b64_tr_b16 v[116:117], v3 offset:23552
    ds_read_b64_tr_b16 v[118:119], v3 offset:24064
    s_waitcnt lgkmcnt(4)
    v_mfma_f32_32x32x16_bf16 v[64:79], a[84:87], v[124:127], v[64:79]
    ds_read_b64_tr_b16 v[120:121], v3 offset:56320
    ds_read_b64_tr_b16 v[122:123], v3 offset:56832
    s_bitcmp1_b32 s16, 0
    s_cbranch_scc1 po85
    s_add_u32 s49, s65, 8192
    buffer_load_dwordx4 a[136:139], v0, s[8:11], s49 offen
    s_branch pd86
po85:
    s_add_u32 s49, s65, 24576
    buffer_load_dwordx4 a[152:155], v0, s[8:11], s49 offen
pd86:
    v_mfma_f32_32x32x16_bf16 v[48:63], a[88:91], v[128:131], v[48:63]
    ds_read_b64_tr_b16 v[124:125], v3 offset:24576
    ds_read_b64_tr_b16 v[126:127], v3 offset:25088
    s_waitcnt lgkmcnt(4)
    v_mfma_f32_32x32x16_bf16 v[64:79], a[88:91], v[112:115], v[64:79]
    ds_read_b64_tr_b16 v[128:129], v3 offset:57344
    ds_read_b64_tr_b16 v[130:131], v3 offset:57856
    v_mfma_f32_32x32x16_bf16 v[48:63], a[92:95], v[116:119], v[48:63]
    ds_read_b64_tr_b16 v[112:113], v3 offset:25600
    ds_read_b64_tr_b16 v[114:115], v3 offset:26112
    s_waitcnt lgkmcnt(4)
    v_mfma_f32_32x32x16_bf16 v[64:79], a[92:95], v[120:123], v[64:79]
    ds_read_b64_tr_b16 v[116:117], v3 offset:58368
    ds_read_b64_tr_b16 v[118:119], v3 offset:58880
    s_bitcmp1_b32 s16, 0
    s_cbranch_scc1 po87
    s_add_u32 s49, s65, 12288
    buffer_load_dwordx4 a[140:143], v0, s[8:11], s49 offen
    s_branch pd88
po87:
    s_add_u32 s49, s65, 28672
    buffer_load_dwordx4 a[156:159], v0, s[8:11], s49 offen
pd88:
    v_mfma_f32_32x32x16_bf16 v[48:63], a[96:99], v[124:127], v[48:63]
    ds_read_b64_tr_b16 v[120:121], v3 offset:26624
    ds_read_b64_tr_b16 v[122:123], v3 offset:27136
    s_waitcnt lgkmcnt(4)
    v_mfma_f32_32x32x16_bf16 v[64:79], a[96:99], v[128:131], v[64:79]
    ds_read_b64_tr_b16 v[124:125], v3 offset:59392
    ds_read_b64_tr_b16 v[126:127], v3 offset:59904
    v_mfma_f32_32x32x16_bf16 v[48:63], a[100:103], v[112:115], v[48:63]
    ds_read_b64_tr_b16 v[128:129], v3 offset:27648
    ds_read_b64_tr_b16 v[130:131], v3 offset:28160
    s_waitcnt lgkmcnt(4)
    v_mfma_f32_32x32x16_bf16 v[64:79], a[100:103], v[116:119], v[64:79]
    ds_read_b64_tr_b16 v[112:113], v3 offset:60416
    ds_read_b64_tr_b16 v[114:115], v3 offset:60928
    s_bitcmp1_b32 s16, 0
    s_cbranch_scc1 po89
    s_add_u32 s49, s65, 16384
    buffer_load_dwordx4 a[144:147], v0, s[8:11], s49 offen
    s_branch pd90
po89:
    s_add_u32 s49, s65, 0
    buffer_load_dwordx4 a[128:131], v0, s[8:11], s49 offen
pd90:
    v_mfma_f32_32x32x16_bf16 v[48:63], a[104:107], v[120:123], v[48:63]
    ds_read_b64_tr_b16 v[116:117], v3 offset:28672
    ds_read_b64_tr_b16 v[118:119], v3 offset:29184
    s_waitcnt lgkmcnt(4)
    v_mfma_f32_32x32x16_bf16 v[64:79], a[104:107], v[124:127], v[64:79]
    ds_read_b64_tr_b16 v[120:121], v3 offset:61440
    ds_read_b64_tr_b16 v[122:123], v3 offset:61952
    v_mfma_f32_32x32x16_bf16 v[48:63], a[108:111], v[128:131], v[48:63]
    ds_read_b64_tr_b16 v[124:125], v3 offset:29696
    ds_read_b64_tr_b16 v[126:127], v3 offset:30208
    s_waitcnt lgkmcnt(4)
    v_mfma_f32_32x32x16_bf16 v[64:79], a[108:111], v[112:115], v[64:79]
    ds_read_b64_tr_b16 v[128:129], v3 offset:62464
    ds_read_b64_tr_b16 v[130:131], v3 offset:62976
    s_bitcmp1_b32 s16, 0
    s_cbranch_scc1 po91
    s_add_u32 s49, s65, 20480
    buffer_load_dwordx4 a[148:151], v0, s[8:11], s49 offen
    s_branch pd92
po91:
    s_cmp_eq_u32 s18, 0
    s_cbranch_scc1 bo93
    s_cmp_eq_u32 s18, 1
    s_cbranch_scc1 bo93
    s_add_u32 s49, s65, 4096
    buffer_load_dwordx4 a[132:135], v0, s[8:11], s49 offen
bo93:
pd92:
    v_mfma_f32_32x32x16_bf16 v[48:63], a[112:115], v[116:119], v[48:63]
    ds_read_b64_tr_b16 v[112:113], v3 offset:30720
    ds_read_b64_tr_b16 v[114:115], v3 offset:31232
    s_waitcnt lgkmcnt(4)
    v_mfma_f32_32x32x16_bf16 v[64:79], a[112:115], v[120:123], v[64:79]
    ds_read_b64_tr_b16 v[116:117], v3 offset:63488
    ds_read_b64_tr_b16 v[118:119], v3 offset:64000
    v_mfma_f32_32x32x16_bf16 v[48:63], a[116:119], v[124:127], v[48:63]
    ds_read_b64_tr_b16 v[120:121], v3 offset:31744
    ds_read_b64_tr_b16 v[122:123], v3 offset:32256
    s_waitcnt lgkmcnt(4)
    v_mfma_f32_32x32x16_bf16 v[64:79], a[116:119], v[128:131], v[64:79]
    ds_read_b64_tr_b16 v[124:125], v3 offset:64512
    ds_read_b64_tr_b16 v[126:127], v3 offset:65024
    s_bitcmp1_b32 s16, 0
    s_cbranch_scc1 po94
    s_add_u32 s49, s65, 24576
    buffer_load_dwordx4 a[152:155], v0, s[8:11], s49 offen
    s_branch pd95
po94:
    s_add_u32 s49, s65, 8192
    buffer_load_dwordx4 a[136:139], v0, s[8:11], s49 offen
pd95:
    v_mfma_f32_32x32x16_bf16 v[48:63], a[120:123], v[112:115], v[48:63]
    ds_read_b128 v[128:131], v1 offset:32768
    s_waitcnt lgkmcnt(3)
    v_mfma_f32_32x32x16_bf16 v[64:79], a[120:123], v[116:119], v[64:79]
    ds_read_b128 v[112:115], v1 offset:33792
    v_mfma_f32_32x32x16_bf16 v[48:63], a[124:127], v[120:123], v[48:63]
    s_waitcnt lgkmcnt(1)
    v_mfma_f32_32x32x16_bf16 v[64:79], a[124:127], v[124:127], v[64:79]
    s_bitcmp1_b32 s16, 0
    s_cbranch_scc1 po96
    s_add_u32 s49, s65, 28672
    buffer_load_dwordx4 a[156:159], v0, s[8:11], s49 offen
    s_branch pd97
po96:
    s_add_u32 s49, s65, 12288
    buffer_load_dwordx4 a[140:143], v0, s[8:11], s49 offen
pd97:
    v_mfma_f32_32x32x16_bf16 v[48:63], v[16:19], v[128:131], v[48:63]
    s_waitcnt lgkmcnt(0)
    v_mfma_f32_32x32x16_bf16 v[64:79], v[16:19], v[112:115], v[64:79]
    s_bitcmp1_b32 s16, 0
    s_cbranch_scc1 po98
    s_add_u32 s49, s65, 32768
    buffer_load_dwordx4 a[160:163], v0, s[8:11], s49 offen
    s_branch pd99
po98:
    s_add_u32 s49, s65, 49152
    buffer_load_dwordx4 a[176:179], v0, s[8:11], s49 offen
pd99:
    s_nop 2
    v_mul_f32 v48, v48, v80
    v_mul_f32 v49, v49, v81
    v_mul_f32 v50, v50, v82
    v_mul_f32 v51, v51, v83
    v_mul_f32 v52, v52, v84
    v_mul_f32 v53, v53, v85
    v_mul_f32 v54, v54, v86
    v_mul_f32 v55, v55, v87
    v_mul_f32 v56, v56, v88
    v_mul_f32 v57, v57, v89
    v_mul_f32 v58, v58, v90
    v_mul_f32 v59, v59, v91
    v_mul_f32 v60, v60, v92
    v_mul_f32 v61, v61, v93
    v_mul_f32 v62, v62, v94
    v_mul_f32 v63, v63, v95
    v_mul_f32 v64, v64, v80
    v_mul_f32 v65, v65, v81
    v_mul_f32 v66, v66, v82
    v_mul_f32 v67, v67, v83
    v_mul_f32 v68, v68, v84
    v_mul_f32 v69, v69, v85
    v_mul_f32 v70, v70, v86
    v_mul_f32 v71, v71, v87
    v_mul_f32 v72, v72, v88
    v_mul_f32 v73, v73, v89
    v_mul_f32 v74, v74, v90
    v_mul_f32 v75, v75, v91
    v_mul_f32 v76, v76, v92
    v_mul_f32 v77, v77, v93
    v_mul_f32 v78, v78, v94
    v_mul_f32 v79, v79, v95
    v_exp_f32_e64 v80, v48 clamp
    v_max_f32 v48, 0, v48
    v_exp_f32_e64 v81, v49 clamp
    v_max_f32 v49, 0, v49
    v_exp_f32_e64 v82, v50 clamp
    v_max_f32 v50, 0, v50
    v_exp_f32_e64 v83, v51 clamp
    v_max_f32 v51, 0, v51
    v_exp_f32_e64 v84, v52 clamp
    v_max_f32 v52, 0, v52
    v_exp_f32_e64 v85, v53 clamp
    v_max_f32 v53, 0, v53
    v_exp_f32_e64 v86, v54 clamp
    v_max_f32 v54, 0, v54
    v_exp_f32_e64 v87, v55 clamp
    v_max_f32 v55, 0, v55
    v_exp_f32_e64 v88, v56 clamp
    v_max_f32 v56, 0, v56
    v_exp_f32_e64 v89, v57 clamp
    v_max_f32 v57, 0, v57
    v_exp_f32_e64 v90, v58 clamp
    v_max_f32 v58, 0, v58
    v_exp_f32_e64 v91, v59 clamp
    v_max_f32 v59, 0, v59
    v_exp_f32_e64 v92, v60 clamp
    v_max_f32 v60, 0, v60
    v_exp_f32_e64 v93, v61 clamp
    v_max_f32 v61, 0, v61
    v_exp_f32_e64 v94, v62 clamp
    v_max_f32 v62, 0, v62
    v_exp_f32_e64 v95, v63 clamp
    v_max_f32 v63, 0, v63
    v_cvt_pk_bf16_f32 v36, v64, v65
    v_cvt_pk_bf16_f32 v37, v66, v67
    v_cvt_pk_bf16_f32 v38, v68, v69
    v_cvt_pk_bf16_f32 v39, v70, v71
    v_cvt_pk_bf16_f32 v40, v72, v73
    v_cvt_pk_bf16_f32 v41, v74, v75
    v_cvt_pk_bf16_f32 v42, v76, v77
    v_cvt_pk_bf16_f32 v43, v78, v79
    v_fma_f32 v48, v48, s37, v80
    v_fma_f32 v49, v49, s37, v81
    v_fma_f32 v50, v50, s37, v82
    v_fma_f32 v51, v51, s37, v83
    v_fma_f32 v52, v52, s37, v84
    v_fma_f32 v53, v53, s37, v85
    v_fma_f32 v54, v54, s37, v86
    v_fma_f32 v55, v55, s37, v87
    v_fma_f32 v56, v56, s37, v88
    v_fma_f32 v57, v57, s37, v89
    v_fma_f32 v58, v58, s37, v90
    v_fma_f32 v59, v59, s37, v91
    v_fma_f32 v60, v60, s37, v92
    v_fma_f32 v61, v61, s37, v93
    v_fma_f32 v62, v62, s37, v94
    v_fma_f32 v63, v63, s37, v95
    v_add_f32 v48, s38, v48
    v_add_f32 v49, s38, v49
    v_add_f32 v50, s38, v50
    v_add_f32 v51, s38, v51
    v_add_f32 v52, s38, v52
    v_add_f32 v53, s38, v53
    v_add_f32 v54, s38, v54
    v_add_f32 v55, s38, v55
    v_add_f32 v56, s38, v56
    v_add_f32 v57, s38, v57
    v_add_f32 v58, s38, v58
    v_add_f32 v59, s38, v59
    v_add_f32 v60, s38, v60
    v_add_f32 v61, s38, v61
    v_add_f32 v62, s38, v62
    v_add_f32 v63, s38, v63
    v_mov_b32 v44, 0x3f803f80
    v_mov_b32 v45, 0x3f803f80
    v_mov_b32 v46, 0x3f803f80
    v_mov_b32 v47, 0x3f803f80
    v_cvt_pk_bf16_f32 v28, v48, v49
    v_cvt_pk_bf16_f32 v29, v50, v51
    v_cvt_pk_bf16_f32 v30, v52, v53
    v_cvt_pk_bf16_f32 v31, v54, v55
    v_cvt_pk_bf16_f32 v32, v56, v57
    v_cvt_pk_bf16_f32 v33, v58, v59
    v_cvt_pk_bf16_f32 v34, v60, v61
    v_cvt_pk_bf16_f32 v35, v62, v63
    s_mul_i32 s40, s18, 2304
    v_add_u32 v6, s40, v4
    v_mfma_f32_32x32x16_bf16 v[48:63], v[28:31], v[36:39], 0
    v_mfma_f32_32x32x16_bf16 v[64:79], v[44:47], v[28:31], 0
    v_mfma_f32_32x32x16_bf16 v[48:63], v[32:35], v[40:43], v[48:63]
    v_mfma_f32_32x32x16_bf16 v[64:79], v[44:47], v[32:35], v[64:79]
    v_lshrrev_b32 v7, 2, v0
    s_add_u32 s41, s40, 101376
    v_add_u32 v7, s41, v7
    s_nop 7
    v_cndmask_b32_e64 v80, v48, v56, s[30:31]
    v_cndmask_b32_e64 v81, v49, v57, s[30:31]
    v_cndmask_b32_e64 v82, v50, v58, s[30:31]
    v_cndmask_b32_e64 v83, v51, v59, s[30:31]
    v_cndmask_b32_e64 v84, v52, v60, s[30:31]
    v_cndmask_b32_e64 v85, v53, v61, s[30:31]
    v_cndmask_b32_e64 v86, v54, v62, s[30:31]
    v_cndmask_b32_e64 v87, v55, v63, s[30:31]
    ds_write_b128 v6, v[80:83] offset:49152
    ds_write_b128 v6, v[84:87] offset:50176
    ds_write_b32 v7, v64 offset:51200
    s_waitcnt lgkmcnt(0)
    s_barrier
    s_cmp_ge_u32 s18, 2
    s_cbranch_scc1 kd101
    s_cmp_eq_u32 s18, 1
    s_cbranch_scc1 kz100
    ds_read_b128 v[48:51], v4 offset:49152
    ds_read_b128 v[52:55], v4 offset:50176
    ds_read_b128 v[56:59], v4 offset:51456
    ds_read_b128 v[60:63], v4 offset:52480
    ds_read_b128 v[64:67], v4 offset:53760
    ds_read_b128 v[68:71], v4 offset:54784
    ds_read_b128 v[72:75], v4 offset:56064
    ds_read_b128 v[76:79], v4 offset:57088
    s_waitcnt lgkmcnt(0)
    v_add_f32 v48, v48, v56
    v_add_f32 v64, v64, v72
    v_add_f32 v49, v49, v57
    v_add_f32 v65, v65, v73
    v_add_f32 v50, v50, v58
    v_add_f32 v66, v66, v74
    v_add_f32 v51, v51, v59
    v_add_f32 v67, v67, v75
    v_add_f32 v52, v52, v60
    v_add_f32 v68, v68, v76
    v_add_f32 v53, v53, v61
    v_add_f32 v69, v69, v77
    v_add_f32 v54, v54, v62
    v_add_f32 v70, v70, v78
    v_add_f32 v55, v55, v63
    v_add_f32 v71, v71, v79
    v_add_f32 v48, v48, v64
    v_add_f32 v49, v49, v65
    v_add_f32 v50, v50, v66
    v_add_f32 v51, v51, v67
    v_add_f32 v52, v52, v68
    v_add_f32 v53, v53, v69
    v_add_f32 v54, v54, v70
    v_add_f32 v55, v55, v71
    v_cvt_pk_bf16_f32 v56, v48, v49
    v_cvt_pk_bf16_f32 v57, v50, v51
    v_cvt_pk_bf16_f32 v58, v52, v53
    v_cvt_pk_bf16_f32 v59, v54, v55
    buffer_store_dwordx4 v[56:59], v0, s[8:11], s35 offen sc1
    s_branch kd101
kz100:
    v_lshrrev_b32 v7, 2, v0
    v_add_u32 v6, 101376, v7
    ds_read_b32 v48, v6 offset:51200
    ds_read_b32 v49, v6 offset:53504
    ds_read_b32 v50, v6 offset:55808
    ds_read_b32 v51, v6 offset:58112
    s_waitcnt lgkmcnt(0)
    v_add_f32 v48, v48, v49
    v_add_f32 v50, v50, v51
    v_add_f32 v48, v48, v50
    s_mov_b64 exec, 0xffffffff
    buffer_store_dword v48, v7, s[8:11], s35 offen offset:1024 sc1
    s_mov_b64 exec, -1
kd101:
    s_barrier
    v_add_u32 v153, 0x10000, v3
    ds_read_b64_tr_b16 v[112:113], v153 offset:0
    ds_read_b64_tr_b16 v[114:115], v153 offset:512
    ds_read_b64_tr_b16 v[116:117], v153 offset:1024
    ds_read_b64_tr_b16 v[118:119], v153 offset:1536
    ds_read_b64_tr_b16 v[120:121], v153 offset:2048
    ds_read_b64_tr_b16 v[122:123], v153 offset:2560
    ds_read_b64_tr_b16 v[124:125], v153 offset:3072
    ds_read_b64_tr_b16 v[126:127], v153 offset:3584
    s_waitcnt lgkmcnt(4)
    v_mfma_f32_32x32x16_bf16 v[96:111], v[112:115], a[0:3], 0
    ds_read_b64_tr_b16 v[128:129], v153 offset:4096
    ds_read_b64_tr_b16 v[130:131], v153 offset:4608
    v_mfma_f32_32x32x16_bf16 v[96:111], v[116:119], a[4:7], v[96:111]
    ds_read_b64_tr_b16 v[112:113], v153 offset:5120
    ds_read_b64_tr_b16 v[114:115], v153 offset:5632
    s_bitcmp1_b32 s16, 0
    s_cbranch_scc1 po103
    s_cmp_eq_u32 s18, 2
    s_cbranch_scc1 bo105
    s_add_u32 s49, s65, 36864
    buffer_load_dwordx4 a[164:167], v0, s[8:11], s49 offen
bo105:
    s_branch pd104
po103:
    s_add_u32 s49, s65, 53248
    buffer_load_dwordx4 a[180:183], v0, s[8:11], s49 offen
pd104:
    s_waitcnt lgkmcnt(4)
    v_mfma_f32_32x32x16_bf16 v[96:111], v[120:123], a[8:11], v[96:111]
    ds_read_b64_tr_b16 v[116:117], v153 offset:6144
    ds_read_b64_tr_b16 v[118:119], v153 offset:6656
    s_bitcmp1_b32 s16, 0
    s_cbranch_scc1 po106
    s_add_u32 s49, s65, 40960
    buffer_load_dwordx4 a[168:171], v0, s[8:11], s49 offen
    s_branch pd107
po106:
    s_add_u32 s49, s65, 57344
    buffer_load_dwordx4 a[184:187], v0, s[8:11], s49 offen
pd107:
    v_mfma_f32_32x32x16_bf16 v[96:111], v[124:127], a[12:15], v[96:111]
    ds_read_b64_tr_b16 v[120:121], v153 offset:7168
    ds_read_b64_tr_b16 v[122:123], v153 offset:7680
    s_bitcmp1_b32 s16, 0
    s_cbranch_scc1 po108
    s_add_u32 s49, s65, 45056
    buffer_load_dwordx4 a[172:175], v0, s[8:11], s49 offen
    s_branch pd109
po108:
    s_add_u32 s49, s65, 61440
    buffer_load_dwordx4 a[188:191], v0, s[8:11], s49 offen
pd109:
    s_waitcnt lgkmcnt(4)
    v_mfma_f32_32x32x16_bf16 v[96:111], v[128:131], a[16:19], v[96:111]
    ds_read_b64_tr_b16 v[124:125], v153 offset:8192
    ds_read_b64_tr_b16 v[126:127], v153 offset:8704
    s_bitcmp1_b32 s16, 0
    s_cbranch_scc1 po110
    s_add_u32 s49, s65, 49152
    buffer_load_dwordx4 a[176:179], v0, s[8:11], s49 offen
    s_branch pd111
po110:
    s_add_u32 s49, s65, 32768
    buffer_load_dwordx4 a[160:163], v0, s[8:11], s49 offen
pd111:
    v_mfma_f32_32x32x16_bf16 v[96:111], v[112:115], a[20:23], v[96:111]
    ds_read_b64_tr_b16 v[128:129], v153 offset:9216
    ds_read_b64_tr_b16 v[130:131], v153 offset:9728
    s_bitcmp1_b32 s16, 0
    s_cbranch_scc1 po112
    s_add_u32 s49, s65, 53248
    buffer_load_dwordx4 a[180:183], v0, s[8:11], s49 offen
    s_branch pd113
po112:
    s_cmp_eq_u32 s18, 2
    s_cbranch_scc1 bo114
    s_add_u32 s49, s65, 36864
    buffer_load_dwordx4 a[164:167], v0, s[8:11], s49 offen
bo114:
pd113:
    s_waitcnt lgkmcnt(4)
    v_mfma_f32_32x32x16_bf16 v[96:111], v[116:119], a[24:27], v[96:111]
    ds_read_b64_tr_b16 v[112:113], v153 offset:10240
    ds_read_b64_tr_b16 v[114:115], v153 offset:10752
    s_bitcmp1_b32 s16, 0
    s_cbranch_scc1 po115
    s_add_u32 s49, s65, 57344
    buffer_load_dwordx4 a[184:187], v0, s[8:11], s49 offen
    s_branch pd116
po115:
    s_add_u32 s49, s65, 40960
    buffer_load_dwordx4 a[168:171], v0, s[8:11], s49 offen
pd116:
    v_mfma_f32_32x32x16_bf16 v[96:111], v[120:123], a[28:31], v[96:111]
    ds_read_b64_tr_b16 v[116:117], v153 offset:11264
    ds_read_b64_tr_b16 v[118:119], v153 offset:11776
    s_bitcmp1_b32 s16, 0
    s_cbranch_scc1 po117
    s_add_u32 s49, s65, 61440
    buffer_load_dwordx4 a[188:191], v0, s[8:11], s49 offen
    s_branch pd118
po117:
    s_add_u32 s49, s65, 45056
    buffer_load_dwordx4 a[172:175], v0, s[8:11], s49 offen
pd118:
    s_waitcnt lgkmcnt(4)
    v_mfma_f32_32x32x16_bf16 v[96:111], v[124:127], a[32:35], v[96:111]
    ds_read_b64_tr_b16 v[120:121], v153 offset:12288
    ds_read_b64_tr_b16 v[122:123], v153 offset:12800
    s_bitcmp1_b32 s16, 0
    s_cbranch_scc1 po119
    s_add_u32 s49, s65, 65536
    buffer_load_dwordx4 a[192:195], v0, s[8:11], s49 offen
    s_branch pd120
po119:
    s_add_u32 s49, s65, 81920
    buffer_load_dwordx4 a[208:211], v0, s[8:11], s49 offen
pd120:
    v_mfma_f32_32x32x16_bf16 v[96:111], v[128:131], a[36:39], v[96:111]
    ds_read_b64_tr_b16 v[124:125], v153 offset:13312
    ds_read_b64_tr_b16 v[126:127], v153 offset:13824
    s_bitcmp1_b32 s16, 0
    s_cbranch_scc1 po121
    s_cmp_eq_u32 s18, 3
    s_cbranch_scc1 bo123
    s_add_u32 s49, s65, 69632
    buffer_load_dwordx4 a[196:199], v0, s[8:11], s49 offen
bo123:
    s_branch pd122
po121:
    s_add_u32 s49, s65, 86016
    buffer_load_dwordx4 a[212:215], v0, s[8:11], s49 offen
pd122:
    s_waitcnt lgkmcnt(4)
    v_mfma_f32_32x32x16_bf16 v[96:111], v[112:115], a[40:43], v[96:111]
    ds_read_b64_tr_b16 v[128:129], v153 offset:14336
    ds_read_b64_tr_b16 v[130:131], v153 offset:14848
    s_bitcmp1_b32 s16, 0
    s_cbranch_scc1 po124
    s_add_u32 s49, s65, 73728
    buffer_load_dwordx4 a[200:203], v0, s[8:11], s49 offen
    s_branch pd125
po124:
    s_add_u32 s49, s65, 90112
    buffer_load_dwordx4 a[216:219], v0, s[8:11], s49 offen
pd125:
    v_mfma_f32_32x32x16_bf16 v[96:111], v[116:119], a[44:47], v[96:111]
    ds_read_b64_tr_b16 v[112:113], v153 offset:15360
    ds_read_b64_tr_b16 v[114:115], v153 offset:15872
    s_bitcmp1_b32 s16, 0
    s_cbranch_scc1 po126
    s_add_u32 s49, s65, 77824
    buffer_load_dwordx4 a[204:207], v0, s[8:11], s49 offen
    s_branch pd127
po126:
    s_add_u32 s49, s65, 94208
    buffer_load_dwordx4 a[220:223], v0, s[8:11], s49 offen
pd127:
    s_waitcnt lgkmcnt(4)
    v_mfma_f32_32x32x16_bf16 v[96:111], v[120:123], a[48:51], v[96:111]
    ds_read_b64_tr_b16 v[116:117], v153 offset:16384
    ds_read_b64_tr_b16 v[118:119], v153 offset:16896
    s_bitcmp1_b32 s16, 0
    s_cbranch_scc1 po128
    s_add_u32 s49, s65, 81920
    buffer_load_dwordx4 a[208:211], v0, s[8:11], s49 offen
    s_branch pd129
po128:
    s_add_u32 s49, s65, 65536
    buffer_load_dwordx4 a[192:195], v0, s[8:11], s49 offen
pd129:
    v_mfma_f32_32x32x16_bf16 v[96:111], v[124:127], a[52:55], v[96:111]
    ds_read_b64_tr_b16 v[120:121], v153 offset:17408
    ds_read_b64_tr_b16 v[122:123], v153 offset:17920
    s_bitcmp1_b32 s16, 0
    s_cbranch_scc1 po130
    s_add_u32 s49, s65, 86016
    buffer_load_dwordx4 a[212:215], v0, s[8:11], s49 offen
    s_branch pd131
po130:
    s_cmp_eq_u32 s18, 3
    s_cbranch_scc1 bo132
    s_add_u32 s49, s65, 69632
    buffer_load_dwordx4 a[196:199], v0, s[8:11], s49 offen
bo132:
pd131:
    s_waitcnt lgkmcnt(4)
    v_mfma_f32_32x32x16_bf16 v[96:111], v[128:131], a[56:59], v[96:111]
    ds_read_b64_tr_b16 v[124:125], v153 offset:18432
    ds_read_b64_tr_b16 v[126:127], v153 offset:18944
    s_bitcmp1_b32 s16, 0
    s_cbranch_scc1 po133
    s_add_u32 s49, s65, 90112
    buffer_load_dwordx4 a[216:219], v0, s[8:11], s49 offen
    s_branch pd134
po133:
    s_add_u32 s49, s65, 73728
    buffer_load_dwordx4 a[200:203], v0, s[8:11], s49 offen
pd134:
    v_mfma_f32_32x32x16_bf16 v[96:111], v[112:115], a[60:63], v[96:111]
    ds_read_b64_tr_b16 v[128:129], v153 offset:19456
    ds_read_b64_tr_b16 v[130:131], v153 offset:19968
    s_bitcmp1_b32 s16, 0
    s_cbranch_scc1 po135
    s_add_u32 s49, s65, 94208
    buffer_load_dwordx4 a[220:223], v0, s[8:11], s49 offen
    s_branch pd136
po135:
    s_add_u32 s49, s65, 77824
    buffer_load_dwordx4 a[204:207], v0, s[8:11], s49 offen
pd136:
    s_waitcnt lgkmcnt(4)
    v_mfma_f32_32x32x16_bf16 v[96:111], v[116:119], a[64:67], v[96:111]
    ds_read_b64_tr_b16 v[112:113], v153 offset:20480
    ds_read_b64_tr_b16 v[114:115], v153 offset:20992
    s_bitcmp1_b32 s16, 0
    s_cbranch_scc1 po137
    s_waitcnt vmcnt(20)
    s_cmp_eq_u32 s18, 0
    s_cbranch_scc0 cs139
    v_add_f32 v196, v196, v204
    v_add_f32 v197, v197, v205
    v_add_f32 v198, v198, v206
    v_add_f32 v199, v199, v207
    v_add_f32 v200, v200, v208
    v_add_f32 v201, v201, v209
    v_add_f32 v202, v202, v210
    v_add_f32 v203, v203, v211
    v_add_f32 v196, v196, v200
    v_add_f32 v197, v197, v201
    v_add_f32 v198, v198, v202
    v_add_f32 v199, v199, v203
    v_add_f32 v196, v196, v198
    v_add_f32 v197, v197, v199
    v_add_f32 v196, v196, v197
    v_mov_b32 v197, v196
    s_nop 1
    v_permlane32_swap_b32 v196, v197
    s_nop 0
    v_add_f32 v196, v196, v197
    v_sub_f32 v196, 0, v196
    v_cvt_pk_bf16_f32 v197, v196, v196
    v_and_b32 v198, 0xffff0000, v197
    v_sub_f32 v199, v196, v198
    v_cvt_pk_bf16_f32 v28, v198, v199
    v_mov_b32 v200, 0
    v_cvt_pk_bf16_f32 v29, v198, v200
    v_cndmask_b32_e64 v28, v28, 0, s[32:33]
    v_cndmask_b32_e64 v29, v29, 0, s[32:33]
    v_mov_b32 v30, 0
    v_mov_b32 v31, 0
    v_accvgpr_write_b32 a132, v28
    v_accvgpr_write_b32 a133, v29
    v_accvgpr_write_b32 a134, v30
    v_accvgpr_write_b32 a135, v31
cs139:
    s_cmp_eq_u32 s18, 1
    s_cbranch_scc0 cs140
    v_add_f32 v196, v196, v204
    v_add_f32 v197, v197, v205
    v_add_f32 v198, v198, v206
    v_add_f32 v199, v199, v207
    v_add_f32 v200, v200, v208
    v_add_f32 v201, v201, v209
    v_add_f32 v202, v202, v210
    v_add_f32 v203, v203, v211
    v_add_f32 v196, v196, v200
    v_add_f32 v197, v197, v201
    v_add_f32 v198, v198, v202
    v_add_f32 v199, v199, v203
    v_add_f32 v196, v196, v198
    v_add_f32 v197, v197, v199
    v_add_f32 v196, v196, v197
    v_mov_b32 v197, v196
    s_nop 1
    v_permlane32_swap_b32 v196, v197
    s_nop 0
    v_add_f32 v196, v196, v197
    v_sub_f32 v196, 0, v196
    v_cvt_pk_bf16_f32 v197, v196, v196
    v_and_b32 v198, 0xffff0000, v197
    v_sub_f32 v199, v196, v198
    v_cvt_pk_bf16_f32 v28, v198, v199
    v_mov_b32 v200, 0
    v_cvt_pk_bf16_f32 v29, v198, v200
    v_cndmask_b32_e64 v28, v28, 0, s[32:33]
    v_cndmask_b32_e64 v29, v29, 0, s[32:33]
    v_mov_b32 v30, 0
    v_mov_b32 v31, 0
    v_accvgpr_write_b32 a132, v28
    v_accvgpr_write_b32 a133, v29
    v_accvgpr_write_b32 a134, v30
    v_accvgpr_write_b32 a135, v31
cs140:
    s_cmp_eq_u32 s18, 2
    s_cbranch_scc0 cs141
    v_add_f32 v196, v196, v204
    v_add_f32 v197, v197, v205
    v_add_f32 v198, v198, v206
    v_add_f32 v199, v199, v207
    v_add_f32 v200, v200, v208
    v_add_f32 v201, v201, v209
    v_add_f32 v202, v202, v210
    v_add_f32 v203, v203, v211
    v_add_f32 v196, v196, v200
    v_add_f32 v197, v197, v201
    v_add_f32 v198, v198, v202
    v_add_f32 v199, v199, v203
    v_add_f32 v196, v196, v198
    v_add_f32 v197, v197, v199
    v_add_f32 v196, v196, v197
    v_mov_b32 v197, v196
    s_nop 1
    v_permlane32_swap_b32 v196, v197
    s_nop 0
    v_add_f32 v196, v196, v197
    v_sub_f32 v196, 0, v196
    v_cvt_pk_bf16_f32 v197, v196, v196
    v_and_b32 v198, 0xffff0000, v197
    v_sub_f32 v199, v196, v198
    v_cvt_pk_bf16_f32 v28, v198, v199
    v_mov_b32 v200, 0
    v_cvt_pk_bf16_f32 v29, v198, v200
    v_cndmask_b32_e64 v28, v28, 0, s[32:33]
    v_cndmask_b32_e64 v29, v29, 0, s[32:33]
    v_mov_b32 v30, 0
    v_mov_b32 v31, 0
    v_accvgpr_write_b32 a164, v28
    v_accvgpr_write_b32 a165, v29
    v_accvgpr_write_b32 a166, v30
    v_accvgpr_write_b32 a167, v31
cs141:
    s_cmp_eq_u32 s18, 3
    s_cbranch_scc0 cs142
    v_add_f32 v196, v196, v204
    v_add_f32 v197, v197, v205
    v_add_f32 v198, v198, v206
    v_add_f32 v199, v199, v207
    v_add_f32 v200, v200, v208
    v_add_f32 v201, v201, v209
    v_add_f32 v202, v202, v210
    v_add_f32 v203, v203, v211
    v_add_f32 v196, v196, v200
    v_add_f32 v197, v197, v201
    v_add_f32 v198, v198, v202
    v_add_f32 v199, v199, v203
    v_add_f32 v196, v196, v198
    v_add_f32 v197, v197, v199
    v_add_f32 v196, v196, v197
    v_mov_b32 v197, v196
    s_nop 1
    v_permlane32_swap_b32 v196, v197
    s_nop 0
    v_add_f32 v196, v196, v197
    v_sub_f32 v196, 0, v196
    v_cvt_pk_bf16_f32 v197, v196, v196
    v_and_b32 v198, 0xffff0000, v197
    v_sub_f32 v199, v196, v198
    v_cvt_pk_bf16_f32 v28, v198, v199
    v_mov_b32 v200, 0
    v_cvt_pk_bf16_f32 v29, v198, v200
    v_cndmask_b32_e64 v28, v28, 0, s[32:33]
    v_cndmask_b32_e64 v29, v29, 0, s[32:33]
    v_mov_b32 v30, 0
    v_mov_b32 v31, 0
    v_accvgpr_write_b32 a196, v28
    v_accvgpr_write_b32 a197, v29
    v_accvgpr_write_b32 a198, v30
    v_accvgpr_write_b32 a199, v31
cs142:
    s_cmp_eq_u32 s18, 3
    s_cbranch_scc0 cs143
    v_add_f32 v212, v212, v220
    v_add_f32 v213, v213, v221
    v_add_f32 v214, v214, v222
    v_add_f32 v215, v215, v223
    v_add_f32 v216, v216, v224
    v_add_f32 v217, v217, v225
    v_add_f32 v218, v218, v226
    v_add_f32 v219, v219, v227
    v_add_f32 v212, v212, v216
    v_add_f32 v213, v213, v217
    v_add_f32 v214, v214, v218
    v_add_f32 v215, v215, v219
    v_add_f32 v212, v212, v214
    v_add_f32 v213, v213, v215
    v_add_f32 v212, v212, v213
    v_mov_b32 v213, v212
    s_nop 1
    v_permlane32_swap_b32 v212, v213
    s_nop 0
    v_add_f32 v212, v212, v213
    v_sub_f32 v212, 0, v212
    v_cvt_pk_bf16_f32 v213, v212, v212
    v_and_b32 v214, 0xffff0000, v213
    v_sub_f32 v215, v212, v214
    v_cvt_pk_bf16_f32 v28, v214, v215
    v_mov_b32 v216, 0
    v_cvt_pk_bf16_f32 v29, v214, v216
    v_cndmask_b32_e64 v28, v28, 0, s[32:33]
    v_cndmask_b32_e64 v29, v29, 0, s[32:33]
    v_mov_b32 v30, 0
    v_mov_b32 v31, 0
    v_accvgpr_write_b32 a244, v28
    v_accvgpr_write_b32 a245, v29
    v_accvgpr_write_b32 a246, v30
    v_accvgpr_write_b32 a247, v31
cs143:
    s_cmp_eq_u32 s18, 1
    s_cbranch_scc0 cs144
    v_add_f32 v212, v212, v220
    v_add_f32 v213, v213, v221
    v_add_f32 v214, v214, v222
    v_add_f32 v215, v215, v223
    v_add_f32 v216, v216, v224
    v_add_f32 v217, v217, v225
    v_add_f32 v218, v218, v226
    v_add_f32 v219, v219, v227
    v_add_f32 v212, v212, v216
    v_add_f32 v213, v213, v217
    v_add_f32 v214, v214, v218
    v_add_f32 v215, v215, v219
    v_add_f32 v212, v212, v214
    v_add_f32 v213, v213, v215
    v_add_f32 v212, v212, v213
    v_mov_b32 v213, v212
    s_nop 1
    v_permlane32_swap_b32 v212, v213
    s_nop 0
    v_add_f32 v212, v212, v213
    v_sub_f32 v212, 0, v212
    v_cvt_pk_bf16_f32 v213, v212, v212
    v_and_b32 v214, 0xffff0000, v213
    v_sub_f32 v215, v212, v214
    v_cvt_pk_bf16_f32 v28, v214, v215
    v_mov_b32 v216, 0
    v_cvt_pk_bf16_f32 v29, v214, v216
    v_cndmask_b32_e64 v28, v28, 0, s[32:33]
    v_cndmask_b32_e64 v29, v29, 0, s[32:33]
    v_mov_b32 v30, 0
    v_mov_b32 v31, 0
    v_mov_b32 v204, v28
    v_mov_b32 v205, v29
    v_mov_b32 v206, v30
    v_mov_b32 v207, v31
cs144:
    s_branch pd138
po137:
    s_waitcnt vmcnt(20)
    s_cmp_eq_u32 s18, 0
    s_cbranch_scc0 cs145
    v_add_f32 v196, v196, v204
    v_add_f32 v197, v197, v205
    v_add_f32 v198, v198, v206
    v_add_f32 v199, v199, v207
    v_add_f32 v200, v200, v208
    v_add_f32 v201, v201, v209
    v_add_f32 v202, v202, v210
    v_add_f32 v203, v203, v211
    v_add_f32 v196, v196, v200
    v_add_f32 v197, v197, v201
    v_add_f32 v198, v198, v202
    v_add_f32 v199, v199, v203
    v_add_f32 v196, v196, v198
    v_add_f32 v197, v197, v199
    v_add_f32 v196, v196, v197
    v_mov_b32 v197, v196
    s_nop 1
    v_permlane32_swap_b32 v196, v197
    s_nop 0
    v_add_f32 v196, v196, v197
    v_sub_f32 v196, 0, v196
    v_cvt_pk_bf16_f32 v197, v196, v196
    v_and_b32 v198, 0xffff0000, v197
    v_sub_f32 v199, v196, v198
    v_cvt_pk_bf16_f32 v28, v198, v199
    v_mov_b32 v200, 0
    v_cvt_pk_bf16_f32 v29, v198, v200
    v_cndmask_b32_e64 v28, v28, 0, s[32:33]
    v_cndmask_b32_e64 v29, v29, 0, s[32:33]
    v_mov_b32 v30, 0
    v_mov_b32 v31, 0
    v_accvgpr_write_b32 a132, v28
    v_accvgpr_write_b32 a133, v29
    v_accvgpr_write_b32 a134, v30
    v_accvgpr_write_b32 a135, v31
cs145:
    s_cmp_eq_u32 s18, 1
    s_cbranch_scc0 cs146
    v_add_f32 v196, v196, v204
    v_add_f32 v197, v197, v205
    v_add_f32 v198, v198, v206
    v_add_f32 v199, v199, v207
    v_add_f32 v200, v200, v208
    v_add_f32 v201, v201, v209
    v_add_f32 v202, v202, v210
    v_add_f32 v203, v203, v211
    v_add_f32 v196, v196, v200
    v_add_f32 v197, v197, v201
    v_add_f32 v198, v198, v202
    v_add_f32 v199, v199, v203
    v_add_f32 v196, v196, v198
    v_add_f32 v197, v197, v199
    v_add_f32 v196, v196, v197
    v_mov_b32 v197, v196
    s_nop 1
    v_permlane32_swap_b32 v196, v197
    s_nop 0
    v_add_f32 v196, v196, v197
    v_sub_f32 v196, 0, v196
    v_cvt_pk_bf16_f32 v197, v196, v196
    v_and_b32 v198, 0xffff0000, v197
    v_sub_f32 v199, v196, v198
    v_cvt_pk_bf16_f32 v28, v198, v199
    v_mov_b32 v200, 0
    v_cvt_pk_bf16_f32 v29, v198, v200
    v_cndmask_b32_e64 v28, v28, 0, s[32:33]
    v_cndmask_b32_e64 v29, v29, 0, s[32:33]
    v_mov_b32 v30, 0
    v_mov_b32 v31, 0
    v_accvgpr_write_b32 a132, v28
    v_accvgpr_write_b32 a133, v29
    v_accvgpr_write_b32 a134, v30
    v_accvgpr_write_b32 a135, v31
cs146:
    s_cmp_eq_u32 s18, 2
    s_cbranch_scc0 cs147
    v_add_f32 v196, v196, v204
    v_add_f32 v197, v197, v205
    v_add_f32 v198, v198, v206
    v_add_f32 v199, v199, v207
    v_add_f32 v200, v200, v208
    v_add_f32 v201, v201, v209
    v_add_f32 v202, v202, v210
    v_add_f32 v203, v203, v211
    v_add_f32 v196, v196, v200
    v_add_f32 v197, v197, v201
    v_add_f32 v198, v198, v202
    v_add_f32 v199, v199, v203
    v_add_f32 v196, v196, v198
    v_add_f32 v197, v197, v199
    v_add_f32 v196, v196, v197
    v_mov_b32 v197, v196
    s_nop 1
    v_permlane32_swap_b32 v196, v197
    s_nop 0
    v_add_f32 v196, v196, v197
    v_sub_f32 v196, 0, v196
    v_cvt_pk_bf16_f32 v197, v196, v196
    v_and_b32 v198, 0xffff0000, v197
    v_sub_f32 v199, v196, v198
    v_cvt_pk_bf16_f32 v28, v198, v199
    v_mov_b32 v200, 0
    v_cvt_pk_bf16_f32 v29, v198, v200
    v_cndmask_b32_e64 v28, v28, 0, s[32:33]
    v_cndmask_b32_e64 v29, v29, 0, s[32:33]
    v_mov_b32 v30, 0
    v_mov_b32 v31, 0
    v_accvgpr_write_b32 a164, v28
    v_accvgpr_write_b32 a165, v29
    v_accvgpr_write_b32 a166, v30
    v_accvgpr_write_b32 a167, v31
cs147:
    s_cmp_eq_u32 s18, 3
    s_cbranch_scc0 cs148
    v_add_f32 v196, v196, v204
    v_add_f32 v197, v197, v205
    v_add_f32 v198, v198, v206
    v_add_f32 v199, v199, v207
    v_add_f32 v200, v200, v208
    v_add_f32 v201, v201, v209
    v_add_f32 v202, v202, v210
    v_add_f32 v203, v203, v211
    v_add_f32 v196, v196, v200
    v_add_f32 v197, v197, v201
    v_add_f32 v198, v198, v202
    v_add_f32 v199, v199, v203
    v_add_f32 v196, v196, v198
    v_add_f32 v197, v197, v199
    v_add_f32 v196, v196, v197
    v_mov_b32 v197, v196
    s_nop 1
    v_permlane32_swap_b32 v196, v197
    s_nop 0
    v_add_f32 v196, v196, v197
    v_sub_f32 v196, 0, v196
    v_cvt_pk_bf16_f32 v197, v196, v196
    v_and_b32 v198, 0xffff0000, v197
    v_sub_f32 v199, v196, v198
    v_cvt_pk_bf16_f32 v28, v198, v199
    v_mov_b32 v200, 0
    v_cvt_pk_bf16_f32 v29, v198, v200
    v_cndmask_b32_e64 v28, v28, 0, s[32:33]
    v_cndmask_b32_e64 v29, v29, 0, s[32:33]
    v_mov_b32 v30, 0
    v_mov_b32 v31, 0
    v_accvgpr_write_b32 a196, v28
    v_accvgpr_write_b32 a197, v29
    v_accvgpr_write_b32 a198, v30
    v_accvgpr_write_b32 a199, v31
cs148:
    s_cmp_eq_u32 s18, 3
    s_cbranch_scc0 cs149
    v_add_f32 v212, v212, v220
    v_add_f32 v213, v213, v221
    v_add_f32 v214, v214, v222
    v_add_f32 v215, v215, v223
    v_add_f32 v216, v216, v224
    v_add_f32 v217, v217, v225
    v_add_f32 v218, v218, v226
    v_add_f32 v219, v219, v227
    v_add_f32 v212, v212, v216
    v_add_f32 v213, v213, v217
    v_add_f32 v214, v214, v218
    v_add_f32 v215, v215, v219
    v_add_f32 v212, v212, v214
    v_add_f32 v213, v213, v215
    v_add_f32 v212, v212, v213
    v_mov_b32 v213, v212
    s_nop 1
    v_permlane32_swap_b32 v212, v213
    s_nop 0
    v_add_f32 v212, v212, v213
    v_sub_f32 v212, 0, v212
    v_cvt_pk_bf16_f32 v213, v212, v212
    v_and_b32 v214, 0xffff0000, v213
    v_sub_f32 v215, v212, v214
    v_cvt_pk_bf16_f32 v28, v214, v215
    v_mov_b32 v216, 0
    v_cvt_pk_bf16_f32 v29, v214, v216
    v_cndmask_b32_e64 v28, v28, 0, s[32:33]
    v_cndmask_b32_e64 v29, v29, 0, s[32:33]
    v_mov_b32 v30, 0
    v_mov_b32 v31, 0
    v_accvgpr_write_b32 a244, v28
    v_accvgpr_write_b32 a245, v29
    v_accvgpr_write_b32 a246, v30
    v_accvgpr_write_b32 a247, v31
cs149:
    s_cmp_eq_u32 s18, 1
    s_cbranch_scc0 cs150
    v_add_f32 v212, v212, v220
    v_add_f32 v213, v213, v221
    v_add_f32 v214, v214, v222
    v_add_f32 v215, v215, v223
    v_add_f32 v216, v216, v224
    v_add_f32 v217, v217, v225
    v_add_f32 v218, v218, v226
    v_add_f32 v219, v219, v227
    v_add_f32 v212, v212, v216
    v_add_f32 v213, v213, v217
    v_add_f32 v214, v214, v218
    v_add_f32 v215, v215, v219
    v_add_f32 v212, v212, v214
    v_add_f32 v213, v213, v215
    v_add_f32 v212, v212, v213
    v_mov_b32 v213, v212
    s_nop 1
    v_permlane32_swap_b32 v212, v213
    s_nop 0
    v_add_f32 v212, v212, v213
    v_sub_f32 v212, 0, v212
    v_cvt_pk_bf16_f32 v213, v212, v212
    v_and_b32 v214, 0xffff0000, v213
    v_sub_f32 v215, v212, v214
    v_cvt_pk_bf16_f32 v28, v214, v215
    v_mov_b32 v216, 0
    v_cvt_pk_bf16_f32 v29, v214, v216
    v_cndmask_b32_e64 v28, v28, 0, s[32:33]
    v_cndmask_b32_e64 v29, v29, 0, s[32:33]
    v_mov_b32 v30, 0
    v_mov_b32 v31, 0
    v_mov_b32 v204, v28
    v_mov_b32 v205, v29
    v_mov_b32 v206, v30
    v_mov_b32 v207, v31
cs150:
pd138:
    v_mfma_f32_32x32x16_bf16 v[96:111], v[120:123], a[68:71], v[96:111]
    ds_read_b64_tr_b16 v[116:117], v153 offset:21504
    ds_read_b64_tr_b16 v[118:119], v153 offset:22016
    s_bitcmp1_b32 s16, 0
    s_cbranch_scc1 po151
    s_add_u32 s49, s65, 98304
    buffer_load_dwordx4 a[224:227], v0, s[8:11], s49 offen
    s_branch pd152
po151:
    s_add_u32 s49, s65, 114688
    buffer_load_dwordx4 a[240:243], v0, s[8:11], s49 offen
pd152:
    s_waitcnt lgkmcnt(4)
    v_mfma_f32_32x32x16_bf16 v[96:111], v[124:127], a[72:75], v[96:111]
    ds_read_b64_tr_b16 v[120:121], v153 offset:22528
    ds_read_b64_tr_b16 v[122:123], v153 offset:23040
    s_bitcmp1_b32 s16, 0
    s_cbranch_scc1 po153
    s_add_u32 s49, s65, 102400
    buffer_load_dwordx4 a[228:231], v0, s[8:11], s49 offen
    s_branch pd154
po153:
    s_cmp_eq_u32 s18, 3
    s_cbranch_scc1 bo155
    s_add_u32 s49, s65, 118784
    buffer_load_dwordx4 a[244:247], v0, s[8:11], s49 offen
bo155:
pd154:
    v_mfma_f32_32x32x16_bf16 v[96:111], v[128:131], a[76:79], v[96:111]
    ds_read_b64_tr_b16 v[124:125], v153 offset:23552
    ds_read_b64_tr_b16 v[126:127], v153 offset:24064
    s_bitcmp1_b32 s16, 0
    s_cbranch_scc1 po156
    s_add_u32 s49, s65, 106496
    buffer_load_dwordx4 a[232:235], v0, s[8:11], s49 offen
    s_branch pd157
po156:
    s_add_u32 s49, s65, 122880
    buffer_load_dwordx4 a[248:251], v0, s[8:11], s49 offen
pd157:
    s_waitcnt lgkmcnt(4)
    v_mfma_f32_32x32x16_bf16 v[96:111], v[112:115], a[80:83], v[96:111]
    ds_read_b64_tr_b16 v[128:129], v153 offset:24576
    ds_read_b64_tr_b16 v[130:131], v153 offset:25088
    s_bitcmp1_b32 s16, 0
    s_cbranch_scc1 po158
    s_add_u32 s49, s65, 110592
    buffer_load_dwordx4 a[236:239], v0, s[8:11], s49 offen
    s_branch pd159
po158:
    s_add_u32 s49, s65, 126976
    buffer_load_dwordx4 a[252:255], v0, s[8:11], s49 offen
pd159:
    v_mfma_f32_32x32x16_bf16 v[96:111], v[116:119], a[84:87], v[96:111]
    ds_read_b64_tr_b16 v[112:113], v153 offset:25600
    ds_read_b64_tr_b16 v[114:115], v153 offset:26112
    s_bitcmp1_b32 s16, 0
    s_cbranch_scc1 po160
    s_add_u32 s49, s65, 114688
    buffer_load_dwordx4 a[240:243], v0, s[8:11], s49 offen
    s_branch pd161
po160:
    s_add_u32 s49, s65, 98304
    buffer_load_dwordx4 a[224:227], v0, s[8:11], s49 offen
pd161:
    s_waitcnt lgkmcnt(4)
    v_mfma_f32_32x32x16_bf16 v[96:111], v[120:123], a[88:91], v[96:111]
    ds_read_b64_tr_b16 v[116:117], v153 offset:26624
    ds_read_b64_tr_b16 v[118:119], v153 offset:27136
    s_bitcmp1_b32 s16, 0
    s_cbranch_scc1 po162
    s_cmp_eq_u32 s18, 3
    s_cbranch_scc1 bo164
    s_add_u32 s49, s65, 118784
    buffer_load_dwordx4 a[244:247], v0, s[8:11], s49 offen
bo164:
    s_branch pd163
po162:
    s_add_u32 s49, s65, 102400
    buffer_load_dwordx4 a[228:231], v0, s[8:11], s49 offen
pd163:
    v_mfma_f32_32x32x16_bf16 v[96:111], v[124:127], a[92:95], v[96:111]
    ds_read_b64_tr_b16 v[120:121], v153 offset:27648
    ds_read_b64_tr_b16 v[122:123], v153 offset:28160
    s_bitcmp1_b32 s16, 0
    s_cbranch_scc1 po165
    s_add_u32 s49, s65, 122880
    buffer_load_dwordx4 a[248:251], v0, s[8:11], s49 offen
    s_branch pd166
po165:
    s_add_u32 s49, s65, 106496
    buffer_load_dwordx4 a[232:235], v0, s[8:11], s49 offen
pd166:
    s_waitcnt lgkmcnt(4)
    v_mfma_f32_32x32x16_bf16 v[96:111], v[128:131], a[96:99], v[96:111]
    ds_read_b64_tr_b16 v[124:125], v153 offset:28672
    ds_read_b64_tr_b16 v[126:127], v153 offset:29184
    s_bitcmp1_b32 s16, 0
    s_cbranch_scc1 po167
    s_add_u32 s49, s65, 126976
    buffer_load_dwordx4 a[252:255], v0, s[8:11], s49 offen
    s_branch pd168
po167:
    s_add_u32 s49, s65, 110592
    buffer_load_dwordx4 a[236:239], v0, s[8:11], s49 offen
pd168:
    v_mfma_f32_32x32x16_bf16 v[96:111], v[112:115], a[100:103], v[96:111]
    ds_read_b64_tr_b16 v[128:129], v153 offset:29696
    ds_read_b64_tr_b16 v[130:131], v153 offset:30208
    s_bitcmp1_b32 s16, 0
    s_cbranch_scc1 po169
    s_add_u32 s49, s65, 131072
    buffer_load_dwordx4 v[156:159], v0, s[8:11], s49 offen
    s_branch pd170
po169:
    s_add_u32 s49, s65, 147456
    buffer_load_dwordx4 v[172:175], v0, s[8:11], s49 offen
pd170:
    s_waitcnt lgkmcnt(4)
    v_mfma_f32_32x32x16_bf16 v[96:111], v[116:119], a[104:107], v[96:111]
    ds_read_b64_tr_b16 v[112:113], v153 offset:30720
    ds_read_b64_tr_b16 v[114:115], v153 offset:31232
    s_bitcmp1_b32 s16, 0
    s_cbranch_scc1 po171
    s_add_u32 s49, s65, 135168
    buffer_load_dwordx4 v[160:163], v0, s[8:11], s49 offen
    s_branch pd172
po171:
    s_add_u32 s49, s65, 151552
    buffer_load_dwordx4 v[176:179], v0, s[8:11], s49 offen
pd172:
    v_mfma_f32_32x32x16_bf16 v[96:111], v[120:123], a[108:111], v[96:111]
    ds_read_b64_tr_b16 v[116:117], v153 offset:31744
    ds_read_b64_tr_b16 v[118:119], v153 offset:32256
    s_bitcmp1_b32 s16, 0
    s_cbranch_scc1 po173
    s_add_u32 s49, s65, 139264
    buffer_load_dwordx4 v[164:167], v0, s[8:11], s49 offen
    s_branch pd174
po173:
    s_add_u32 s49, s65, 155648
    buffer_load_dwordx4 v[180:183], v0, s[8:11], s49 offen
pd174:
    s_waitcnt lgkmcnt(4)
    v_mfma_f32_32x32x16_bf16 v[96:111], v[124:127], a[112:115], v[96:111]
    ds_read_b128 v[120:123], v1 offset:34816
    s_bitcmp1_b32 s16, 0
    s_cbranch_scc1 po175
    s_add_u32 s49, s65, 143360
    buffer_load_dwordx4 v[168:171], v0, s[8:11], s49 offen
    s_branch pd176
po175:
    s_add_u32 s49, s65, 159744
    buffer_load_dwordx4 v[184:187], v0, s[8:11], s49 offen
pd176:
    v_mfma_f32_32x32x16_bf16 v[96:111], v[128:131], a[116:119], v[96:111]
    s_bitcmp1_b32 s16, 0
    s_cbranch_scc1 po177
    s_add_u32 s49, s65, 147456
    buffer_load_dwordx4 v[172:175], v0, s[8:11], s49 offen
    s_branch pd178
po177:
    s_add_u32 s49, s65, 131072
    buffer_load_dwordx4 v[156:159], v0, s[8:11], s49 offen
pd178:
    s_waitcnt lgkmcnt(1)
    v_mfma_f32_32x32x16_bf16 v[96:111], v[112:115], a[120:123], v[96:111]
    s_bitcmp1_b32 s16, 0
    s_cbranch_scc1 po179
    s_add_u32 s49, s65, 151552
    buffer_load_dwordx4 v[176:179], v0, s[8:11], s49 offen
    s_branch pd180
po179:
    s_add_u32 s49, s65, 135168
    buffer_load_dwordx4 v[160:163], v0, s[8:11], s49 offen
pd180:
    v_mfma_f32_32x32x16_bf16 v[96:111], v[116:119], a[124:127], v[96:111]
    s_bitcmp1_b32 s16, 0
    s_cbranch_scc1 po181
    s_add_u32 s49, s65, 155648
    buffer_load_dwordx4 v[180:183], v0, s[8:11], s49 offen
    s_branch pd182
po181:
    s_add_u32 s49, s65, 139264
    buffer_load_dwordx4 v[164:167], v0, s[8:11], s49 offen
pd182:
    s_waitcnt lgkmcnt(0)
    v_mfma_f32_32x32x16_bf16 v[96:111], v[120:123], v[16:19], v[96:111]
    s_bitcmp1_b32 s16, 0
    s_cbranch_scc1 po183
    s_add_u32 s49, s65, 159744
    buffer_load_dwordx4 v[184:187], v0, s[8:11], s49 offen
    s_branch pd184
po183:
    s_add_u32 s49, s65, 143360
    buffer_load_dwordx4 v[168:171], v0, s[8:11], s49 offen
pd184:
    s_bitcmp1_b32 s16, 0
    s_cbranch_scc1 po185
    s_add_u32 s49, s65, 163840
    buffer_load_dwordx4 v[188:191], v0, s[8:11], s49 offen
    s_branch pd186
po185:
    s_cmp_eq_u32 s18, 1
    s_cbranch_scc1 bo187
    s_add_u32 s49, s65, 180224
    buffer_load_dwordx4 v[204:207], v0, s[8:11], s49 offen
bo187:
pd186:
    v_mul_f32 v28, 0x3fb8aa3b, v24
    v_mul_f32 v96, v96, v28
    v_mul_f32 v97, v97, v28
    v_mul_f32 v98, v98, v28
    v_mul_f32 v99, v99, v28
    v_mul_f32 v100, v100, v28
    v_mul_f32 v101, v101, v28
    v_mul_f32 v102, v102, v28
    v_mul_f32 v103, v103, v28
    v_mul_f32 v104, v104, v28
    v_mul_f32 v105, v105, v28
    v_mul_f32 v106, v106, v28
    v_mul_f32 v107, v107, v28
    v_mul_f32 v108, v108, v28
    v_mul_f32 v109, v109, v28
    v_mul_f32 v110, v110, v28
    v_mul_f32 v111, v111, v28
    v_exp_f32_e64 v80, v96 clamp
    v_max_f32 v96, 0, v96
    v_exp_f32_e64 v81, v97 clamp
    v_max_f32 v97, 0, v97
    v_exp_f32_e64 v82, v98 clamp
    v_max_f32 v98, 0, v98
    v_exp_f32_e64 v83, v99 clamp
    v_max_f32 v99, 0, v99
    v_exp_f32_e64 v84, v100 clamp
    v_max_f32 v100, 0, v100
    v_exp_f32_e64 v85, v101 clamp
    v_max_f32 v101, 0, v101
    v_exp_f32_e64 v86, v102 clamp
    v_max_f32 v102, 0, v102
    v_exp_f32_e64 v87, v103 clamp
    v_max_f32 v103, 0, v103
    v_exp_f32_e64 v88, v104 clamp
    v_max_f32 v104, 0, v104
    v_exp_f32_e64 v89, v105 clamp
    v_max_f32 v105, 0, v105
    v_exp_f32_e64 v90, v106 clamp
    v_max_f32 v106, 0, v106
    v_exp_f32_e64 v91, v107 clamp
    v_max_f32 v107, 0, v107
    v_exp_f32_e64 v92, v108 clamp
    v_max_f32 v108, 0, v108
    v_exp_f32_e64 v93, v109 clamp
    v_max_f32 v109, 0, v109
    v_exp_f32_e64 v94, v110 clamp
    v_max_f32 v110, 0, v110
    v_exp_f32_e64 v95, v111 clamp
    v_max_f32 v111, 0, v111
    v_fma_f32 v96, v96, s37, v80
    v_fma_f32 v97, v97, s37, v81
    v_fma_f32 v98, v98, s37, v82
    v_fma_f32 v99, v99, s37, v83
    v_fma_f32 v100, v100, s37, v84
    v_fma_f32 v101, v101, s37, v85
    v_fma_f32 v102, v102, s37, v86
    v_fma_f32 v103, v103, s37, v87
    v_fma_f32 v104, v104, s37, v88
    v_fma_f32 v105, v105, s37, v89
    v_fma_f32 v106, v106, s37, v90
    v_fma_f32 v107, v107, s37, v91
    v_fma_f32 v108, v108, s37, v92
    v_fma_f32 v109, v109, s37, v93
    v_fma_f32 v110, v110, s37, v94
    v_fma_f32 v111, v111, s37, v95
    v_add_f32 v96, s38, v96
    v_add_f32 v97, s38, v97
    v_add_f32 v98, s38, v98
    v_add_f32 v99, s38, v99
    v_add_f32 v100, s38, v100
    v_add_f32 v101, s38, v101
    v_add_f32 v102, s38, v102
    v_add_f32 v103, s38, v103
    v_add_f32 v104, s38, v104
    v_add_f32 v105, s38, v105
    v_add_f32 v106, s38, v106
    v_add_f32 v107, s38, v107
    v_add_f32 v108, s38, v108
    v_add_f32 v109, s38, v109
    v_add_f32 v110, s38, v110
    v_add_f32 v111, s38, v111
    v_cvt_pk_bf16_f32 v132, v96, v97
    v_cvt_pk_bf16_f32 v133, v98, v99
    v_cvt_pk_bf16_f32 v134, v100, v101
    v_cvt_pk_bf16_f32 v135, v102, v103
    v_cvt_pk_bf16_f32 v136, v104, v105
    v_cvt_pk_bf16_f32 v137, v106, v107
    v_cvt_pk_bf16_f32 v138, v108, v109
    v_cvt_pk_bf16_f32 v139, v110, v111
    s_branch main_s1_fast
ob24:
    s_and_b32 s52, s17, 1
    s_lshl_b32 s52, s52, 2
    s_add_u32 s52, s52, 0
    v_xor_b32 v147, s52, v146
    v_lshlrev_b32 v147, 4, v147
    v_add_u32 v147, v145, v147
    ds_read_b64 v[8:9], v147 offset:0
    s_and_b32 s52, s17, 1
    s_lshl_b32 s52, s52, 2
    s_add_u32 s52, s52, 1
    v_xor_b32 v147, s52, v146
    v_lshlrev_b32 v147, 4, v147
    v_add_u32 v147, v145, v147
    ds_read_b64 v[10:11], v147 offset:0
    s_and_b32 s52, s17, 1
    s_lshl_b32 s52, s52, 2
    s_add_u32 s52, s52, 2
    v_xor_b32 v147, s52, v146
    v_lshlrev_b32 v147, 4, v147
    v_add_u32 v147, v145, v147
    ds_read_b64 v[12:13], v147 offset:0
    s_and_b32 s52, s17, 1
    s_lshl_b32 s52, s52, 2
    s_add_u32 s52, s52, 3
    v_xor_b32 v147, s52, v146
    v_lshlrev_b32 v147, 4, v147
    v_add_u32 v147, v145, v147
    ds_read_b64 v[14:15], v147 offset:0
    s_waitcnt lgkmcnt(0)
    s_branch or25
ob26:
    s_and_b32 s52, s17, 1
    s_lshl_b32 s52, s52, 2
    s_add_u32 s52, s52, 0
    v_xor_b32 v147, s52, v146
    v_lshlrev_b32 v147, 4, v147
    v_add_u32 v147, v145, v147
    ds_read_b64 v[8:9], v147 offset:4096
    s_and_b32 s52, s17, 1
    s_lshl_b32 s52, s52, 2
    s_add_u32 s52, s52, 1
    v_xor_b32 v147, s52, v146
    v_lshlrev_b32 v147, 4, v147
    v_add_u32 v147, v145, v147
    ds_read_b64 v[10:11], v147 offset:4096
    s_and_b32 s52, s17, 1
    s_lshl_b32 s52, s52, 2
    s_add_u32 s52, s52, 2
    v_xor_b32 v147, s52, v146
    v_lshlrev_b32 v147, 4, v147
    v_add_u32 v147, v145, v147
    ds_read_b64 v[12:13], v147 offset:4096
    s_and_b32 s52, s17, 1
    s_lshl_b32 s52, s52, 2
    s_add_u32 s52, s52, 3
    v_xor_b32 v147, s52, v146
    v_lshlrev_b32 v147, 4, v147
    v_add_u32 v147, v145, v147
    ds_read_b64 v[14:15], v147 offset:4096
    s_waitcnt lgkmcnt(0)
    s_branch or27
ob28:
    s_and_b32 s52, s17, 1
    s_lshl_b32 s52, s52, 2
    s_add_u32 s52, s52, 0
    v_xor_b32 v147, s52, v146
    v_lshlrev_b32 v147, 4, v147
    v_add_u32 v147, v145, v147
    ds_read_b64 v[8:9], v147 offset:8192
    s_and_b32 s52, s17, 1
    s_lshl_b32 s52, s52, 2
    s_add_u32 s52, s52, 1
    v_xor_b32 v147, s52, v146
    v_lshlrev_b32 v147, 4, v147
    v_add_u32 v147, v145, v147
    ds_read_b64 v[10:11], v147 offset:8192
    s_and_b32 s52, s17, 1
    s_lshl_b32 s52, s52, 2
    s_add_u32 s52, s52, 2
    v_xor_b32 v147, s52, v146
    v_lshlrev_b32 v147, 4, v147
    v_add_u32 v147, v145, v147
    ds_read_b64 v[12:13], v147 offset:8192
    s_and_b32 s52, s17, 1
    s_lshl_b32 s52, s52, 2
    s_add_u32 s52, s52, 3
    v_xor_b32 v147, s52, v146
    v_lshlrev_b32 v147, 4, v147
    v_add_u32 v147, v145, v147
    ds_read_b64 v[14:15], v147 offset:8192
    s_waitcnt lgkmcnt(0)
    s_branch or29
ob30:
    s_and_b32 s52, s17, 1
    s_lshl_b32 s52, s52, 2
    s_add_u32 s52, s52, 0
    v_xor_b32 v147, s52, v146
    v_lshlrev_b32 v147, 4, v147
    v_add_u32 v147, v208, v147
    ds_read_b64 v[8:9], v147 offset:0
    s_and_b32 s52, s17, 1
    s_lshl_b32 s52, s52, 2
    s_add_u32 s52, s52, 1
    v_xor_b32 v147, s52, v146
    v_lshlrev_b32 v147, 4, v147
    v_add_u32 v147, v208, v147
    ds_read_b64 v[10:11], v147 offset:0
    s_and_b32 s52, s17, 1
    s_lshl_b32 s52, s52, 2
    s_add_u32 s52, s52, 2
    v_xor_b32 v147, s52, v146
    v_lshlrev_b32 v147, 4, v147
    v_add_u32 v147, v208, v147
    ds_read_b64 v[12:13], v147 offset:0
    s_and_b32 s52, s17, 1
    s_lshl_b32 s52, s52, 2
    s_add_u32 s52, s52, 3
    v_xor_b32 v147, s52, v146
    v_lshlrev_b32 v147, 4, v147
    v_add_u32 v147, v208, v147
    ds_read_b64 v[14:15], v147 offset:0
    s_waitcnt lgkmcnt(0)
    s_branch or31
ob32:
    s_and_b32 s52, s17, 1
    s_lshl_b32 s52, s52, 2
    s_add_u32 s52, s52, 0
    v_xor_b32 v147, s52, v146
    v_lshlrev_b32 v147, 4, v147
    v_add_u32 v147, v208, v147
    ds_read_b64 v[8:9], v147 offset:4096
    s_and_b32 s52, s17, 1
    s_lshl_b32 s52, s52, 2
    s_add_u32 s52, s52, 1
    v_xor_b32 v147, s52, v146
    v_lshlrev_b32 v147, 4, v147
    v_add_u32 v147, v208, v147
    ds_read_b64 v[10:11], v147 offset:4096
    s_and_b32 s52, s17, 1
    s_lshl_b32 s52, s52, 2
    s_add_u32 s52, s52, 2
    v_xor_b32 v147, s52, v146
    v_lshlrev_b32 v147, 4, v147
    v_add_u32 v147, v208, v147
    ds_read_b64 v[12:13], v147 offset:4096
    s_and_b32 s52, s17, 1
    s_lshl_b32 s52, s52, 2
    s_add_u32 s52, s52, 3
    v_xor_b32 v147, s52, v146
    v_lshlrev_b32 v147, 4, v147
    v_add_u32 v147, v208, v147
    ds_read_b64 v[14:15], v147 offset:4096
    s_waitcnt lgkmcnt(0)
    s_branch or33
ob35:
    s_and_b32 s52, s17, 1
    s_lshl_b32 s52, s52, 2
    s_add_u32 s52, s52, 0
    v_xor_b32 v147, s52, v146
    v_lshlrev_b32 v147, 4, v147
    v_add_u32 v147, v145, v147
    ds_read_b64 v[8:9], v147 offset:0
    s_and_b32 s52, s17, 1
    s_lshl_b32 s52, s52, 2
    s_add_u32 s52, s52, 1
    v_xor_b32 v147, s52, v146
    v_lshlrev_b32 v147, 4, v147
    v_add_u32 v147, v145, v147
    ds_read_b64 v[10:11], v147 offset:0
    s_and_b32 s52, s17, 1
    s_lshl_b32 s52, s52, 2
    s_add_u32 s52, s52, 2
    v_xor_b32 v147, s52, v146
    v_lshlrev_b32 v147, 4, v147
    v_add_u32 v147, v145, v147
    ds_read_b64 v[12:13], v147 offset:0
    s_and_b32 s52, s17, 1
    s_lshl_b32 s52, s52, 2
    s_add_u32 s52, s52, 3
    v_xor_b32 v147, s52, v146
    v_lshlrev_b32 v147, 4, v147
    v_add_u32 v147, v145, v147
    ds_read_b64 v[14:15], v147 offset:0
    s_waitcnt lgkmcnt(0)
    s_branch or36
ob37:
    s_mov_b32 s44, 0x80808080
    buffer_load_dword v193, v192, s[4:7], 0 offen sc1
    s_branch or38
ob39:
    s_and_b32 s52, s17, 1
    s_lshl_b32 s52, s52, 2
    s_add_u32 s52, s52, 0
    v_xor_b32 v147, s52, v146
    v_lshlrev_b32 v147, 4, v147
    v_add_u32 v147, v145, v147
    ds_read_b64 v[8:9], v147 offset:4096
    s_and_b32 s52, s17, 1
    s_lshl_b32 s52, s52, 2
    s_add_u32 s52, s52, 1
    v_xor_b32 v147, s52, v146
    v_lshlrev_b32 v147, 4, v147
    v_add_u32 v147, v145, v147
    ds_read_b64 v[10:11], v147 offset:4096
    s_and_b32 s52, s17, 1
    s_lshl_b32 s52, s52, 2
    s_add_u32 s52, s52, 2
    v_xor_b32 v147, s52, v146
    v_lshlrev_b32 v147, 4, v147
    v_add_u32 v147, v145, v147
    ds_read_b64 v[12:13], v147 offset:4096
    s_and_b32 s52, s17, 1
    s_lshl_b32 s52, s52, 2
    s_add_u32 s52, s52, 3
    v_xor_b32 v147, s52, v146
    v_lshlrev_b32 v147, 4, v147
    v_add_u32 v147, v145, v147
    ds_read_b64 v[14:15], v147 offset:4096
    s_waitcnt lgkmcnt(0)
    s_branch or40
ob41:
    s_mov_b32 s44, 0x80808080
ldp191:
    s_waitcnt vmcnt(0)
    v_and_b32 v194, 0x80808080, v193
    v_cmp_ne_u32 vcc, s44, v194
    s_cbranch_vccz ldg193
    buffer_load_dword v193, v192, s[4:7], 0 offen sc1
    s_branch ldo192
ldg193:
    s_waitcnt vmcnt(0)
    s_mul_i32 s45, s3, 0x01010101
    v_cmp_ne_u32 vcc, s45, v193
    s_lshl_b32 s45, s16, 2
    s_lshr_b64 s[46:47], vcc, s45
    s_and_b32 s46, s46, 15
    s_cmp_eq_u32 s46, 0
    s_cselect_b32 s46, 1, 2
    v_mov_b32 v194, s46
    v_lshlrev_b32 v192, 3, v0
    s_lshl_b32 s45, s16, 11
    s_add_u32 s45, s45, 22085632
    s_mov_b64 exec, 0xffff
    buffer_store_dword v194, v192, s[8:11], s45 offen sc1
    s_mov_b64 exec, -1
    s_mov_b32 s72, 0
ldo192:
    s_branch or42
ob43:
    s_and_b32 s52, s17, 1
    s_lshl_b32 s52, s52, 2
    s_add_u32 s52, s52, 0
    v_xor_b32 v147, s52, v146
    v_lshlrev_b32 v147, 4, v147
    v_add_u32 v147, v145, v147
    ds_read_b64 v[8:9], v147 offset:8192
    s_and_b32 s52, s17, 1
    s_lshl_b32 s52, s52, 2
    s_add_u32 s52, s52, 1
    v_xor_b32 v147, s52, v146
    v_lshlrev_b32 v147, 4, v147
    v_add_u32 v147, v145, v147
    ds_read_b64 v[10:11], v147 offset:8192
    s_and_b32 s52, s17, 1
    s_lshl_b32 s52, s52, 2
    s_add_u32 s52, s52, 2
    v_xor_b32 v147, s52, v146
    v_lshlrev_b32 v147, 4, v147
    v_add_u32 v147, v145, v147
    ds_read_b64 v[12:13], v147 offset:8192
    s_and_b32 s52, s17, 1
    s_lshl_b32 s52, s52, 2
    s_add_u32 s52, s52, 3
    v_xor_b32 v147, s52, v146
    v_lshlrev_b32 v147, 4, v147
    v_add_u32 v147, v145, v147
    ds_read_b64 v[14:15], v147 offset:8192
    s_waitcnt lgkmcnt(0)
    s_branch or44
ob45:
    s_mov_b32 s44, 0x80808080
ldp194:
    s_waitcnt vmcnt(0)
    v_and_b32 v194, 0x80808080, v193
    v_cmp_ne_u32 vcc, s44, v194
    s_cbranch_vccz ldg196
    buffer_load_dword v193, v192, s[4:7], 0 offen sc1
    s_cmp_eq_u32 s34, 0
    s_cbranch_scc1 ldg196
    s_sub_u32 s34, s34, 1
    s_branch ldp194
ldg196:
    s_waitcnt vmcnt(0)
    s_mul_i32 s45, s3, 0x01010101
    v_cmp_ne_u32 vcc, s45, v193
    s_lshl_b32 s45, s16, 2
    s_lshr_b64 s[46:47], vcc, s45
    s_and_b32 s46, s46, 15
    s_cmp_eq_u32 s46, 0
    s_cselect_b32 s46, 1, 2
    v_mov_b32 v194, s46
    v_lshlrev_b32 v192, 3, v0
    s_lshl_b32 s45, s16, 11
    s_add_u32 s45, s45, 22085632
    s_mov_b64 exec, 0xffff
    buffer_store_dword v194, v192, s[8:11], s45 offen sc1
    s_mov_b64 exec, -1
    s_mov_b32 s72, 0
ldo195:
    s_branch or46
ob50:
msp197:
    buffer_load_dword v6, off, s[8:11], s44 sc1
    s_cmp_eq_u32 s34, 0
    s_cbranch_scc1 mex198
    s_sub_u32 s34, s34, 1
    s_waitcnt vmcnt(0)
    v_cmp_eq_u32 vcc, 0, v6
    s_cbranch_vccnz msp197
mex198:
    s_waitcnt vmcnt(0)
    s_branch or51
main_loop_fast:
    ds_read_b64_tr_b16 v[112:113], v3 offset:0
    ds_read_b64_tr_b16 v[114:115], v3 offset:512
    ds_read_b64_tr_b16 v[116:117], v3 offset:32768
    ds_read_b64_tr_b16 v[118:119], v3 offset:33280
    ds_read_b64_tr_b16 v[120:121], v3 offset:1024
    ds_read_b64_tr_b16 v[122:123], v3 offset:1536
    ds_read_b64_tr_b16 v[124:125], v3 offset:33792
    ds_read_b64_tr_b16 v[126:127], v3 offset:34304
    s_waitcnt vmcnt(4) lgkmcnt(4)
    v_mfma_f32_32x32x16_bf16 v[48:63], a[0:3], v[112:115], 0
    ds_read_b64_tr_b16 v[128:129], v3 offset:2048
    ds_read_b64_tr_b16 v[130:131], v3 offset:2560
    buffer_load_dwordx4 a[20:23], v0, s[8:11], s68 offen offset:1024 sc1
    buffer_load_dwordx4 a[24:27], v0, s[8:11], s68 offen offset:2048 sc1
    v_mfma_f32_32x32x16_bf16 v[64:79], a[0:3], v[116:119], 0
    ds_read_b64_tr_b16 v[112:113], v3 offset:34816
    ds_read_b64_tr_b16 v[114:115], v3 offset:35328
    s_waitcnt vmcnt(5) lgkmcnt(4)
    v_mfma_f32_32x32x16_bf16 v[48:63], a[4:7], v[120:123], v[48:63]
    ds_read_b64_tr_b16 v[116:117], v3 offset:3072
    ds_read_b64_tr_b16 v[118:119], v3 offset:3584
    buffer_load_dwordx4 a[28:31], v0, s[8:11], s68 offen offset:3072 sc1
    s_add_u32 s68, s20, s98
    buffer_load_dwordx4 a[32:35], v0, s[8:11], s68 offen offset:0 sc1
    v_mfma_f32_32x32x16_bf16 v[64:79], a[4:7], v[124:127], v[64:79]
    ds_read_b64_tr_b16 v[120:121], v3 offset:35840
    ds_read_b64_tr_b16 v[122:123], v3 offset:36352
    s_waitcnt vmcnt(6) lgkmcnt(4)
    v_mfma_f32_32x32x16_bf16 v[48:63], a[8:11], v[128:131], v[48:63]
    ds_read_b64_tr_b16 v[124:125], v3 offset:4096
    ds_read_b64_tr_b16 v[126:127], v3 offset:4608
    buffer_load_dwordx4 a[36:39], v0, s[8:11], s68 offen offset:1024 sc1
    buffer_load_dwordx4 a[40:43], v0, s[8:11], s68 offen offset:2048 sc1
    v_mfma_f32_32x32x16_bf16 v[64:79], a[8:11], v[112:115], v[64:79]
    ds_read_b64_tr_b16 v[128:129], v3 offset:36864
    ds_read_b64_tr_b16 v[130:131], v3 offset:37376
    s_waitcnt vmcnt(7) lgkmcnt(4)
    v_mfma_f32_32x32x16_bf16 v[48:63], a[12:15], v[116:119], v[48:63]
    ds_read_b64_tr_b16 v[112:113], v3 offset:5120
    ds_read_b64_tr_b16 v[114:115], v3 offset:5632
    buffer_load_dwordx4 a[44:47], v0, s[8:11], s68 offen offset:3072 sc1
    s_add_u32 s68, s20, s99
    buffer_load_dwordx4 a[48:51], v0, s[8:11], s68 offen offset:0 sc1
    v_mfma_f32_32x32x16_bf16 v[64:79], a[12:15], v[120:123], v[64:79]
    ds_read_b64_tr_b16 v[116:117], v3 offset:37888
    ds_read_b64_tr_b16 v[118:119], v3 offset:38400
    s_waitcnt vmcnt(8) lgkmcnt(4)
    v_mfma_f32_32x32x16_bf16 v[48:63], a[16:19], v[124:127], v[48:63]
    ds_read_b64_tr_b16 v[120:121], v3 offset:6144
    ds_read_b64_tr_b16 v[122:123], v3 offset:6656
    buffer_load_dwordx4 a[52:55], v0, s[8:11], s68 offen offset:1024 sc1
    v_mfma_f32_32x32x16_bf16 v[64:79], a[16:19], v[128:131], v[64:79]
    ds_read_b64_tr_b16 v[124:125], v3 offset:38912
    ds_read_b64_tr_b16 v[126:127], v3 offset:39424
    s_waitcnt vmcnt(8) lgkmcnt(4)
    v_mfma_f32_32x32x16_bf16 v[48:63], a[20:23], v[112:115], v[48:63]
    ds_read_b64_tr_b16 v[128:129], v3 offset:7168
    ds_read_b64_tr_b16 v[130:131], v3 offset:7680
    buffer_load_dwordx4 a[56:59], v0, s[8:11], s68 offen offset:2048 sc1
    v_mfma_f32_32x32x16_bf16 v[64:79], a[20:23], v[116:119], v[64:79]
    ds_read_b64_tr_b16 v[112:113], v3 offset:39936
    ds_read_b64_tr_b16 v[114:115], v3 offset:40448
    s_waitcnt vmcnt(8) lgkmcnt(4)
    v_mfma_f32_32x32x16_bf16 v[48:63], a[24:27], v[120:123], v[48:63]
    ds_read_b64_tr_b16 v[116:117], v3 offset:8192
    ds_read_b64_tr_b16 v[118:119], v3 offset:8704
    buffer_load_dwordx4 a[60:63], v0, s[8:11], s68 offen offset:3072 sc1
    v_mfma_f32_32x32x16_bf16 v[64:79], a[24:27], v[124:127], v[64:79]
    ds_read_b64_tr_b16 v[120:121], v3 offset:40960
    ds_read_b64_tr_b16 v[122:123], v3 offset:41472
    s_waitcnt vmcnt(8) lgkmcnt(4)
    v_mfma_f32_32x32x16_bf16 v[48:63], a[28:31], v[128:131], v[48:63]
    ds_read_b64_tr_b16 v[124:125], v3 offset:9216
    ds_read_b64_tr_b16 v[126:127], v3 offset:9728
    s_add_u32 s68, s20, s100
    buffer_load_dwordx4 a[64:67], v0, s[8:11], s68 offen offset:0 sc1
    v_mfma_f32_32x32x16_bf16 v[64:79], a[28:31], v[112:115], v[64:79]
    ds_read_b64_tr_b16 v[128:129], v3 offset:41984
    ds_read_b64_tr_b16 v[130:131], v3 offset:42496
    s_waitcnt vmcnt(8) lgkmcnt(4)
    v_mfma_f32_32x32x16_bf16 v[48:63], a[32:35], v[116:119], v[48:63]
    ds_read_b64_tr_b16 v[112:113], v3 offset:10240
    ds_read_b64_tr_b16 v[114:115], v3 offset:10752
    buffer_load_dwordx4 a[68:71], v0, s[8:11], s68 offen offset:1024 sc1
    buffer_load_dwordx4 v[28:31], v0, s[8:11], s23 offen offset:0 sc1
    buffer_load_dwordx4 v[32:35], v0, s[8:11], s23 offen offset:1024 sc1
    buffer_load_dwordx4 v[36:39], v0, s[8:11], s23 offen offset:2048 sc1
    buffer_load_dwordx4 v[40:43], v0, s[8:11], s23 offen offset:3072 sc1
    v_mfma_f32_32x32x16_bf16 v[64:79], a[32:35], v[120:123], v[64:79]
    ds_read_b64_tr_b16 v[116:117], v3 offset:43008
    ds_read_b64_tr_b16 v[118:119], v3 offset:43520
    s_waitcnt vmcnt(12) lgkmcnt(4)
    v_mfma_f32_32x32x16_bf16 v[48:63], a[36:39], v[124:127], v[48:63]
    ds_read_b64_tr_b16 v[120:121], v3 offset:11264
    ds_read_b64_tr_b16 v[122:123], v3 offset:11776
    buffer_load_dwordx4 a[72:75], v0, s[8:11], s68 offen offset:2048 sc1
    v_mfma_f32_32x32x16_bf16 v[64:79], a[36:39], v[128:131], v[64:79]
    ds_read_b64_tr_b16 v[124:125], v3 offset:44032
    ds_read_b64_tr_b16 v[126:127], v3 offset:44544
    s_waitcnt vmcnt(12) lgkmcnt(4)
    v_mfma_f32_32x32x16_bf16 v[48:63], a[40:43], v[112:115], v[48:63]
    ds_read_b64_tr_b16 v[128:129], v3 offset:12288
    ds_read_b64_tr_b16 v[130:131], v3 offset:12800
    buffer_load_dwordx4 a[76:79], v0, s[8:11], s68 offen offset:3072 sc1
    v_mfma_f32_32x32x16_bf16 v[64:79], a[40:43], v[116:119], v[64:79]
    ds_read_b64_tr_b16 v[112:113], v3 offset:45056
    ds_read_b64_tr_b16 v[114:115], v3 offset:45568
    s_waitcnt vmcnt(12) lgkmcnt(4)
    v_mfma_f32_32x32x16_bf16 v[48:63], a[44:47], v[120:123], v[48:63]
    ds_read_b64_tr_b16 v[116:117], v3 offset:13312
    ds_read_b64_tr_b16 v[118:119], v3 offset:13824
    s_add_u32 s68, s20, s101
    buffer_load_dwordx4 a[80:83], v0, s[8:11], s68 offen offset:0 sc1
    v_mfma_f32_32x32x16_bf16 v[64:79], a[44:47], v[124:127], v[64:79]
    ds_read_b64_tr_b16 v[120:121], v3 offset:46080
    ds_read_b64_tr_b16 v[122:123], v3 offset:46592
    s_waitcnt vmcnt(12) lgkmcnt(4)
    v_mfma_f32_32x32x16_bf16 v[48:63], a[48:51], v[128:131], v[48:63]
    ds_read_b64_tr_b16 v[124:125], v3 offset:14336
    ds_read_b64_tr_b16 v[126:127], v3 offset:14848
    buffer_load_dwordx4 a[84:87], v0, s[8:11], s68 offen offset:1024 sc1
    v_mfma_f32_32x32x16_bf16 v[64:79], a[48:51], v[112:115], v[64:79]
    ds_read_b64_tr_b16 v[128:129], v3 offset:47104
    ds_read_b64_tr_b16 v[130:131], v3 offset:47616
    s_waitcnt vmcnt(12) lgkmcnt(4)
    v_mfma_f32_32x32x16_bf16 v[48:63], a[52:55], v[116:119], v[48:63]
    ds_read_b64_tr_b16 v[112:113], v3 offset:15360
    ds_read_b64_tr_b16 v[114:115], v3 offset:15872
    buffer_load_dwordx4 a[88:91], v0, s[8:11], s68 offen offset:2048 sc1
    v_mfma_f32_32x32x16_bf16 v[64:79], a[52:55], v[120:123], v[64:79]
    ds_read_b64_tr_b16 v[116:117], v3 offset:48128
    ds_read_b64_tr_b16 v[118:119], v3 offset:48640
    s_waitcnt vmcnt(12) lgkmcnt(4)
    v_mfma_f32_32x32x16_bf16 v[48:63], a[56:59], v[124:127], v[48:63]
    ds_read_b64_tr_b16 v[120:121], v3 offset:16384
    ds_read_b64_tr_b16 v[122:123], v3 offset:16896
    buffer_load_dwordx4 a[92:95], v0, s[8:11], s68 offen offset:3072 sc1
    v_mfma_f32_32x32x16_bf16 v[64:79], a[56:59], v[128:131], v[64:79]
    ds_read_b64_tr_b16 v[124:125], v3 offset:49152
    ds_read_b64_tr_b16 v[126:127], v3 offset:49664
    s_waitcnt vmcnt(12) lgkmcnt(4)
    v_mfma_f32_32x32x16_bf16 v[48:63], a[60:63], v[112:115], v[48:63]
    ds_read_b64_tr_b16 v[128:129], v3 offset:17408
    ds_read_b64_tr_b16 v[130:131], v3 offset:17920
    s_add_u32 s68, s20, s29
    buffer_load_dwordx4 a[96:99], v0, s[8:11], s68 offen offset:0 sc1
    v_mfma_f32_32x32x16_bf16 v[64:79], a[60:63], v[116:119], v[64:79]
    ds_read_b64_tr_b16 v[112:113], v3 offset:50176
    ds_read_b64_tr_b16 v[114:115], v3 offset:50688
    s_waitcnt vmcnt(12) lgkmcnt(4)
    v_mfma_f32_32x32x16_bf16 v[48:63], a[64:67], v[120:123], v[48:63]
    ds_read_b64_tr_b16 v[116:117], v3 offset:18432
    ds_read_b64_tr_b16 v[118:119], v3 offset:18944
    buffer_load_dwordx4 a[100:103], v0, s[8:11], s68 offen offset:1024 sc1
    v_mfma_f32_32x32x16_bf16 v[64:79], a[64:67], v[124:127], v[64:79]
    ds_read_b64_tr_b16 v[120:121], v3 offset:51200
    ds_read_b64_tr_b16 v[122:123], v3 offset:51712
    s_waitcnt vmcnt(12) lgkmcnt(4)
    v_mfma_f32_32x32x16_bf16 v[48:63], a[68:71], v[128:131], v[48:63]
    ds_read_b64_tr_b16 v[124:125], v3 offset:19456
    ds_read_b64_tr_b16 v[126:127], v3 offset:19968
    buffer_load_dwordx4 a[104:107], v0, s[8:11], s68 offen offset:2048 sc1
    v_mfma_f32_32x32x16_bf16 v[64:79], a[68:71], v[112:115], v[64:79]
    ds_read_b64_tr_b16 v[128:129], v3 offset:52224
    ds_read_b64_tr_b16 v[130:131], v3 offset:52736
    s_waitcnt vmcnt(9)
    v_add_f32 v28, v28, v30
    v_add_f32 v29, v29, v31
    s_waitcnt vmcnt(8) lgkmcnt(4)
    v_mfma_f32_32x32x16_bf16 v[48:63], a[72:75], v[116:119], v[48:63]
    ds_read_b64_tr_b16 v[112:113], v3 offset:20480
    ds_read_b64_tr_b16 v[114:115], v3 offset:20992
    buffer_load_dwordx4 a[108:111], v0, s[8:11], s68 offen offset:3072 sc1
    v_mfma_f32_32x32x16_bf16 v[64:79], a[72:75], v[120:123], v[64:79]
    ds_read_b64_tr_b16 v[116:117], v3 offset:53248
    ds_read_b64_tr_b16 v[118:119], v3 offset:53760
    v_add_f32 v28, v28, v32
    v_add_f32 v29, v29, v33
    v_add_f32 v28, v28, v34
    s_waitcnt vmcnt(8) lgkmcnt(4)
    v_mfma_f32_32x32x16_bf16 v[48:63], a[76:79], v[124:127], v[48:63]
    ds_read_b64_tr_b16 v[120:121], v3 offset:21504
    ds_read_b64_tr_b16 v[122:123], v3 offset:22016
    s_add_u32 s68, s20, s39
    buffer_load_dwordx4 a[112:115], v0, s[8:11], s68 offen offset:0 sc1
    v_mfma_f32_32x32x16_bf16 v[64:79], a[76:79], v[128:131], v[64:79]
    ds_read_b64_tr_b16 v[124:125], v3 offset:54272
    ds_read_b64_tr_b16 v[126:127], v3 offset:54784
    v_add_f32 v29, v29, v35
    v_add_f32 v28, v28, v36
    v_add_f32 v29, v29, v37
    s_waitcnt vmcnt(8) lgkmcnt(4)
    v_mfma_f32_32x32x16_bf16 v[48:63], a[80:83], v[112:115], v[48:63]
    ds_read_b64_tr_b16 v[128:129], v3 offset:22528
    ds_read_b64_tr_b16 v[130:131], v3 offset:23040
    buffer_load_dwordx4 a[116:119], v0, s[8:11], s68 offen offset:1024 sc1
    v_mfma_f32_32x32x16_bf16 v[64:79], a[80:83], v[116:119], v[64:79]
    ds_read_b64_tr_b16 v[112:113], v3 offset:55296
    ds_read_b64_tr_b16 v[114:115], v3 offset:55808
    v_add_f32 v28, v28, v38
    v_add_f32 v29, v29, v39
    v_add_f32 v28, v28, v40
    s_waitcnt vmcnt(8) lgkmcnt(4)
    v_mfma_f32_32x32x16_bf16 v[48:63], a[84:87], v[120:123], v[48:63]
    ds_read_b64_tr_b16 v[116:117], v3 offset:23552
    ds_read_b64_tr_b16 v[118:119], v3 offset:24064
    buffer_load_dwordx4 a[120:123], v0, s[8:11], s68 offen offset:2048 sc1
    v_mfma_f32_32x32x16_bf16 v[64:79], a[84:87], v[124:127], v[64:79]
    ds_read_b64_tr_b16 v[120:121], v3 offset:56320
    ds_read_b64_tr_b16 v[122:123], v3 offset:56832
    v_add_f32 v29, v29, v41
    v_add_f32 v28, v28, v42
    v_add_f32 v29, v29, v43
    s_waitcnt vmcnt(8) lgkmcnt(4)
    v_mfma_f32_32x32x16_bf16 v[48:63], a[88:91], v[128:131], v[48:63]
    ds_read_b64_tr_b16 v[124:125], v3 offset:24576
    ds_read_b64_tr_b16 v[126:127], v3 offset:25088
    buffer_load_dwordx4 a[124:127], v0, s[8:11], s68 offen offset:3072 sc1
    v_mfma_f32_32x32x16_bf16 v[64:79], a[88:91], v[112:115], v[64:79]
    ds_read_b64_tr_b16 v[128:129], v3 offset:57344
    ds_read_b64_tr_b16 v[130:131], v3 offset:57856
    v_mov_b32 v30, v28
    v_mov_b32 v31, v29
    v_mov_b32 v18, 0
    s_waitcnt vmcnt(8) lgkmcnt(4)
    v_mfma_f32_32x32x16_bf16 v[48:63], a[92:95], v[116:119], v[48:63]
    ds_read_b64_tr_b16 v[112:113], v3 offset:25600
    ds_read_b64_tr_b16 v[114:115], v3 offset:26112
    v_mov_b32 v19, 0
    v_permlane32_swap_b32 v28, v30
    v_permlane32_swap_b32 v29, v31
    v_mfma_f32_32x32x16_bf16 v[64:79], a[92:95], v[120:123], v[64:79]
    ds_read_b64_tr_b16 v[116:117], v3 offset:58368
    ds_read_b64_tr_b16 v[118:119], v3 offset:58880
    v_mov_b32 v32, 0
    v_add_f32 v28, v28, v30
    v_add_f32 v29, v29, v31
    s_waitcnt vmcnt(7) lgkmcnt(4)
    v_mfma_f32_32x32x16_bf16 v[48:63], a[96:99], v[124:127], v[48:63]
    ds_read_b64_tr_b16 v[120:121], v3 offset:26624
    ds_read_b64_tr_b16 v[122:123], v3 offset:27136
    v_mul_f32 v28, 0x3b000000, v28
    v_mul_f32 v29, 0x3b000000, v29
    v_fma_f32 v29, -v28, v28, v29
    v_mfma_f32_32x32x16_bf16 v[64:79], a[96:99], v[128:131], v[64:79]
    ds_read_b64_tr_b16 v[124:125], v3 offset:59392
    ds_read_b64_tr_b16 v[126:127], v3 offset:59904
    v_cvt_pk_bf16_f32 v16, v28, v28
    v_max_f32 v29, 0, v29
    v_and_b32 v30, 0xffff0000, v16
    s_waitcnt vmcnt(6) lgkmcnt(4)
    v_mfma_f32_32x32x16_bf16 v[48:63], a[100:103], v[112:115], v[48:63]
    ds_read_b64_tr_b16 v[128:129], v3 offset:27648
    ds_read_b64_tr_b16 v[130:131], v3 offset:28160
    v_add_f32 v27, 0x3727c5ac, v29
    v_sub_f32 v30, v28, v30
    v_rsq_f32 v24, v27
    v_mfma_f32_32x32x16_bf16 v[64:79], a[100:103], v[116:119], v[64:79]
    ds_read_b64_tr_b16 v[112:113], v3 offset:60416
    ds_read_b64_tr_b16 v[114:115], v3 offset:60928
    v_cvt_pk_bf16_f32 v17, v30, v32
    v_cndmask_b32_e64 v16, v16, 0, s[32:33]
    v_cndmask_b32_e64 v17, v17, 0, s[32:33]
    s_waitcnt vmcnt(5) lgkmcnt(4)
    v_mfma_f32_32x32x16_bf16 v[48:63], a[104:107], v[120:123], v[48:63]
    ds_read_b64_tr_b16 v[116:117], v3 offset:28672
    ds_read_b64_tr_b16 v[118:119], v3 offset:29184
    v_mul_f32 v32, 0x3fb8aa3b, v24
    ds_write_b32 v21, v32
    s_waitcnt lgkmcnt(0)
    v_mfma_f32_32x32x16_bf16 v[64:79], a[104:107], v[124:127], v[64:79]
    ds_read_b64_tr_b16 v[120:121], v3 offset:61440
    ds_read_b64_tr_b16 v[122:123], v3 offset:61952
    ds_read_b128 v[80:83], v20 offset:0
    ds_read_b128 v[84:87], v20 offset:32
    ds_read_b128 v[88:91], v20 offset:64
    s_waitcnt vmcnt(4)
    v_mfma_f32_32x32x16_bf16 v[48:63], a[108:111], v[128:131], v[48:63]
    ds_read_b64_tr_b16 v[124:125], v3 offset:29696
    ds_read_b64_tr_b16 v[126:127], v3 offset:30208
    ds_read_b128 v[92:95], v20 offset:96
    v_mfma_f32_32x32x16_bf16 v[64:79], a[108:111], v[112:115], v[64:79]
    ds_read_b64_tr_b16 v[128:129], v3 offset:62464
    ds_read_b64_tr_b16 v[130:131], v3 offset:62976
    s_waitcnt vmcnt(3)
    v_mfma_f32_32x32x16_bf16 v[48:63], a[112:115], v[116:119], v[48:63]
    ds_read_b64_tr_b16 v[112:113], v3 offset:30720
    ds_read_b64_tr_b16 v[114:115], v3 offset:31232
    s_waitcnt lgkmcnt(5)
    v_mfma_f32_32x32x16_bf16 v[64:79], a[112:115], v[120:123], v[64:79]
    ds_read_b64_tr_b16 v[116:117], v3 offset:63488
    ds_read_b64_tr_b16 v[118:119], v3 offset:64000
    s_waitcnt vmcnt(2)
    v_mfma_f32_32x32x16_bf16 v[48:63], a[116:119], v[124:127], v[48:63]
    ds_read_b64_tr_b16 v[120:121], v3 offset:31744
    ds_read_b64_tr_b16 v[122:123], v3 offset:32256
    s_waitcnt lgkmcnt(4)
    v_mfma_f32_32x32x16_bf16 v[64:79], a[116:119], v[128:131], v[64:79]
    ds_read_b64_tr_b16 v[124:125], v3 offset:64512
    ds_read_b64_tr_b16 v[126:127], v3 offset:65024
    s_waitcnt vmcnt(1)
    v_mfma_f32_32x32x16_bf16 v[48:63], a[120:123], v[112:115], v[48:63]
    ds_read_b128 v[128:131], v1 offset:32768
    s_waitcnt lgkmcnt(3)
    v_mfma_f32_32x32x16_bf16 v[64:79], a[120:123], v[116:119], v[64:79]
    ds_read_b128 v[112:115], v1 offset:33792
    s_waitcnt vmcnt(0)
    v_mfma_f32_32x32x16_bf16 v[48:63], a[124:127], v[120:123], v[48:63]
    s_waitcnt lgkmcnt(1)
    v_mfma_f32_32x32x16_bf16 v[64:79], a[124:127], v[124:127], v[64:79]
    v_mfma_f32_32x32x16_bf16 v[48:63], v[16:19], v[128:131], v[48:63]
    s_waitcnt lgkmcnt(0)
    v_mfma_f32_32x32x16_bf16 v[64:79], v[16:19], v[112:115], v[64:79]
    s_nop 9
    v_mul_f32 v48, v48, v80
    v_mul_f32 v49, v49, v81
    v_mul_f32 v50, v50, v82
    v_mul_f32 v51, v51, v83
    v_mul_f32 v52, v52, v84
    v_mul_f32 v53, v53, v85
    v_mul_f32 v54, v54, v86
    v_mul_f32 v55, v55, v87
    v_mul_f32 v56, v56, v88
    v_mul_f32 v57, v57, v89
    v_mul_f32 v58, v58, v90
    v_mul_f32 v59, v59, v91
    v_mul_f32 v60, v60, v92
    v_mul_f32 v61, v61, v93
    v_mul_f32 v62, v62, v94
    v_mul_f32 v63, v63, v95
    v_mul_f32 v64, v64, v80
    v_mul_f32 v65, v65, v81
    v_mul_f32 v66, v66, v82
    v_mul_f32 v67, v67, v83
    v_mul_f32 v68, v68, v84
    v_mul_f32 v69, v69, v85
    v_mul_f32 v70, v70, v86
    v_mul_f32 v71, v71, v87
    v_mul_f32 v72, v72, v88
    v_mul_f32 v73, v73, v89
    v_mul_f32 v74, v74, v90
    v_mul_f32 v75, v75, v91
    v_mul_f32 v76, v76, v92
    v_mul_f32 v77, v77, v93
    v_mul_f32 v78, v78, v94
    v_mul_f32 v79, v79, v95
    v_exp_f32_e64 v80, v48 clamp
    v_max_f32 v48, 0, v48
    v_exp_f32_e64 v81, v49 clamp
    v_max_f32 v49, 0, v49
    v_exp_f32_e64 v82, v50 clamp
    v_max_f32 v50, 0, v50
    v_exp_f32_e64 v83, v51 clamp
    v_max_f32 v51, 0, v51
    v_exp_f32_e64 v84, v52 clamp
    v_max_f32 v52, 0, v52
    v_exp_f32_e64 v85, v53 clamp
    v_max_f32 v53, 0, v53
    v_exp_f32_e64 v86, v54 clamp
    v_max_f32 v54, 0, v54
    v_exp_f32_e64 v87, v55 clamp
    v_max_f32 v55, 0, v55
    v_exp_f32_e64 v88, v56 clamp
    v_max_f32 v56, 0, v56
    v_exp_f32_e64 v89, v57 clamp
    v_max_f32 v57, 0, v57
    v_exp_f32_e64 v90, v58 clamp
    v_max_f32 v58, 0, v58
    v_exp_f32_e64 v91, v59 clamp
    v_max_f32 v59, 0, v59
    v_exp_f32_e64 v92, v60 clamp
    v_max_f32 v60, 0, v60
    v_exp_f32_e64 v93, v61 clamp
    v_max_f32 v61, 0, v61
    v_exp_f32_e64 v94, v62 clamp
    v_max_f32 v62, 0, v62
    v_exp_f32_e64 v95, v63 clamp
    v_max_f32 v63, 0, v63
    v_cvt_pk_bf16_f32 v36, v64, v65
    v_cvt_pk_bf16_f32 v37, v66, v67
    v_cvt_pk_bf16_f32 v38, v68, v69
    v_cvt_pk_bf16_f32 v39, v70, v71
    v_cvt_pk_bf16_f32 v40, v72, v73
    v_cvt_pk_bf16_f32 v41, v74, v75
    v_cvt_pk_bf16_f32 v42, v76, v77
    v_cvt_pk_bf16_f32 v43, v78, v79
    v_fma_f32 v48, v48, s37, v80
    v_fma_f32 v49, v49, s37, v81
    v_fma_f32 v50, v50, s37, v82
    v_fma_f32 v51, v51, s37, v83
    v_fma_f32 v52, v52, s37, v84
    v_fma_f32 v53, v53, s37, v85
    v_fma_f32 v54, v54, s37, v86
    v_fma_f32 v55, v55, s37, v87
    v_fma_f32 v56, v56, s37, v88
    v_fma_f32 v57, v57, s37, v89
    v_fma_f32 v58, v58, s37, v90
    v_fma_f32 v59, v59, s37, v91
    v_fma_f32 v60, v60, s37, v92
    v_fma_f32 v61, v61, s37, v93
    v_fma_f32 v62, v62, s37, v94
    v_fma_f32 v63, v63, s37, v95
    v_add_f32 v48, s38, v48
    v_add_f32 v49, s38, v49
    v_add_f32 v50, s38, v50
    v_add_f32 v51, s38, v51
    v_add_f32 v52, s38, v52
    v_add_f32 v53, s38, v53
    v_add_f32 v54, s38, v54
    v_add_f32 v55, s38, v55
    v_add_f32 v56, s38, v56
    v_add_f32 v57, s38, v57
    v_add_f32 v58, s38, v58
    v_add_f32 v59, s38, v59
    v_add_f32 v60, s38, v60
    v_add_f32 v61, s38, v61
    v_add_f32 v62, s38, v62
    v_add_f32 v63, s38, v63
    v_mov_b32 v44, 0x3f803f80
    v_mov_b32 v45, 0x3f803f80
    v_mov_b32 v46, 0x3f803f80
    v_mov_b32 v47, 0x3f803f80
    v_cvt_pk_bf16_f32 v28, v48, v49
    v_cvt_pk_bf16_f32 v29, v50, v51
    v_cvt_pk_bf16_f32 v30, v52, v53
    v_cvt_pk_bf16_f32 v31, v54, v55
    v_cvt_pk_bf16_f32 v32, v56, v57
    v_cvt_pk_bf16_f32 v33, v58, v59
    v_cvt_pk_bf16_f32 v34, v60, v61
    v_cvt_pk_bf16_f32 v35, v62, v63
    s_mul_i32 s40, s18, 2304
    v_add_u32 v6, s40, v4
    v_mfma_f32_32x32x16_bf16 v[48:63], v[28:31], v[36:39], 0
    v_mfma_f32_32x32x16_bf16 v[64:79], v[44:47], v[28:31], 0
    v_mfma_f32_32x32x16_bf16 v[48:63], v[32:35], v[40:43], v[48:63]
    v_mfma_f32_32x32x16_bf16 v[64:79], v[44:47], v[32:35], v[64:79]
    v_lshrrev_b32 v7, 2, v0
    s_add_u32 s41, s40, 101376
    v_add_u32 v7, s41, v7
    s_nop 7
    v_cndmask_b32_e64 v80, v48, v56, s[30:31]
    v_cndmask_b32_e64 v81, v49, v57, s[30:31]
    v_cndmask_b32_e64 v82, v50, v58, s[30:31]
    v_cndmask_b32_e64 v83, v51, v59, s[30:31]
    v_cndmask_b32_e64 v84, v52, v60, s[30:31]
    v_cndmask_b32_e64 v85, v53, v61, s[30:31]
    v_cndmask_b32_e64 v86, v54, v62, s[30:31]
    v_cndmask_b32_e64 v87, v55, v63, s[30:31]
    ds_write_b128 v6, v[80:83] offset:49152
    ds_write_b128 v6, v[84:87] offset:50176
    ds_write_b32 v7, v64 offset:51200
    s_waitcnt lgkmcnt(0)
    s_barrier
    s_cmp_ge_u32 s18, 2
    s_cbranch_scc1 kd201
    s_cmp_eq_u32 s18, 1
    s_cbranch_scc1 kz200
    ds_read_b128 v[48:51], v4 offset:49152
    ds_read_b128 v[52:55], v4 offset:50176
    ds_read_b128 v[56:59], v4 offset:51456
    ds_read_b128 v[60:63], v4 offset:52480
    ds_read_b128 v[64:67], v4 offset:53760
    ds_read_b128 v[68:71], v4 offset:54784
    ds_read_b128 v[72:75], v4 offset:56064
    ds_read_b128 v[76:79], v4 offset:57088
    s_waitcnt lgkmcnt(0)
    v_add_f32 v48, v48, v56
    v_add_f32 v64, v64, v72
    v_add_f32 v49, v49, v57
    v_add_f32 v65, v65, v73
    v_add_f32 v50, v50, v58
    v_add_f32 v66, v66, v74
    v_add_f32 v51, v51, v59
    v_add_f32 v67, v67, v75
    v_add_f32 v52, v52, v60
    v_add_f32 v68, v68, v76
    v_add_f32 v53, v53, v61
    v_add_f32 v69, v69, v77
    v_add_f32 v54, v54, v62
    v_add_f32 v70, v70, v78
    v_add_f32 v55, v55, v63
    v_add_f32 v71, v71, v79
    v_add_f32 v48, v48, v64
    v_add_f32 v49, v49, v65
    v_add_f32 v50, v50, v66
    v_add_f32 v51, v51, v67
    v_add_f32 v52, v52, v68
    v_add_f32 v53, v53, v69
    v_add_f32 v54, v54, v70
    v_add_f32 v55, v55, v71
    v_cvt_pk_bf16_f32 v56, v48, v49
    v_cvt_pk_bf16_f32 v57, v50, v51
    v_cvt_pk_bf16_f32 v58, v52, v53
    v_cvt_pk_bf16_f32 v59, v54, v55
    buffer_store_dwordx4 v[56:59], v0, s[8:11], s35 offen sc1
    s_branch kd201
kz200:
    v_lshrrev_b32 v7, 2, v0
    v_add_u32 v6, 101376, v7
    ds_read_b32 v48, v6 offset:51200
    ds_read_b32 v49, v6 offset:53504
    ds_read_b32 v50, v6 offset:55808
    ds_read_b32 v51, v6 offset:58112
    s_waitcnt lgkmcnt(0)
    v_add_f32 v48, v48, v49
    v_add_f32 v50, v50, v51
    v_add_f32 v48, v48, v50
    s_mov_b64 exec, 0xffffffff
    buffer_store_dword v48, v7, s[8:11], s35 offen offset:1024 sc1
    s_mov_b64 exec, -1
kd201:
    s_barrier
    v_add_u32 v153, 0x10000, v3
    ds_read_b64_tr_b16 v[112:113], v153 offset:0
    ds_read_b64_tr_b16 v[114:115], v153 offset:512
    ds_read_b64_tr_b16 v[116:117], v153 offset:1024
    ds_read_b64_tr_b16 v[118:119], v153 offset:1536
    ds_read_b64_tr_b16 v[120:121], v153 offset:2048
    ds_read_b64_tr_b16 v[122:123], v153 offset:2560
    ds_read_b64_tr_b16 v[124:125], v153 offset:3072
    ds_read_b64_tr_b16 v[126:127], v153 offset:3584
    s_waitcnt lgkmcnt(4)
    v_mfma_f32_32x32x16_bf16 v[96:111], v[112:115], a[0:3], 0
    ds_read_b64_tr_b16 v[128:129], v153 offset:4096
    ds_read_b64_tr_b16 v[130:131], v153 offset:4608
    v_mfma_f32_32x32x16_bf16 v[96:111], v[116:119], a[4:7], v[96:111]
    ds_read_b64_tr_b16 v[112:113], v153 offset:5120
    ds_read_b64_tr_b16 v[114:115], v153 offset:5632
    s_bitcmp1_b32 s16, 0
    s_cbranch_scc1 po203
    s_add_u32 m0, s60, 0
    s_add_u32 s42, s61, 101376
    buffer_load_dwordx4 v0, s[8:11], s42 offen offset:0 lds
    buffer_load_dwordx4 v0, s[8:11], s42 offen offset:1024 lds
    buffer_load_dwordx4 v0, s[8:11], s42 offen offset:2048 lds
    buffer_load_dwordx4 v0, s[8:11], s42 offen offset:3072 lds
    s_add_u32 m0, s60, 4096
    s_add_u32 s42, s61, 105472
    buffer_load_dwordx4 v0, s[8:11], s42 offen offset:0 lds
    buffer_load_dwordx4 v0, s[8:11], s42 offen offset:1024 lds
    buffer_load_dwordx4 v0, s[8:11], s42 offen offset:2048 lds
    buffer_load_dwordx4 v0, s[8:11], s42 offen offset:3072 lds
    s_branch pd204
po203:
    s_lshl_b32 s43, s18, 12
    s_add_u32 s43, s43, s26
    s_add_u32 s43, s43, 134144
    v_lshlrev_b32 v154, 3, v0
    s_mov_b64 exec, 0xffffffff
    buffer_load_dword v152, v154, s[8:11], s43 offen
    s_mov_b64 exec, -1
pd204:
    s_waitcnt lgkmcnt(4)
    v_mfma_f32_32x32x16_bf16 v[96:111], v[120:123], a[8:11], v[96:111]
    ds_read_b64_tr_b16 v[116:117], v153 offset:6144
    ds_read_b64_tr_b16 v[118:119], v153 offset:6656
    v_mfma_f32_32x32x16_bf16 v[96:111], v[124:127], a[12:15], v[96:111]
    ds_read_b64_tr_b16 v[120:121], v153 offset:7168
    ds_read_b64_tr_b16 v[122:123], v153 offset:7680
    s_waitcnt lgkmcnt(4)
    v_mfma_f32_32x32x16_bf16 v[96:111], v[128:131], a[16:19], v[96:111]
    ds_read_b64_tr_b16 v[124:125], v153 offset:8192
    ds_read_b64_tr_b16 v[126:127], v153 offset:8704
    v_mfma_f32_32x32x16_bf16 v[96:111], v[112:115], a[20:23], v[96:111]
    ds_read_b64_tr_b16 v[128:129], v153 offset:9216
    ds_read_b64_tr_b16 v[130:131], v153 offset:9728
    s_waitcnt lgkmcnt(4)
    v_mfma_f32_32x32x16_bf16 v[96:111], v[116:119], a[24:27], v[96:111]
    ds_read_b64_tr_b16 v[112:113], v153 offset:10240
    ds_read_b64_tr_b16 v[114:115], v153 offset:10752
    v_mfma_f32_32x32x16_bf16 v[96:111], v[120:123], a[28:31], v[96:111]
    ds_read_b64_tr_b16 v[116:117], v153 offset:11264
    ds_read_b64_tr_b16 v[118:119], v153 offset:11776
    s_waitcnt lgkmcnt(4)
    v_mfma_f32_32x32x16_bf16 v[96:111], v[124:127], a[32:35], v[96:111]
    ds_read_b64_tr_b16 v[120:121], v153 offset:12288
    ds_read_b64_tr_b16 v[122:123], v153 offset:12800
    v_mfma_f32_32x32x16_bf16 v[96:111], v[128:131], a[36:39], v[96:111]
    ds_read_b64_tr_b16 v[124:125], v153 offset:13312
    ds_read_b64_tr_b16 v[126:127], v153 offset:13824
    s_waitcnt lgkmcnt(4)
    v_mfma_f32_32x32x16_bf16 v[96:111], v[112:115], a[40:43], v[96:111]
    ds_read_b64_tr_b16 v[128:129], v153 offset:14336
    ds_read_b64_tr_b16 v[130:131], v153 offset:14848
    v_mfma_f32_32x32x16_bf16 v[96:111], v[116:119], a[44:47], v[96:111]
    ds_read_b64_tr_b16 v[112:113], v153 offset:15360
    ds_read_b64_tr_b16 v[114:115], v153 offset:15872
    s_waitcnt lgkmcnt(4)
    v_mfma_f32_32x32x16_bf16 v[96:111], v[120:123], a[48:51], v[96:111]
    ds_read_b64_tr_b16 v[116:117], v153 offset:16384
    ds_read_b64_tr_b16 v[118:119], v153 offset:16896
    v_mfma_f32_32x32x16_bf16 v[96:111], v[124:127], a[52:55], v[96:111]
    ds_read_b64_tr_b16 v[120:121], v153 offset:17408
    ds_read_b64_tr_b16 v[122:123], v153 offset:17920
    s_waitcnt lgkmcnt(4)
    v_mfma_f32_32x32x16_bf16 v[96:111], v[128:131], a[56:59], v[96:111]
    ds_read_b64_tr_b16 v[124:125], v153 offset:18432
    ds_read_b64_tr_b16 v[126:127], v153 offset:18944
    v_mfma_f32_32x32x16_bf16 v[96:111], v[112:115], a[60:63], v[96:111]
    ds_read_b64_tr_b16 v[128:129], v153 offset:19456
    ds_read_b64_tr_b16 v[130:131], v153 offset:19968
    s_waitcnt lgkmcnt(4)
    v_mfma_f32_32x32x16_bf16 v[96:111], v[116:119], a[64:67], v[96:111]
    ds_read_b64_tr_b16 v[112:113], v153 offset:20480
    ds_read_b64_tr_b16 v[114:115], v153 offset:20992
    v_mfma_f32_32x32x16_bf16 v[96:111], v[120:123], a[68:71], v[96:111]
    ds_read_b64_tr_b16 v[116:117], v153 offset:21504
    ds_read_b64_tr_b16 v[118:119], v153 offset:22016
    s_waitcnt lgkmcnt(4)
    v_mfma_f32_32x32x16_bf16 v[96:111], v[124:127], a[72:75], v[96:111]
    ds_read_b64_tr_b16 v[120:121], v153 offset:22528
    ds_read_b64_tr_b16 v[122:123], v153 offset:23040
    v_mfma_f32_32x32x16_bf16 v[96:111], v[128:131], a[76:79], v[96:111]
    ds_read_b64_tr_b16 v[124:125], v153 offset:23552
    ds_read_b64_tr_b16 v[126:127], v153 offset:24064
    s_waitcnt lgkmcnt(4)
    v_mfma_f32_32x32x16_bf16 v[96:111], v[112:115], a[80:83], v[96:111]
    ds_read_b64_tr_b16 v[128:129], v153 offset:24576
    ds_read_b64_tr_b16 v[130:131], v153 offset:25088
    v_mfma_f32_32x32x16_bf16 v[96:111], v[116:119], a[84:87], v[96:111]
    ds_read_b64_tr_b16 v[112:113], v153 offset:25600
    ds_read_b64_tr_b16 v[114:115], v153 offset:26112
    s_waitcnt lgkmcnt(4)
    v_mfma_f32_32x32x16_bf16 v[96:111], v[120:123], a[88:91], v[96:111]
    ds_read_b64_tr_b16 v[116:117], v153 offset:26624
    ds_read_b64_tr_b16 v[118:119], v153 offset:27136
    v_mfma_f32_32x32x16_bf16 v[96:111], v[124:127], a[92:95], v[96:111]
    ds_read_b64_tr_b16 v[120:121], v153 offset:27648
    ds_read_b64_tr_b16 v[122:123], v153 offset:28160
    s_waitcnt lgkmcnt(4)
    v_mfma_f32_32x32x16_bf16 v[96:111], v[128:131], a[96:99], v[96:111]
    ds_read_b64_tr_b16 v[124:125], v153 offset:28672
    ds_read_b64_tr_b16 v[126:127], v153 offset:29184
    v_mfma_f32_32x32x16_bf16 v[96:111], v[112:115], a[100:103], v[96:111]
    ds_read_b64_tr_b16 v[128:129], v153 offset:29696
    ds_read_b64_tr_b16 v[130:131], v153 offset:30208
    s_waitcnt lgkmcnt(4)
    v_mfma_f32_32x32x16_bf16 v[96:111], v[116:119], a[104:107], v[96:111]
    ds_read_b64_tr_b16 v[112:113], v153 offset:30720
    ds_read_b64_tr_b16 v[114:115], v153 offset:31232
    v_mfma_f32_32x32x16_bf16 v[96:111], v[120:123], a[108:111], v[96:111]
    ds_read_b64_tr_b16 v[116:117], v153 offset:31744
    ds_read_b64_tr_b16 v[118:119], v153 offset:32256
    s_waitcnt lgkmcnt(4)
    v_mfma_f32_32x32x16_bf16 v[96:111], v[124:127], a[112:115], v[96:111]
    ds_read_b128 v[120:123], v1 offset:34816
    v_mfma_f32_32x32x16_bf16 v[96:111], v[128:131], a[116:119], v[96:111]
    s_waitcnt lgkmcnt(1)
    v_mfma_f32_32x32x16_bf16 v[96:111], v[112:115], a[120:123], v[96:111]
    v_mfma_f32_32x32x16_bf16 v[96:111], v[116:119], a[124:127], v[96:111]
    s_waitcnt lgkmcnt(0)
    v_mfma_f32_32x32x16_bf16 v[96:111], v[120:123], v[16:19], v[96:111]
    s_bitcmp1_b32 s16, 0
    s_cbranch_scc1 po205
    s_lshl_b32 s43, s18, 12
    s_add_u32 s44, s43, 134144
    s_add_u32 s45, s43, s26
    s_add_u32 m0, s44, 0
    s_add_u32 s42, s45, 134144
    buffer_load_dwordx4 v0, s[8:11], s42 offen offset:0 lds
    buffer_load_dwordx4 v0, s[8:11], s42 offen offset:1024 lds
    buffer_load_dwordx4 v0, s[8:11], s42 offen offset:2048 lds
    buffer_load_dwordx4 v0, s[8:11], s42 offen offset:3072 lds
    s_branch pd206
po205:
    s_add_u32 m0, s60, 0
    s_add_u32 s42, s61, 101376
    buffer_load_dwordx4 v0, s[8:11], s42 offen offset:0 lds
    buffer_load_dwordx4 v0, s[8:11], s42 offen offset:1024 lds
    buffer_load_dwordx4 v0, s[8:11], s42 offen offset:2048 lds
    buffer_load_dwordx4 v0, s[8:11], s42 offen offset:3072 lds
    s_add_u32 m0, s60, 4096
    s_add_u32 s42, s61, 105472
    buffer_load_dwordx4 v0, s[8:11], s42 offen offset:0 lds
    buffer_load_dwordx4 v0, s[8:11], s42 offen offset:1024 lds
    buffer_load_dwordx4 v0, s[8:11], s42 offen offset:2048 lds
    buffer_load_dwordx4 v0, s[8:11], s42 offen offset:3072 lds
    s_lshl_b32 s43, s18, 12
    s_add_u32 s44, s43, 134144
    s_add_u32 s45, s43, s26
    s_add_u32 m0, s44, 0
    s_add_u32 s42, s45, 134144
    buffer_load_dwordx4 v0, s[8:11], s42 offen offset:0 lds
    buffer_load_dwordx4 v0, s[8:11], s42 offen offset:1024 lds
    buffer_load_dwordx4 v0, s[8:11], s42 offen offset:2048 lds
    buffer_load_dwordx4 v0, s[8:11], s42 offen offset:3072 lds
pd206:
    v_mul_f32 v28, 0x3fb8aa3b, v24
    v_mul_f32 v96, v96, v28
    v_mul_f32 v97, v97, v28
    v_mul_f32 v98, v98, v28
    v_mul_f32 v99, v99, v28
    v_mul_f32 v100, v100, v28
    v_mul_f32 v101, v101, v28
    v_mul_f32 v102, v102, v28
    v_mul_f32 v103, v103, v28
    v_mul_f32 v104, v104, v28
    v_mul_f32 v105, v105, v28
    v_mul_f32 v106, v106, v28
    v_mul_f32 v107, v107, v28
    v_mul_f32 v108, v108, v28
    v_mul_f32 v109, v109, v28
    v_mul_f32 v110, v110, v28
    v_mul_f32 v111, v111, v28
    v_exp_f32_e64 v80, v96 clamp
    v_max_f32 v96, 0, v96
    v_exp_f32_e64 v81, v97 clamp
    v_max_f32 v97, 0, v97
    v_exp_f32_e64 v82, v98 clamp
    v_max_f32 v98, 0, v98
    v_exp_f32_e64 v83, v99 clamp
    v_max_f32 v99, 0, v99
    v_exp_f32_e64 v84, v100 clamp
    v_max_f32 v100, 0, v100
    v_exp_f32_e64 v85, v101 clamp
    v_max_f32 v101, 0, v101
    v_exp_f32_e64 v86, v102 clamp
    v_max_f32 v102, 0, v102
    v_exp_f32_e64 v87, v103 clamp
    v_max_f32 v103, 0, v103
    v_exp_f32_e64 v88, v104 clamp
    v_max_f32 v104, 0, v104
    v_exp_f32_e64 v89, v105 clamp
    v_max_f32 v105, 0, v105
    v_exp_f32_e64 v90, v106 clamp
    v_max_f32 v106, 0, v106
    v_exp_f32_e64 v91, v107 clamp
    v_max_f32 v107, 0, v107
    v_exp_f32_e64 v92, v108 clamp
    v_max_f32 v108, 0, v108
    v_exp_f32_e64 v93, v109 clamp
    v_max_f32 v109, 0, v109
    v_exp_f32_e64 v94, v110 clamp
    v_max_f32 v110, 0, v110
    v_exp_f32_e64 v95, v111 clamp
    v_max_f32 v111, 0, v111
    v_fma_f32 v96, v96, s37, v80
    v_fma_f32 v97, v97, s37, v81
    v_fma_f32 v98, v98, s37, v82
    v_fma_f32 v99, v99, s37, v83
    v_fma_f32 v100, v100, s37, v84
    v_fma_f32 v101, v101, s37, v85
    v_fma_f32 v102, v102, s37, v86
    v_fma_f32 v103, v103, s37, v87
    v_fma_f32 v104, v104, s37, v88
    v_fma_f32 v105, v105, s37, v89
    v_fma_f32 v106, v106, s37, v90
    v_fma_f32 v107, v107, s37, v91
    v_fma_f32 v108, v108, s37, v92
    v_fma_f32 v109, v109, s37, v93
    v_fma_f32 v110, v110, s37, v94
    v_fma_f32 v111, v111, s37, v95
    v_add_f32 v96, s38, v96
    v_add_f32 v97, s38, v97
    v_add_f32 v98, s38, v98
    v_add_f32 v99, s38, v99
    v_add_f32 v100, s38, v100
    v_add_f32 v101, s38, v101
    v_add_f32 v102, s38, v102
    v_add_f32 v103, s38, v103
    v_add_f32 v104, s38, v104
    v_add_f32 v105, s38, v105
    v_add_f32 v106, s38, v106
    v_add_f32 v107, s38, v107
    v_add_f32 v108, s38, v108
    v_add_f32 v109, s38, v109
    v_add_f32 v110, s38, v110
    v_add_f32 v111, s38, v111
    v_cvt_pk_bf16_f32 v132, v96, v97
    v_cvt_pk_bf16_f32 v133, v98, v99
    v_cvt_pk_bf16_f32 v134, v100, v101
    v_cvt_pk_bf16_f32 v135, v102, v103
    v_cvt_pk_bf16_f32 v136, v104, v105
    v_cvt_pk_bf16_f32 v137, v106, v107
    v_cvt_pk_bf16_f32 v138, v108, v109
    v_cvt_pk_bf16_f32 v139, v110, v111
main_s1_fast:
    v_lshrrev_b32 v7, 2, v0
    v_and_b32 v6, 0x7f, v7
    v_mov_b32 v28, v6
s1r207:
    s_add_u32 s40, s36, 0
    buffer_load_dwordx4 v[64:67], v0, s[8:11], s40 offen sc1
    buffer_load_dword v80, v28, s[8:11], s40 offen offset:1024 sc1
    s_add_u32 s40, s36, 4096
    buffer_load_dwordx4 v[68:71], v0, s[8:11], s40 offen sc1
    buffer_load_dword v81, v28, s[8:11], s40 offen offset:1024 sc1
    s_add_u32 s40, s36, 8192
    buffer_load_dwordx4 v[72:75], v0, s[8:11], s40 offen sc1
    buffer_load_dword v82, v28, s[8:11], s40 offen offset:1024 sc1
    s_add_u32 s40, s36, 12288
    buffer_load_dwordx4 v[76:79], v0, s[8:11], s40 offen sc1
    buffer_load_dword v83, v28, s[8:11], s40 offen offset:1024 sc1
    s_waitcnt vmcnt(0)
    v_max3_u32 v6, v64, v65, v66
    v_max3_u32 v6, v6, v67, v68
    v_max3_u32 v6, v6, v69, v70
    v_max3_u32 v6, v6, v71, v72
    v_max3_u32 v6, v6, v73, v74
    v_max3_u32 v6, v6, v75, v76
    v_max3_u32 v6, v6, v77, v78
    v_max3_u32 v6, v6, v79, v80
    v_max3_u32 v6, v6, v81, v82
    v_max_u32 v6, v6, v83
    v_cmp_eq_u32 vcc, -1, v6
    s_cmp_eq_u32 s34, 0
    s_cbranch_scc1 s1ok208
    s_sub_u32 s34, s34, 1
    s_cbranch_vccnz s1r207
s1ok208:
    s_and_b32 s43, s16, 1
    s_mul_i32 s43, s43, 22528
    s_mul_i32 s44, s18, 5632
    s_add_u32 s43, s43, s44
    s_add_u32 s43, s43, s26
    s_add_u32 s43, s43, 150528
    v_lshlrev_b32 v155, 3, v0
    s_mov_b32 exec_hi, 0xfff
    buffer_load_dword v152, v155, s[8:11], s43 offen
    s_mov_b64 exec, -1
    v_lshlrev_b32 v48, 16, v64
    v_and_b32 v49, 0xffff0000, v64
    v_lshlrev_b32 v50, 16, v65
    v_and_b32 v51, 0xffff0000, v65
    v_lshlrev_b32 v52, 16, v66
    v_and_b32 v53, 0xffff0000, v66
    v_lshlrev_b32 v54, 16, v67
    v_and_b32 v55, 0xffff0000, v67
    v_lshlrev_b32 v56, 16, v68
    v_and_b32 v57, 0xffff0000, v68
    v_lshlrev_b32 v58, 16, v69
    v_and_b32 v59, 0xffff0000, v69
    v_lshlrev_b32 v60, 16, v70
    v_and_b32 v61, 0xffff0000, v70
    v_lshlrev_b32 v62, 16, v71
    v_and_b32 v63, 0xffff0000, v71
    v_add_f32 v48, v48, v56
    v_add_f32 v49, v49, v57
    v_add_f32 v50, v50, v58
    v_add_f32 v51, v51, v59
    v_add_f32 v52, v52, v60
    v_add_f32 v53, v53, v61
    v_add_f32 v54, v54, v62
    v_add_f32 v55, v55, v63
    v_lshlrev_b32 v56, 16, v72
    v_and_b32 v57, 0xffff0000, v72
    v_lshlrev_b32 v58, 16, v73
    v_and_b32 v59, 0xffff0000, v73
    v_lshlrev_b32 v60, 16, v74
    v_and_b32 v61, 0xffff0000, v74
    v_lshlrev_b32 v62, 16, v75
    v_and_b32 v63, 0xffff0000, v75
    v_add_f32 v48, v48, v56
    v_add_f32 v49, v49, v57
    v_add_f32 v50, v50, v58
    v_add_f32 v51, v51, v59
    v_add_f32 v52, v52, v60
    v_add_f32 v53, v53, v61
    v_add_f32 v54, v54, v62
    v_add_f32 v55, v55, v63
    v_lshlrev_b32 v56, 16, v76
    v_and_b32 v57, 0xffff0000, v76
    v_lshlrev_b32 v58, 16, v77
    v_and_b32 v59, 0xffff0000, v77
    v_lshlrev_b32 v60, 16, v78
    v_and_b32 v61, 0xffff0000, v78
    v_lshlrev_b32 v62, 16, v79
    v_and_b32 v63, 0xffff0000, v79
    v_add_f32 v48, v48, v56
    v_add_f32 v49, v49, v57
    v_add_f32 v50, v50, v58
    v_add_f32 v51, v51, v59
    v_add_f32 v52, v52, v60
    v_add_f32 v53, v53, v61
    v_add_f32 v54, v54, v62
    v_add_f32 v55, v55, v63
    v_add_f32 v80, v80, v81
    v_add_f32 v82, v82, v83
    v_add_f32 v80, v80, v82
    s_mul_i32 s40, s18, 2304
    v_add_u32 v6, s40, v4
    s_add_u32 s41, s40, 101376
    v_add_u32 v7, s41, v7
    ds_write_b128 v6, v[48:51] offset:49152
    ds_write_b128 v6, v[52:55] offset:50176
    ds_write_b32 v7, v80 offset:51200
    s_waitcnt lgkmcnt(0)
    s_barrier
    ds_read_b128 v[48:51], v4 offset:49152
    ds_read_b128 v[52:55], v4 offset:50176
    ds_read_b128 v[56:59], v4 offset:51456
    ds_read_b128 v[60:63], v4 offset:52480
    ds_read_b128 v[64:67], v4 offset:53760
    ds_read_b128 v[68:71], v4 offset:54784
    ds_read_b128 v[72:75], v4 offset:56064
    ds_read_b128 v[76:79], v4 offset:57088
    ds_read_b128 v[112:115], v23 offset:51200
    ds_read_b128 v[116:119], v23 offset:51232
    ds_read_b128 v[120:123], v23 offset:53504
    ds_read_b128 v[124:127], v23 offset:53536
    ds_read_b128 v[128:131], v23 offset:55808
    ds_read_b128 v[44:47], v23 offset:55840
    ds_read_b128 v[28:31], v23 offset:58112
    ds_read_b128 v[32:35], v23 offset:58144
    s_waitcnt lgkmcnt(8)
    v_add_f32 v48, v48, v56
    v_add_f32 v64, v64, v72
    v_add_f32 v49, v49, v57
    v_add_f32 v65, v65, v73
    v_add_f32 v50, v50, v58
    v_add_f32 v66, v66, v74
    v_add_f32 v51, v51, v59
    v_add_f32 v67, v67, v75
    v_add_f32 v52, v52, v60
    v_add_f32 v68, v68, v76
    v_add_f32 v53, v53, v61
    v_add_f32 v69, v69, v77
    v_add_f32 v54, v54, v62
    v_add_f32 v70, v70, v78
    v_add_f32 v55, v55, v63
    v_add_f32 v71, v71, v79
    v_add_f32 v48, v48, v64
    v_add_f32 v49, v49, v65
    v_add_f32 v50, v50, v66
    v_add_f32 v51, v51, v67
    v_add_f32 v52, v52, v68
    v_add_f32 v53, v53, v69
    v_add_f32 v54, v54, v70
    v_add_f32 v55, v55, v71
    s_waitcnt lgkmcnt(0)
    s_barrier
    s_cmp_lg_u32 s71, 0
    s_cbranch_scc1 main_mode_slow
    v_add_f32 v112, v112, v120
    v_add_f32 v116, v116, v124
    v_add_f32 v128, v128, v28
    v_add_f32 v44, v44, v32
    v_add_f32 v113, v113, v121
    v_add_f32 v117, v117, v125
    v_add_f32 v129, v129, v29
    v_add_f32 v45, v45, v33
    v_add_f32 v114, v114, v122
    v_add_f32 v118, v118, v126
    v_add_f32 v130, v130, v30
    v_add_f32 v46, v46, v34
    v_add_f32 v115, v115, v123
    v_add_f32 v119, v119, v127
    v_add_f32 v131, v131, v31
    v_add_f32 v47, v47, v35
    v_cvt_pk_bf16_f32 v36, v48, v49
    v_cvt_pk_bf16_f32 v37, v50, v51
    v_cvt_pk_bf16_f32 v38, v52, v53
    v_cvt_pk_bf16_f32 v39, v54, v55
    v_add_f32 v112, v112, v128
    v_add_f32 v116, v116, v44
    v_add_f32 v113, v113, v129
    v_add_f32 v117, v117, v45
    v_add_f32 v114, v114, v130
    v_add_f32 v118, v118, v46
    v_add_f32 v115, v115, v131
    v_add_f32 v119, v119, v47
    v_cndmask_b32_e64 v80, v36, 0, s[30:31]
    v_cndmask_b32_e64 v84, 0, v36, s[30:31]
    v_cndmask_b32_e64 v81, v37, 0, s[30:31]
    v_cndmask_b32_e64 v85, 0, v37, s[30:31]
    v_cndmask_b32_e64 v82, v38, 0, s[30:31]
    v_cndmask_b32_e64 v86, 0, v38, s[30:31]
    v_cndmask_b32_e64 v83, v39, 0, s[30:31]
    v_cndmask_b32_e64 v87, 0, v39, s[30:31]
    v_cvt_pk_bf16_f32 v40, v112, v113
    v_cvt_pk_bf16_f32 v41, v114, v115
    v_cvt_pk_bf16_f32 v42, v116, v117
    v_cvt_pk_bf16_f32 v43, v118, v119
    v_mfma_f32_32x32x16_bf16 v[48:63], v[80:83], v[132:135], 0
    v_cndmask_b32_e64 v88, v40, 0, s[30:31]
    v_cndmask_b32_e64 v92, 0, v40, s[30:31]
    v_cndmask_b32_e64 v89, v41, 0, s[30:31]
    v_cndmask_b32_e64 v93, 0, v41, s[30:31]
    v_cndmask_b32_e64 v90, v42, 0, s[30:31]
    v_cndmask_b32_e64 v94, 0, v42, s[30:31]
    v_cndmask_b32_e64 v91, v43, 0, s[30:31]
    v_cndmask_b32_e64 v95, 0, v43, s[30:31]
    v_mfma_f32_32x32x16_bf16 v[48:63], v[84:87], v[136:139], v[48:63]
    v_mfma_f32_32x32x16_bf16 v[64:79], v[88:91], v[132:135], 0
    v_mfma_f32_32x32x16_bf16 v[64:79], v[92:95], v[136:139], v[64:79]
    s_lshl_b32 s40, s17, 11
    s_add_u32 s40, s40, s21
    s_nop 9
    v_add_f32 v28, s38, v64
    v_add_f32 v29, s38, v72
    v_rcp_f32 v28, v28
    v_rcp_f32 v29, v29
    v_mul_f32 v28, s37, v28
    v_mul_f32 v29, s37, v29
    v_mul_f32 v48, v48, v28
    v_mul_f32 v49, v49, v28
    v_mul_f32 v50, v50, v28
    v_mul_f32 v51, v51, v28
    v_mul_f32 v52, v52, v28
    v_mul_f32 v53, v53, v28
    v_mul_f32 v54, v54, v28
    v_mul_f32 v55, v55, v28
    v_cvt_pk_bf16_f32 v36, v48, v49
    v_cvt_pk_bf16_f32 v37, v50, v51
    v_cvt_pk_bf16_f32 v38, v52, v53
    v_cvt_pk_bf16_f32 v39, v54, v55
    buffer_store_dwordx4 v[36:39], v0, s[8:11], s40 offen
    v_mul_f32 v56, v56, v29
    v_mul_f32 v57, v57, v29
    v_mul_f32 v58, v58, v29
    v_mul_f32 v59, v59, v29
    v_mul_f32 v60, v60, v29
    v_mul_f32 v61, v61, v29
    v_mul_f32 v62, v62, v29
    v_mul_f32 v63, v63, v29
    v_cvt_pk_bf16_f32 v40, v56, v57
    v_cvt_pk_bf16_f32 v41, v58, v59
    v_cvt_pk_bf16_f32 v42, v60, v61
    v_cvt_pk_bf16_f32 v43, v62, v63
    buffer_store_dwordx4 v[40:43], v0, s[8:11], s40 offen offset:1024
    s_mul_i32 s43, s18, 3072
    s_add_u32 s44, s43, 150528
    s_add_u32 s45, s43, s26
    s_add_u32 m0, s44, 0
    s_add_u32 s42, s45, 150528
    buffer_load_dwordx4 v0, s[8:11], s42 offen offset:0 lds
    buffer_load_dwordx4 v0, s[8:11], s42 offen offset:1024 lds
    buffer_load_dwordx4 v0, s[8:11], s42 offen offset:2048 lds
    s_add_u32 s58, s28, 1
    v_mov_b32 v7, s58
    s_waitcnt vmcnt(3)
    buffer_store_dword v7, off, s[8:11], s25
    buffer_load_dword v6, v2, s[8:11], s24 offen sc1
    s_add_u32 s62, s28, 1
    s_waitcnt vmcnt(0)
    v_cmp_gt_u32 vcc, s62, v6
    s_cbranch_vccnz ob209
or210:
    s_add_u32 s68, s21, 0
    buffer_load_dwordx4 a[0:3], v0, s[8:11], s68 offen offset:0 sc1
    buffer_load_dwordx4 a[4:7], v0, s[8:11], s68 offen offset:1024 sc1
    buffer_load_dwordx4 a[8:11], v0, s[8:11], s68 offen offset:2048 sc1
    buffer_load_dwordx4 a[12:15], v0, s[8:11], s68 offen offset:3072 sc1
    s_add_u32 s68, s21, 4096
    buffer_load_dwordx4 a[16:19], v0, s[8:11], s68 offen offset:0 sc1
    ds_read_b128 v[112:115], v4 offset:0
    ds_read_b128 v[116:119], v4 offset:1024
    ds_read_b128 v[120:123], v4 offset:2048
    ds_read_b128 v[124:127], v4 offset:3072
    s_waitcnt vmcnt(4) lgkmcnt(2)
    v_mfma_f32_32x32x16_bf16 v[96:111], v[112:115], a[0:3], 0
    ds_read_b128 v[128:131], v4 offset:4096
    buffer_load_dwordx4 a[20:23], v0, s[8:11], s68 offen offset:1024 sc1
    buffer_load_dwordx4 a[24:27], v0, s[8:11], s68 offen offset:2048 sc1
    s_waitcnt vmcnt(5)
    v_mfma_f32_32x32x16_bf16 v[96:111], v[116:119], a[4:7], v[96:111]
    ds_read_b128 v[112:115], v4 offset:5120
    buffer_load_dwordx4 a[28:31], v0, s[8:11], s68 offen offset:3072 sc1
    s_add_u32 s68, s21, 8192
    buffer_load_dwordx4 a[32:35], v0, s[8:11], s68 offen offset:0 sc1
    s_waitcnt vmcnt(6) lgkmcnt(2)
    v_mfma_f32_32x32x16_bf16 v[96:111], v[120:123], a[8:11], v[96:111]
    ds_read_b128 v[116:119], v4 offset:6144
    buffer_load_dwordx4 a[36:39], v0, s[8:11], s68 offen offset:1024 sc1
    buffer_load_dwordx4 a[40:43], v0, s[8:11], s68 offen offset:2048 sc1
    s_waitcnt vmcnt(7)
    v_mfma_f32_32x32x16_bf16 v[96:111], v[124:127], a[12:15], v[96:111]
    ds_read_b128 v[120:123], v4 offset:7168
    buffer_load_dwordx4 a[44:47], v0, s[8:11], s68 offen offset:3072 sc1
    s_add_u32 s68, s21, 12288
    buffer_load_dwordx4 a[48:51], v0, s[8:11], s68 offen offset:0 sc1
    s_waitcnt vmcnt(8) lgkmcnt(2)
    v_mfma_f32_32x32x16_bf16 v[96:111], v[128:131], a[16:19], v[96:111]
    ds_read_b128 v[124:127], v4 offset:8192
    buffer_load_dwordx4 a[52:55], v0, s[8:11], s68 offen offset:1024 sc1
    s_waitcnt vmcnt(8)
    v_mfma_f32_32x32x16_bf16 v[96:111], v[112:115], a[20:23], v[96:111]
    ds_read_b128 v[128:131], v4 offset:9216
    buffer_load_dwordx4 a[56:59], v0, s[8:11], s68 offen offset:2048 sc1
    s_waitcnt vmcnt(8) lgkmcnt(2)
    v_mfma_f32_32x32x16_bf16 v[96:111], v[116:119], a[24:27], v[96:111]
    ds_read_b128 v[112:115], v4 offset:10240
    buffer_load_dwordx4 a[60:63], v0, s[8:11], s68 offen offset:3072 sc1
    s_waitcnt vmcnt(8)
    v_mfma_f32_32x32x16_bf16 v[96:111], v[120:123], a[28:31], v[96:111]
    ds_read_b128 v[116:119], v4 offset:11264
    s_add_u32 s68, s21, 16384
    buffer_load_dwordx4 a[64:67], v0, s[8:11], s68 offen offset:0 sc1
    s_waitcnt vmcnt(8) lgkmcnt(2)
    v_mfma_f32_32x32x16_bf16 v[96:111], v[124:127], a[32:35], v[96:111]
    ds_read_b128 v[120:123], v4 offset:12288
    buffer_load_dwordx4 a[68:71], v0, s[8:11], s68 offen offset:1024 sc1
    s_waitcnt vmcnt(8)
    v_mfma_f32_32x32x16_bf16 v[96:111], v[128:131], a[36:39], v[96:111]
    ds_read_b128 v[124:127], v4 offset:13312
    buffer_load_dwordx4 a[72:75], v0, s[8:11], s68 offen offset:2048 sc1
    s_waitcnt vmcnt(8) lgkmcnt(2)
    v_mfma_f32_32x32x16_bf16 v[96:111], v[112:115], a[40:43], v[96:111]
    ds_read_b128 v[128:131], v4 offset:14336
    buffer_load_dwordx4 a[76:79], v0, s[8:11], s68 offen offset:3072 sc1
    s_waitcnt vmcnt(8)
    v_mfma_f32_32x32x16_bf16 v[96:111], v[116:119], a[44:47], v[96:111]
    ds_read_b128 v[112:115], v4 offset:15360
    s_add_u32 s68, s21, 20480
    buffer_load_dwordx4 a[80:83], v0, s[8:11], s68 offen offset:0 sc1
    s_waitcnt vmcnt(8) lgkmcnt(2)
    v_mfma_f32_32x32x16_bf16 v[96:111], v[120:123], a[48:51], v[96:111]
    ds_read_b128 v[116:119], v4 offset:16384
    buffer_load_dwordx4 a[84:87], v0, s[8:11], s68 offen offset:1024 sc1
    s_waitcnt vmcnt(8)
    v_mfma_f32_32x32x16_bf16 v[96:111], v[124:127], a[52:55], v[96:111]
    ds_read_b128 v[120:123], v4 offset:17408
    buffer_load_dwordx4 a[88:91], v0, s[8:11], s68 offen offset:2048 sc1
    s_waitcnt vmcnt(8) lgkmcnt(2)
    v_mfma_f32_32x32x16_bf16 v[96:111], v[128:131], a[56:59], v[96:111]
    ds_read_b128 v[124:127], v4 offset:18432
    buffer_load_dwordx4 a[92:95], v0, s[8:11], s68 offen offset:3072 sc1
    s_waitcnt vmcnt(8)
    v_mfma_f32_32x32x16_bf16 v[96:111], v[112:115], a[60:63], v[96:111]
    ds_read_b128 v[128:131], v4 offset:19456
    s_add_u32 s68, s21, 24576
    buffer_load_dwordx4 a[96:99], v0, s[8:11], s68 offen offset:0 sc1
    s_waitcnt vmcnt(8) lgkmcnt(2)
    v_mfma_f32_32x32x16_bf16 v[96:111], v[116:119], a[64:67], v[96:111]
    ds_read_b128 v[112:115], v4 offset:20480
    buffer_load_dwordx4 a[100:103], v0, s[8:11], s68 offen offset:1024 sc1
    s_waitcnt vmcnt(8)
    v_mfma_f32_32x32x16_bf16 v[96:111], v[120:123], a[68:71], v[96:111]
    ds_read_b128 v[116:119], v4 offset:21504
    buffer_load_dwordx4 a[104:107], v0, s[8:11], s68 offen offset:2048 sc1
    s_waitcnt vmcnt(8) lgkmcnt(2)
    v_mfma_f32_32x32x16_bf16 v[96:111], v[124:127], a[72:75], v[96:111]
    ds_read_b128 v[120:123], v4 offset:22528
    buffer_load_dwordx4 a[108:111], v0, s[8:11], s68 offen offset:3072 sc1
    s_waitcnt vmcnt(8)
    v_mfma_f32_32x32x16_bf16 v[96:111], v[128:131], a[76:79], v[96:111]
    ds_read_b128 v[124:127], v4 offset:23552
    s_add_u32 s68, s21, 28672
    buffer_load_dwordx4 a[112:115], v0, s[8:11], s68 offen offset:0 sc1
    s_waitcnt vmcnt(8) lgkmcnt(2)
    v_mfma_f32_32x32x16_bf16 v[96:111], v[112:115], a[80:83], v[96:111]
    ds_read_b128 v[128:131], v4 offset:24576
    buffer_load_dwordx4 a[116:119], v0, s[8:11], s68 offen offset:1024 sc1
    s_waitcnt vmcnt(8)
    v_mfma_f32_32x32x16_bf16 v[96:111], v[116:119], a[84:87], v[96:111]
    ds_read_b128 v[112:115], v4 offset:25600
    buffer_load_dwordx4 a[120:123], v0, s[8:11], s68 offen offset:2048 sc1
    s_waitcnt vmcnt(8) lgkmcnt(2)
    v_mfma_f32_32x32x16_bf16 v[96:111], v[120:123], a[88:91], v[96:111]
    ds_read_b128 v[116:119], v4 offset:26624
    buffer_load_dwordx4 a[124:127], v0, s[8:11], s68 offen offset:3072 sc1
    s_waitcnt vmcnt(8)
    v_mfma_f32_32x32x16_bf16 v[96:111], v[124:127], a[92:95], v[96:111]
    ds_read_b128 v[120:123], v4 offset:27648
    s_waitcnt vmcnt(7) lgkmcnt(2)
    v_mfma_f32_32x32x16_bf16 v[96:111], v[128:131], a[96:99], v[96:111]
    ds_read_b128 v[124:127], v4 offset:28672
    s_waitcnt vmcnt(6)
    v_mfma_f32_32x32x16_bf16 v[96:111], v[112:115], a[100:103], v[96:111]
    ds_read_b128 v[128:131], v4 offset:29696
    s_waitcnt vmcnt(5) lgkmcnt(2)
    v_mfma_f32_32x32x16_bf16 v[96:111], v[116:119], a[104:107], v[96:111]
    ds_read_b128 v[112:115], v4 offset:30720
    s_waitcnt vmcnt(4)
    v_mfma_f32_32x32x16_bf16 v[96:111], v[120:123], a[108:111], v[96:111]
    ds_read_b128 v[116:119], v4 offset:31744
    s_waitcnt vmcnt(3) lgkmcnt(2)
    v_mfma_f32_32x32x16_bf16 v[96:111], v[124:127], a[112:115], v[96:111]
    s_waitcnt vmcnt(2)
    v_mfma_f32_32x32x16_bf16 v[96:111], v[128:131], a[116:119], v[96:111]
    s_waitcnt vmcnt(1) lgkmcnt(0)
    v_mfma_f32_32x32x16_bf16 v[96:111], v[112:115], a[120:123], v[96:111]
    s_waitcnt vmcnt(0)
    v_mfma_f32_32x32x16_bf16 v[96:111], v[116:119], a[124:127], v[96:111]
    s_barrier
    v_lshlrev_b32 v28, 16, v8
    v_and_b32 v29, 0xffff0000, v8
    v_lshlrev_b32 v30, 16, v9
    v_and_b32 v31, 0xffff0000, v9
    v_lshlrev_b32 v32, 16, v10
    v_and_b32 v33, 0xffff0000, v10
    v_lshlrev_b32 v34, 16, v11
    v_and_b32 v35, 0xffff0000, v11
    v_lshlrev_b32 v36, 16, v12
    v_and_b32 v37, 0xffff0000, v12
    v_lshlrev_b32 v38, 16, v13
    v_and_b32 v39, 0xffff0000, v13
    v_lshlrev_b32 v40, 16, v14
    v_and_b32 v41, 0xffff0000, v14
    v_lshlrev_b32 v42, 16, v15
    v_and_b32 v43, 0xffff0000, v15
    v_add_f32 v96, v96, v28
    v_add_f32 v97, v97, v29
    v_add_f32 v98, v98, v30
    v_add_f32 v99, v99, v31
    v_add_f32 v100, v100, v32
    v_add_f32 v101, v101, v33
    v_add_f32 v102, v102, v34
    v_add_f32 v103, v103, v35
    v_add_f32 v104, v104, v36
    v_add_f32 v105, v105, v37
    v_add_f32 v106, v106, v38
    v_add_f32 v107, v107, v39
    v_add_f32 v108, v108, v40
    v_add_f32 v109, v109, v41
    v_add_f32 v110, v110, v42
    v_add_f32 v111, v111, v43
    v_cvt_pk_bf16_f32 v8, v96, v97
    v_cvt_pk_bf16_f32 v9, v98, v99
    v_cvt_pk_bf16_f32 v10, v100, v101
    v_cvt_pk_bf16_f32 v11, v102, v103
    v_cvt_pk_bf16_f32 v12, v104, v105
    v_cvt_pk_bf16_f32 v13, v106, v107
    v_cvt_pk_bf16_f32 v14, v108, v109
    v_cvt_pk_bf16_f32 v15, v110, v111
    s_lshl_b32 s40, s17, 11
    s_add_u32 s40, s40, s20
    buffer_store_dwordx4 v[8:11], v0, s[8:11], s40 offen
    buffer_store_dwordx4 v[12:15], v0, s[8:11], s40 offen offset:1024
    v_mov_b32 v30, 0
    v_mov_b32 v31, 0
    v_mov_b32 v34, 0x3f803f80
    v_dot2_f32_bf16 v30, v8, v34, v30
    v_dot2_f32_bf16 v31, v8, v8, v31
    v_dot2_f32_bf16 v30, v9, v34, v30
    v_dot2_f32_bf16 v31, v9, v9, v31
    v_dot2_f32_bf16 v30, v10, v34, v30
    v_dot2_f32_bf16 v31, v10, v10, v31
    v_dot2_f32_bf16 v30, v11, v34, v30
    v_dot2_f32_bf16 v31, v11, v11, v31
    v_dot2_f32_bf16 v30, v12, v34, v30
    v_dot2_f32_bf16 v31, v12, v12, v31
    v_dot2_f32_bf16 v30, v13, v34, v30
    v_dot2_f32_bf16 v31, v13, v13, v31
    v_dot2_f32_bf16 v30, v14, v34, v30
    v_dot2_f32_bf16 v31, v14, v14, v31
    v_dot2_f32_bf16 v30, v15, v34, v30
    v_dot2_f32_bf16 v31, v15, v15, v31
    v_and_b32 v6, 0x1ff, v0
    s_nop 0
    v_mov_b32 v32, v30
    v_mov_b32 v33, v31
    s_nop 0
    v_permlane32_swap_b32 v30, v32
    v_permlane32_swap_b32 v31, v33
    s_nop 0
    v_add_f32 v30, v30, v32
    v_add_f32 v31, v31, v33
    buffer_store_dwordx2 v[30:31], v6, s[8:11], s73 offen
    s_add_u32 m0, s60, 0
    s_add_u32 s42, s61, 162816
    buffer_load_dwordx4 v0, s[8:11], s42 offen offset:0 lds
    buffer_load_dwordx4 v0, s[8:11], s42 offen offset:1024 lds
    buffer_load_dwordx4 v0, s[8:11], s42 offen offset:2048 lds
    buffer_load_dwordx4 v0, s[8:11], s42 offen offset:3072 lds
    s_add_u32 s58, s28, 2
    v_mov_b32 v7, s58
    s_waitcnt vmcnt(4)
    buffer_store_dword v7, off, s[8:11], s25
    s_add_u32 m0, s60, 4096
    s_add_u32 s42, s61, 166912
    buffer_load_dwordx4 v0, s[8:11], s42 offen offset:0 lds
    buffer_load_dwordx4 v0, s[8:11], s42 offen offset:1024 lds
    buffer_load_dwordx4 v0, s[8:11], s42 offen offset:2048 lds
    buffer_load_dwordx4 v0, s[8:11], s42 offen offset:3072 lds
    buffer_load_dword v6, v2, s[8:11], s24 offen sc1
    s_add_u32 s62, s28, 2
    s_waitcnt vmcnt(0)
    v_cmp_gt_u32 vcc, s62, v6
    s_cbranch_vccnz ob212
or213:
    s_add_u32 s68, s20, 0
    buffer_load_dwordx4 a[0:3], v0, s[8:11], s68 offen offset:0 sc1
    buffer_load_dwordx4 a[4:7], v0, s[8:11], s68 offen offset:1024 sc1
    buffer_load_dwordx4 a[8:11], v0, s[8:11], s68 offen offset:2048 sc1
    buffer_load_dwordx4 a[12:15], v0, s[8:11], s68 offen offset:3072 sc1
    s_add_u32 s68, s20, 4096
    buffer_load_dwordx4 a[16:19], v0, s[8:11], s68 offen offset:0 sc1
    s_lshl_b32 s46, s17, 10
    s_add_u32 s46, s46, s22
    s_barrier
    ds_read_b128 v[112:115], v4 offset:32768
    ds_read_b128 v[116:119], v4 offset:33792
    ds_read_b128 v[120:123], v4 offset:34816
    ds_read_b128 v[124:127], v4 offset:35840
    s_waitcnt vmcnt(4) lgkmcnt(2)
    v_mfma_f32_32x32x16_bf16 v[48:63], v[112:115], a[0:3], 0
    ds_read_b128 v[128:131], v4 offset:36864
    buffer_load_dwordx4 a[20:23], v0, s[8:11], s68 offen offset:1024 sc1
    buffer_load_dwordx4 a[24:27], v0, s[8:11], s68 offen offset:2048 sc1
    v_mfma_f32_32x32x16_bf16 v[64:79], v[116:119], a[0:3], 0
    ds_read_b128 v[112:115], v4 offset:37888
    s_waitcnt vmcnt(5) lgkmcnt(2)
    v_mfma_f32_32x32x16_bf16 v[48:63], v[120:123], a[4:7], v[48:63]
    ds_read_b128 v[116:119], v4 offset:38912
    buffer_load_dwordx4 a[28:31], v0, s[8:11], s68 offen offset:3072 sc1
    s_add_u32 s68, s20, 8192
    buffer_load_dwordx4 a[32:35], v0, s[8:11], s68 offen offset:0 sc1
    v_mfma_f32_32x32x16_bf16 v[64:79], v[124:127], a[4:7], v[64:79]
    ds_read_b128 v[120:123], v4 offset:39936
    s_waitcnt vmcnt(6) lgkmcnt(2)
    v_mfma_f32_32x32x16_bf16 v[48:63], v[128:131], a[8:11], v[48:63]
    ds_read_b128 v[124:127], v4 offset:40960
    buffer_load_dwordx4 a[36:39], v0, s[8:11], s68 offen offset:1024 sc1
    buffer_load_dwordx4 a[40:43], v0, s[8:11], s68 offen offset:2048 sc1
    v_mfma_f32_32x32x16_bf16 v[64:79], v[112:115], a[8:11], v[64:79]
    ds_read_b128 v[128:131], v4 offset:41984
    s_waitcnt vmcnt(7) lgkmcnt(2)
    v_mfma_f32_32x32x16_bf16 v[48:63], v[116:119], a[12:15], v[48:63]
    ds_read_b128 v[112:115], v4 offset:43008
    buffer_load_dwordx4 a[44:47], v0, s[8:11], s68 offen offset:3072 sc1
    s_add_u32 s68, s20, 12288
    buffer_load_dwordx4 a[48:51], v0, s[8:11], s68 offen offset:0 sc1
    v_mfma_f32_32x32x16_bf16 v[64:79], v[120:123], a[12:15], v[64:79]
    ds_read_b128 v[116:119], v4 offset:44032
    s_waitcnt vmcnt(8) lgkmcnt(2)
    v_mfma_f32_32x32x16_bf16 v[48:63], v[124:127], a[16:19], v[48:63]
    ds_read_b128 v[120:123], v4 offset:45056
    buffer_load_dwordx4 a[52:55], v0, s[8:11], s68 offen offset:1024 sc1
    v_mfma_f32_32x32x16_bf16 v[64:79], v[128:131], a[16:19], v[64:79]
    ds_read_b128 v[124:127], v4 offset:46080
    s_waitcnt vmcnt(8) lgkmcnt(2)
    v_mfma_f32_32x32x16_bf16 v[48:63], v[112:115], a[20:23], v[48:63]
    ds_read_b128 v[128:131], v4 offset:47104
    buffer_load_dwordx4 a[56:59], v0, s[8:11], s68 offen offset:2048 sc1
    v_mfma_f32_32x32x16_bf16 v[64:79], v[116:119], a[20:23], v[64:79]
    ds_read_b128 v[112:115], v4 offset:48128
    s_waitcnt vmcnt(8) lgkmcnt(2)
    v_mfma_f32_32x32x16_bf16 v[48:63], v[120:123], a[24:27], v[48:63]
    ds_read_b128 v[116:119], v4 offset:49152
    buffer_load_dwordx4 a[60:63], v0, s[8:11], s68 offen offset:3072 sc1
    v_mfma_f32_32x32x16_bf16 v[64:79], v[124:127], a[24:27], v[64:79]
    ds_read_b128 v[120:123], v4 offset:50176
    s_waitcnt vmcnt(8) lgkmcnt(2)
    v_mfma_f32_32x32x16_bf16 v[48:63], v[128:131], a[28:31], v[48:63]
    ds_read_b128 v[124:127], v4 offset:51200
    s_add_u32 s68, s20, 16384
    buffer_load_dwordx4 a[64:67], v0, s[8:11], s68 offen offset:0 sc1
    v_mfma_f32_32x32x16_bf16 v[64:79], v[112:115], a[28:31], v[64:79]
    ds_read_b128 v[128:131], v4 offset:52224
    s_waitcnt vmcnt(8) lgkmcnt(2)
    v_mfma_f32_32x32x16_bf16 v[48:63], v[116:119], a[32:35], v[48:63]
    ds_read_b128 v[112:115], v4 offset:53248
    buffer_load_dwordx4 a[68:71], v0, s[8:11], s68 offen offset:1024 sc1
    buffer_load_dwordx4 v[28:31], v0, s[8:11], s23 offen offset:0 sc1
    buffer_load_dwordx4 v[32:35], v0, s[8:11], s23 offen offset:1024 sc1
    buffer_load_dwordx4 v[36:39], v0, s[8:11], s23 offen offset:2048 sc1
    buffer_load_dwordx4 v[40:43], v0, s[8:11], s23 offen offset:3072 sc1
    v_mfma_f32_32x32x16_bf16 v[64:79], v[120:123], a[32:35], v[64:79]
    ds_read_b128 v[116:119], v4 offset:54272
    s_waitcnt vmcnt(12) lgkmcnt(2)
    v_mfma_f32_32x32x16_bf16 v[48:63], v[124:127], a[36:39], v[48:63]
    ds_read_b128 v[120:123], v4 offset:55296
    buffer_load_dwordx4 a[72:75], v0, s[8:11], s68 offen offset:2048 sc1
    v_mfma_f32_32x32x16_bf16 v[64:79], v[128:131], a[36:39], v[64:79]
    ds_read_b128 v[124:127], v4 offset:56320
    s_waitcnt vmcnt(12) lgkmcnt(2)
    v_mfma_f32_32x32x16_bf16 v[48:63], v[112:115], a[40:43], v[48:63]
    ds_read_b128 v[128:131], v4 offset:57344
    buffer_load_dwordx4 a[76:79], v0, s[8:11], s68 offen offset:3072 sc1
    v_mfma_f32_32x32x16_bf16 v[64:79], v[116:119], a[40:43], v[64:79]
    ds_read_b128 v[112:115], v4 offset:58368
    s_waitcnt vmcnt(12) lgkmcnt(2)
    v_mfma_f32_32x32x16_bf16 v[48:63], v[120:123], a[44:47], v[48:63]
    ds_read_b128 v[116:119], v4 offset:59392
    s_add_u32 s68, s20, 20480
    buffer_load_dwordx4 a[80:83], v0, s[8:11], s68 offen offset:0 sc1
    v_mfma_f32_32x32x16_bf16 v[64:79], v[124:127], a[44:47], v[64:79]
    ds_read_b128 v[120:123], v4 offset:60416
    s_barrier
    s_waitcnt vmcnt(12) lgkmcnt(2)
    v_mfma_f32_32x32x16_bf16 v[48:63], v[128:131], a[48:51], v[48:63]
    ds_read_b128 v[124:127], v4 offset:0
    buffer_load_dwordx4 a[84:87], v0, s[8:11], s68 offen offset:1024 sc1
    v_mfma_f32_32x32x16_bf16 v[64:79], v[112:115], a[48:51], v[64:79]
    ds_read_b128 v[128:131], v4 offset:1024
    s_waitcnt vmcnt(12) lgkmcnt(2)
    v_mfma_f32_32x32x16_bf16 v[48:63], v[116:119], a[52:55], v[48:63]
    ds_read_b128 v[112:115], v4 offset:2048
    buffer_load_dwordx4 a[88:91], v0, s[8:11], s68 offen offset:2048 sc1
    v_mfma_f32_32x32x16_bf16 v[64:79], v[120:123], a[52:55], v[64:79]
    ds_read_b128 v[116:119], v4 offset:3072
    ds_write_b128 v5, a[128:131] offset:32768
    s_waitcnt vmcnt(12) lgkmcnt(3)
    v_mfma_f32_32x32x16_bf16 v[48:63], v[124:127], a[56:59], v[48:63]
    ds_read_b128 v[120:123], v4 offset:4096
    buffer_load_dwordx4 a[92:95], v0, s[8:11], s68 offen offset:3072 sc1
    v_mfma_f32_32x32x16_bf16 v[64:79], v[128:131], a[56:59], v[64:79]
    ds_read_b128 v[124:127], v4 offset:5120
    s_waitcnt vmcnt(12) lgkmcnt(3)
    v_mfma_f32_32x32x16_bf16 v[48:63], v[112:115], a[60:63], v[48:63]
    ds_read_b128 v[128:131], v4 offset:6144
    s_add_u32 s68, s20, 24576
    buffer_load_dwordx4 a[96:99], v0, s[8:11], s68 offen offset:0 sc1
    v_mfma_f32_32x32x16_bf16 v[64:79], v[116:119], a[60:63], v[64:79]
    ds_read_b128 v[112:115], v4 offset:7168
    s_waitcnt vmcnt(7)
    v_add_f32 v28, v28, v30
    v_add_f32 v29, v29, v31
    v_add_f32 v28, v28, v32
    v_add_f32 v29, v29, v33
    s_waitcnt lgkmcnt(2)
    v_mfma_f32_32x32x16_bf16 v[48:63], v[120:123], a[64:67], v[48:63]
    ds_read_b128 v[116:119], v4 offset:8192
    buffer_load_dwordx4 a[100:103], v0, s[8:11], s68 offen offset:1024 sc1
    v_mfma_f32_32x32x16_bf16 v[64:79], v[124:127], a[64:67], v[64:79]
    ds_read_b128 v[120:123], v4 offset:9216
    ds_write_b128 v5, a[132:135] offset:36864
    v_add_f32 v28, v28, v34
    s_waitcnt lgkmcnt(3)
    v_mfma_f32_32x32x16_bf16 v[48:63], v[128:131], a[68:71], v[48:63]
    ds_read_b128 v[124:127], v4 offset:10240
    buffer_load_dwordx4 a[104:107], v0, s[8:11], s68 offen offset:2048 sc1
    v_mfma_f32_32x32x16_bf16 v[64:79], v[112:115], a[68:71], v[64:79]
    ds_read_b128 v[128:131], v4 offset:11264
    v_add_f32 v29, v29, v35
    v_add_f32 v28, v28, v36
    v_add_f32 v29, v29, v37
    v_add_f32 v28, v28, v38
    v_add_f32 v29, v29, v39
    s_waitcnt vmcnt(8) lgkmcnt(3)
    v_mfma_f32_32x32x16_bf16 v[48:63], v[116:119], a[72:75], v[48:63]
    ds_read_b128 v[112:115], v4 offset:12288
    buffer_load_dwordx4 a[108:111], v0, s[8:11], s68 offen offset:3072 sc1
    ds_write_b128 v5, a[136:139] offset:40960
    v_mfma_f32_32x32x16_bf16 v[64:79], v[120:123], a[72:75], v[64:79]
    ds_read_b128 v[116:119], v4 offset:13312
    ds_write_b128 v5, a[140:143] offset:45056
    v_add_f32 v28, v28, v40
    s_waitcnt vmcnt(8) lgkmcnt(4)
    v_mfma_f32_32x32x16_bf16 v[48:63], v[124:127], a[76:79], v[48:63]
    ds_read_b128 v[120:123], v4 offset:14336
    s_add_u32 s68, s20, 28672
    buffer_load_dwordx4 a[112:115], v0, s[8:11], s68 offen offset:0 sc1
    ds_write_b128 v5, a[144:147] offset:49152
    v_mfma_f32_32x32x16_bf16 v[64:79], v[128:131], a[76:79], v[64:79]
    ds_read_b128 v[124:127], v4 offset:15360
    ds_write_b128 v5, a[148:151] offset:53248
    v_add_f32 v29, v29, v41
    s_waitcnt vmcnt(8) lgkmcnt(5)
    v_mfma_f32_32x32x16_bf16 v[48:63], v[112:115], a[80:83], v[48:63]
    ds_read_b128 v[128:131], v4 offset:16384
    buffer_load_dwordx4 a[116:119], v0, s[8:11], s68 offen offset:1024 sc1
    v_mfma_f32_32x32x16_bf16 v[64:79], v[116:119], a[80:83], v[64:79]
    ds_read_b128 v[112:115], v4 offset:17408
    v_add_f32 v28, v28, v42
    v_add_f32 v29, v29, v43
    v_mov_b32 v30, v28
    v_mov_b32 v31, v29
    v_mov_b32 v18, 0
    s_waitcnt vmcnt(8) lgkmcnt(3)
    v_mfma_f32_32x32x16_bf16 v[48:63], v[120:123], a[84:87], v[48:63]
    ds_read_b128 v[116:119], v4 offset:18432
    buffer_load_dwordx4 a[120:123], v0, s[8:11], s68 offen offset:2048 sc1
    v_mfma_f32_32x32x16_bf16 v[64:79], v[124:127], a[84:87], v[64:79]
    ds_read_b128 v[120:123], v4 offset:19456
    v_mov_b32 v19, 0
    v_permlane32_swap_b32 v28, v30
    v_permlane32_swap_b32 v29, v31
    v_mov_b32 v32, 0
    v_add_f32 v28, v28, v30
    s_waitcnt vmcnt(8) lgkmcnt(2)
    v_mfma_f32_32x32x16_bf16 v[48:63], v[128:131], a[88:91], v[48:63]
    ds_read_b128 v[124:127], v4 offset:20480
    buffer_load_dwordx4 a[124:127], v0, s[8:11], s68 offen offset:3072 sc1
    v_mfma_f32_32x32x16_bf16 v[64:79], v[112:115], a[88:91], v[64:79]
    ds_read_b128 v[128:131], v4 offset:21504
    v_add_f32 v29, v29, v31
    v_mul_f32 v28, 0x3b000000, v28
    v_mul_f32 v29, 0x3b000000, v29
    v_fma_f32 v29, -v28, v28, v29
    v_cvt_pk_bf16_f32 v16, v28, v28
    s_waitcnt vmcnt(8) lgkmcnt(2)
    v_mfma_f32_32x32x16_bf16 v[48:63], v[116:119], a[92:95], v[48:63]
    ds_read_b128 v[112:115], v4 offset:22528
    v_max_f32 v29, 0, v29
    v_and_b32 v30, 0xffff0000, v16
    v_add_f32 v27, 0x3727c5ac, v29
    v_sub_f32 v30, v28, v30
    v_rsq_f32 v24, v27
    v_mfma_f32_32x32x16_bf16 v[64:79], v[120:123], a[92:95], v[64:79]
    ds_read_b128 v[116:119], v4 offset:23552
    v_cvt_pk_bf16_f32 v17, v30, v32
    v_cndmask_b32_e64 v16, v16, 0, s[32:33]
    v_cndmask_b32_e64 v17, v17, 0, s[32:33]
    v_mul_f32 v26, v24, v24
    v_mul_f32 v25, 0xc0135761, v24
    s_waitcnt vmcnt(7) lgkmcnt(2)
    v_mfma_f32_32x32x16_bf16 v[48:63], v[124:127], a[96:99], v[48:63]
    ds_read_b128 v[120:123], v4 offset:24576
    v_mul_f32 v26, v26, v24
    v_mul_f32 v26, 0xbdd2d3e8, v26
    v_mfma_f32_32x32x16_bf16 v[64:79], v[128:131], a[96:99], v[64:79]
    ds_read_b128 v[124:127], v4 offset:25600
    s_waitcnt vmcnt(6) lgkmcnt(2)
    v_mfma_f32_32x32x16_bf16 v[48:63], v[112:115], a[100:103], v[48:63]
    ds_read_b128 v[128:131], v4 offset:26624
    v_mfma_f32_32x32x16_bf16 v[64:79], v[116:119], a[100:103], v[64:79]
    ds_read_b128 v[112:115], v4 offset:27648
    s_barrier
    s_waitcnt vmcnt(5) lgkmcnt(2)
    v_mfma_f32_32x32x16_bf16 v[48:63], v[120:123], a[104:107], v[48:63]
    ds_read_b128 v[116:119], v4 offset:28672
    v_mfma_f32_32x32x16_bf16 v[64:79], v[124:127], a[104:107], v[64:79]
    ds_read_b128 v[120:123], v4 offset:29696
    s_waitcnt vmcnt(4) lgkmcnt(2)
    v_mfma_f32_32x32x16_bf16 v[48:63], v[128:131], a[108:111], v[48:63]
    ds_read_b128 v[124:127], v4 offset:30720
    ds_write_b128 v5, a[152:155] offset:57344
    v_mfma_f32_32x32x16_bf16 v[64:79], v[112:115], a[108:111], v[64:79]
    ds_read_b128 v[128:131], v4 offset:31744
    s_waitcnt vmcnt(3) lgkmcnt(3)
    v_mfma_f32_32x32x16_bf16 v[48:63], v[116:119], a[112:115], v[48:63]
    ds_read_b128 v[112:115], v4 offset:32768
    v_mfma_f32_32x32x16_bf16 v[64:79], v[120:123], a[112:115], v[64:79]
    ds_read_b128 v[116:119], v4 offset:33792
    ds_write_b128 v5, a[156:159] offset:0
    s_waitcnt vmcnt(2) lgkmcnt(3)
    v_mfma_f32_32x32x16_bf16 v[48:63], v[124:127], a[116:119], v[48:63]
    ds_read_b128 v[120:123], v4 offset:34816
    v_mfma_f32_32x32x16_bf16 v[64:79], v[128:131], a[116:119], v[64:79]
    ds_read_b128 v[124:127], v4 offset:35840
    s_waitcnt vmcnt(1) lgkmcnt(3)
    v_mfma_f32_32x32x16_bf16 v[48:63], v[112:115], a[120:123], v[48:63]
    ds_read_b128 v[128:131], v4 offset:36864
    ds_write_b128 v5, a[160:163] offset:4096
    v_mfma_f32_32x32x16_bf16 v[64:79], v[116:119], a[120:123], v[64:79]
    ds_read_b128 v[112:115], v4 offset:37888
    s_waitcnt vmcnt(0) lgkmcnt(3)
    v_mfma_f32_32x32x16_bf16 v[48:63], v[120:123], a[124:127], v[48:63]
    ds_read_b128 v[116:119], v4 offset:38912
    v_mfma_f32_32x32x16_bf16 v[64:79], v[124:127], a[124:127], v[64:79]
    ds_read_b128 v[120:123], v4 offset:39936
    ds_write_b128 v5, a[164:167] offset:8192
    s_waitcnt lgkmcnt(3)
    v_mfma_f32_32x32x16_bf16 v[48:63], v[128:131], v[16:19], v[48:63]
    ds_read_b128 v[124:127], v4 offset:40960
    ds_write_b128 v5, a[168:171] offset:12288
    v_mfma_f32_32x32x16_bf16 v[64:79], v[112:115], v[16:19], v[64:79]
    ds_read_b128 v[128:131], v4 offset:41984
    ds_write_b128 v5, a[172:175] offset:16384
    s_waitcnt lgkmcnt(5)
    v_mfma_f32_32x32x16_bf16 v[80:95], v[116:119], a[0:3], 0
    ds_read_b128 v[112:115], v4 offset:43008
    s_cmp_eq_u32 s27, 0
    s_cbranch_scc1 ob214
or215:
    ds_write_b128 v5, a[176:179] offset:20480
    v_mfma_f32_32x32x16_bf16 v[80:95], v[120:123], a[4:7], v[80:95]
    ds_read_b128 v[116:119], v4 offset:44032
    v_mul_f32 v28, v48, v48
    v_mul_f32 v31, v49, v49
    v_mul_f32 v34, v50, v50
    v_mul_f32 v37, v51, v51
    v_mul_f32 v29, v48, v56
    s_waitcnt lgkmcnt(4)
    v_mfma_f32_32x32x16_bf16 v[80:95], v[124:127], a[8:11], v[80:95]
    ds_read_b128 v[120:123], v4 offset:45056
    v_mul_f32 v32, v49, v57
    v_mul_f32 v35, v50, v58
    v_mul_f32 v38, v51, v59
    v_fma_f32 v28, v28, v26, v25
    v_fma_f32 v31, v31, v26, v25
    v_mfma_f32_32x32x16_bf16 v[80:95], v[128:131], a[12:15], v[80:95]
    ds_read_b128 v[124:127], v4 offset:46080
    v_fma_f32 v34, v34, v26, v25
    v_fma_f32 v37, v37, v26, v25
    v_mul_f32 v28, v28, v48
    v_mul_f32 v31, v31, v49
    v_mul_f32 v34, v34, v50
    s_waitcnt lgkmcnt(2)
    v_mfma_f32_32x32x16_bf16 v[80:95], v[112:115], a[16:19], v[80:95]
    ds_read_b128 v[128:131], v4 offset:47104
    v_mul_f32 v37, v37, v51
    v_exp_f32 v28, v28
    v_exp_f32 v31, v31
    v_mfma_f32_32x32x16_bf16 v[80:95], v[116:119], a[20:23], v[80:95]
    ds_read_b128 v[112:115], v4 offset:48128
    v_exp_f32 v34, v34
    v_exp_f32 v37, v37
    v_fma_f32 v28, v28, v27, v27
    s_waitcnt lgkmcnt(2)
    v_mfma_f32_32x32x16_bf16 v[80:95], v[120:123], a[24:27], v[80:95]
    ds_read_b128 v[116:119], v4 offset:49152
    v_fma_f32 v31, v31, v27, v27
    v_fma_f32 v34, v34, v27, v27
    v_fma_f32 v37, v37, v27, v27
    v_rcp_f32 v28, v28
    v_mfma_f32_32x32x16_bf16 v[80:95], v[124:127], a[28:31], v[80:95]
    ds_read_b128 v[120:123], v4 offset:50176
    v_rcp_f32 v31, v31
    v_rcp_f32 v34, v34
    v_rcp_f32 v37, v37
    s_waitcnt lgkmcnt(2)
    v_mfma_f32_32x32x16_bf16 v[80:95], v[128:131], a[32:35], v[80:95]
    ds_read_b128 v[124:127], v4 offset:51200
    v_mul_f32 v48, v29, v28
    v_mul_f32 v49, v32, v31
    v_mul_f32 v50, v35, v34
    v_mul_f32 v51, v38, v37
    v_mul_f32 v28, v52, v52
    v_mfma_f32_32x32x16_bf16 v[80:95], v[112:115], a[36:39], v[80:95]
    ds_read_b128 v[128:131], v4 offset:52224
    v_mul_f32 v31, v53, v53
    v_mul_f32 v34, v54, v54
    v_mul_f32 v37, v55, v55
    v_mul_f32 v29, v52, v60
    v_mul_f32 v32, v53, v61
    s_waitcnt lgkmcnt(2)
    v_mfma_f32_32x32x16_bf16 v[80:95], v[116:119], a[40:43], v[80:95]
    ds_read_b128 v[112:115], v4 offset:53248
    v_mul_f32 v35, v54, v62
    v_mul_f32 v38, v55, v63
    v_fma_f32 v28, v28, v26, v25
    v_fma_f32 v31, v31, v26, v25
    v_fma_f32 v34, v34, v26, v25
    v_mfma_f32_32x32x16_bf16 v[80:95], v[120:123], a[44:47], v[80:95]
    ds_read_b128 v[116:119], v4 offset:54272
    v_fma_f32 v37, v37, v26, v25
    v_mul_f32 v28, v28, v52
    v_mul_f32 v31, v31, v53
    v_mul_f32 v34, v34, v54
    v_mul_f32 v37, v37, v55
    s_waitcnt lgkmcnt(2)
    v_mfma_f32_32x32x16_bf16 v[80:95], v[124:127], a[48:51], v[80:95]
    ds_read_b128 v[120:123], v4 offset:55296
    v_exp_f32 v28, v28
    v_exp_f32 v31, v31
    v_exp_f32 v34, v34
    v_mfma_f32_32x32x16_bf16 v[80:95], v[128:131], a[52:55], v[80:95]
    ds_read_b128 v[124:127], v4 offset:56320
    v_exp_f32 v37, v37
    v_fma_f32 v28, v28, v27, v27
    v_fma_f32 v31, v31, v27, v27
    v_fma_f32 v34, v34, v27, v27
    s_barrier
    s_waitcnt lgkmcnt(2)
    v_mfma_f32_32x32x16_bf16 v[80:95], v[112:115], a[56:59], v[80:95]
    ds_read_b128 v[128:131], v4 offset:57344
    v_fma_f32 v37, v37, v27, v27
    v_rcp_f32 v28, v28
    v_rcp_f32 v31, v31
    v_mfma_f32_32x32x16_bf16 v[80:95], v[116:119], a[60:63], v[80:95]
    ds_read_b128 v[112:115], v4 offset:58368
    ds_write_b128 v5, a[180:183] offset:24576
    v_rcp_f32 v34, v34
    s_waitcnt lgkmcnt(3)
    v_mfma_f32_32x32x16_bf16 v[80:95], v[120:123], a[64:67], v[80:95]
    ds_read_b128 v[116:119], v4 offset:59392
    v_rcp_f32 v37, v37
    v_mul_f32 v52, v29, v28
    v_mul_f32 v53, v32, v31
    v_mul_f32 v54, v35, v34
    v_mfma_f32_32x32x16_bf16 v[80:95], v[124:127], a[68:71], v[80:95]
    ds_read_b128 v[120:123], v4 offset:60416
    v_mul_f32 v55, v38, v37
    v_cvt_pk_bf16_f32 v40, v48, v49
    v_cvt_pk_bf16_f32 v41, v50, v51
    v_cvt_pk_bf16_f32 v42, v52, v53
    v_cvt_pk_bf16_f32 v43, v54, v55
    s_waitcnt lgkmcnt(3)
    v_mfma_f32_32x32x16_bf16 v[80:95], v[128:131], a[72:75], v[80:95]
    ds_read_b128 v[124:127], v4 offset:0
    ds_write_b128 v5, a[184:187] offset:28672
    s_add_u32 s45, s46, 0
    buffer_store_dwordx4 v[40:43], v0, s[8:11], s45 offen nt
    v_mfma_f32_32x32x16_bf16 v[80:95], v[112:115], a[76:79], v[80:95]
    ds_read_b128 v[128:131], v4 offset:1024
    v_mul_f32 v28, v64, v64
    v_mul_f32 v31, v65, v65
    v_mul_f32 v34, v66, v66
    v_mul_f32 v37, v67, v67
    v_mul_f32 v29, v64, v72
    s_waitcnt lgkmcnt(3)
    v_mfma_f32_32x32x16_bf16 v[80:95], v[116:119], a[80:83], v[80:95]
    ds_read_b128 v[112:115], v4 offset:2048
    v_mul_f32 v32, v65, v73
    v_mul_f32 v35, v66, v74
    v_mul_f32 v38, v67, v75
    v_fma_f32 v28, v28, v26, v25
    v_fma_f32 v31, v31, v26, v25
    v_mfma_f32_32x32x16_bf16 v[80:95], v[120:123], a[84:87], v[80:95]
    ds_read_b128 v[116:119], v4 offset:3072
    ds_write_b128 v5, a[188:191] offset:32768
    v_fma_f32 v34, v34, v26, v25
    s_waitcnt lgkmcnt(3)
    v_mfma_f32_32x32x16_bf16 v[80:95], v[124:127], a[88:91], v[80:95]
    ds_read_b128 v[120:123], v4 offset:4096
    v_fma_f32 v37, v37, v26, v25
    v_mul_f32 v28, v28, v64
    v_mul_f32 v31, v31, v65
    v_mul_f32 v34, v34, v66
    v_mul_f32 v37, v37, v67
    v_mfma_f32_32x32x16_bf16 v[80:95], v[128:131], a[92:95], v[80:95]
    ds_read_b128 v[124:127], v4 offset:5120
    v_exp_f32 v28, v28
    v_exp_f32 v31, v31
    v_exp_f32 v34, v34
    s_waitcnt lgkmcnt(3)
    v_mfma_f32_32x32x16_bf16 v[80:95], v[112:115], a[96:99], v[80:95]
    ds_read_b128 v[128:131], v4 offset:6144
    ds_write_b128 v5, a[192:195] offset:36864
    v_exp_f32 v37, v37
    v_mfma_f32_32x32x16_bf16 v[80:95], v[116:119], a[100:103], v[80:95]
    ds_read_b128 v[112:115], v4 offset:7168
    v_fma_f32 v28, v28, v27, v27
    v_fma_f32 v31, v31, v27, v27
    v_fma_f32 v34, v34, v27, v27
    v_fma_f32 v37, v37, v27, v27
    v_rcp_f32 v28, v28
    s_waitcnt lgkmcnt(3)
    v_mfma_f32_32x32x16_bf16 v[80:95], v[120:123], a[104:107], v[80:95]
    ds_read_b128 v[116:119], v4 offset:8192
    ds_write_b128 v5, a[196:199] offset:40960
    v_rcp_f32 v31, v31
    v_mfma_f32_32x32x16_bf16 v[80:95], v[124:127], a[108:111], v[80:95]
    ds_read_b128 v[120:123], v4 offset:9216
    ds_write_b128 v5, a[200:203] offset:45056
    v_rcp_f32 v34, v34
    s_waitcnt lgkmcnt(4)
    v_mfma_f32_32x32x16_bf16 v[80:95], v[128:131], a[112:115], v[80:95]
    ds_read_b128 v[124:127], v4 offset:10240
    ds_write_b128 v5, a[204:207] offset:49152
    v_rcp_f32 v37, v37
    v_mfma_f32_32x32x16_bf16 v[80:95], v[112:115], a[116:119], v[80:95]
    ds_read_b128 v[128:131], v4 offset:11264
    v_mul_f32 v64, v29, v28
    v_mul_f32 v65, v32, v31
    v_mul_f32 v66, v35, v34
    v_mul_f32 v67, v38, v37
    v_mul_f32 v28, v68, v68
    s_waitcnt lgkmcnt(4)
    v_mfma_f32_32x32x16_bf16 v[80:95], v[116:119], a[120:123], v[80:95]
    ds_read_b128 v[112:115], v4 offset:12288
    s_add_u32 s58, s28, 3
    v_mov_b32 v7, s58
    s_waitcnt vmcnt(0)
    buffer_store_dword v7, off, s[8:11], s25
    v_mfma_f32_32x32x16_bf16 v[80:95], v[120:123], a[124:127], v[80:95]
    ds_read_b128 v[116:119], v4 offset:13312
    v_mul_f32 v31, v69, v69
    v_mul_f32 v34, v70, v70
    v_mul_f32 v37, v71, v71
    v_mul_f32 v29, v68, v76
    v_mul_f32 v32, v69, v77
    s_waitcnt lgkmcnt(2)
    v_mfma_f32_32x32x16_bf16 v[80:95], v[124:127], v[16:19], v[80:95]
    ds_read_b128 v[120:123], v4 offset:14336
    v_mul_f32 v35, v70, v78
    v_mul_f32 v38, v71, v79
    v_fma_f32 v28, v28, v26, v25
    v_fma_f32 v31, v31, v26, v25
    v_fma_f32 v34, v34, v26, v25
    v_mfma_f32_32x32x16_bf16 v[48:63], v[128:131], a[0:3], 0
    ds_read_b128 v[124:127], v4 offset:15360
    v_fma_f32 v37, v37, v26, v25
    v_mul_f32 v28, v28, v68
    v_mul_f32 v31, v31, v69
    v_mul_f32 v34, v34, v70
    v_mul_f32 v37, v37, v71
    s_waitcnt lgkmcnt(2)
    v_mfma_f32_32x32x16_bf16 v[48:63], v[112:115], a[4:7], v[48:63]
    ds_read_b128 v[128:131], v4 offset:16384
    s_cmp_eq_u32 s27, 0
    s_cbranch_scc1 ob216
or217:
    v_exp_f32 v28, v28
    v_exp_f32 v31, v31
    v_mfma_f32_32x32x16_bf16 v[48:63], v[116:119], a[8:11], v[48:63]
    ds_read_b128 v[112:115], v4 offset:17408
    v_exp_f32 v34, v34
    v_exp_f32 v37, v37
    v_fma_f32 v28, v28, v27, v27
    s_waitcnt lgkmcnt(2)
    v_mfma_f32_32x32x16_bf16 v[48:63], v[120:123], a[12:15], v[48:63]
    ds_read_b128 v[116:119], v4 offset:18432
    v_fma_f32 v31, v31, v27, v27
    v_fma_f32 v34, v34, v27, v27
    v_fma_f32 v37, v37, v27, v27
    v_rcp_f32 v28, v28
    v_mfma_f32_32x32x16_bf16 v[48:63], v[124:127], a[16:19], v[48:63]
    ds_read_b128 v[120:123], v4 offset:19456
    v_rcp_f32 v31, v31
    v_rcp_f32 v34, v34
    v_rcp_f32 v37, v37
    s_waitcnt lgkmcnt(2)
    v_mfma_f32_32x32x16_bf16 v[48:63], v[128:131], a[20:23], v[48:63]
    ds_read_b128 v[124:127], v4 offset:20480
    v_mul_f32 v68, v29, v28
    v_mul_f32 v69, v32, v31
    v_mul_f32 v70, v35, v34
    v_mul_f32 v71, v38, v37
    v_cvt_pk_bf16_f32 v40, v64, v65
    v_mfma_f32_32x32x16_bf16 v[48:63], v[112:115], a[24:27], v[48:63]
    ds_read_b128 v[128:131], v4 offset:21504
    v_cvt_pk_bf16_f32 v41, v66, v67
    v_cvt_pk_bf16_f32 v42, v68, v69
    v_cvt_pk_bf16_f32 v43, v70, v71
    s_add_u32 s45, s46, 16384
    buffer_store_dwordx4 v[40:43], v0, s[8:11], s45 offen nt
    s_waitcnt lgkmcnt(2)
    v_mfma_f32_32x32x16_bf16 v[48:63], v[116:119], a[28:31], v[48:63]
    ds_read_b128 v[112:115], v4 offset:22528
    v_mul_f32 v28, v80, v80
    v_mul_f32 v31, v81, v81
    v_mul_f32 v34, v82, v82
    v_mul_f32 v37, v83, v83
    v_mul_f32 v29, v80, v88
    v_mfma_f32_32x32x16_bf16 v[48:63], v[120:123], a[32:35], v[48:63]
    ds_read_b128 v[116:119], v4 offset:23552
    v_mul_f32 v32, v81, v89
    v_mul_f32 v35, v82, v90
    v_mul_f32 v38, v83, v91
    v_fma_f32 v28, v28, v26, v25
    v_fma_f32 v31, v31, v26, v25
    s_barrier
    s_waitcnt lgkmcnt(2)
    v_mfma_f32_32x32x16_bf16 v[48:63], v[124:127], a[36:39], v[48:63]
    ds_read_b128 v[120:123], v4 offset:24576
    ds_write_b128 v5, a[208:211] offset:53248
    v_fma_f32 v34, v34, v26, v25
    v_mfma_f32_32x32x16_bf16 v[48:63], v[128:131], a[40:43], v[48:63]
    ds_read_b128 v[124:127], v4 offset:25600
    v_fma_f32 v37, v37, v26, v25
    v_mul_f32 v28, v28, v80
    v_mul_f32 v31, v31, v81
    v_mul_f32 v34, v34, v82
    v_mul_f32 v37, v37, v83
    s_waitcnt lgkmcnt(3)
    v_mfma_f32_32x32x16_bf16 v[48:63], v[112:115], a[44:47], v[48:63]
    ds_read_b128 v[128:131], v4 offset:26624
    v_exp_f32 v28, v28
    v_exp_f32 v31, v31
    v_exp_f32 v34, v34
    v_mfma_f32_32x32x16_bf16 v[48:63], v[116:119], a[48:51], v[48:63]
    ds_read_b128 v[112:115], v4 offset:27648
    ds_write_b128 v5, a[212:215] offset:57344
    v_exp_f32 v37, v37
    s_waitcnt lgkmcnt(3)
    v_mfma_f32_32x32x16_bf16 v[48:63], v[120:123], a[52:55], v[48:63]
    ds_read_b128 v[116:119], v4 offset:28672
    v_fma_f32 v28, v28, v27, v27
    v_fma_f32 v31, v31, v27, v27
    v_fma_f32 v34, v34, v27, v27
    v_fma_f32 v37, v37, v27, v27
    v_rcp_f32 v28, v28
    v_mfma_f32_32x32x16_bf16 v[48:63], v[124:127], a[56:59], v[48:63]
    ds_read_b128 v[120:123], v4 offset:29696
    v_rcp_f32 v31, v31
    v_rcp_f32 v34, v34
    v_rcp_f32 v37, v37
    s_waitcnt lgkmcnt(3)
    v_mfma_f32_32x32x16_bf16 v[48:63], v[128:131], a[60:63], v[48:63]
    ds_read_b128 v[124:127], v4 offset:30720
    ds_write_b128 v5, a[216:219] offset:0
    v_mul_f32 v80, v29, v28
    v_mfma_f32_32x32x16_bf16 v[48:63], v[112:115], a[64:67], v[48:63]
    ds_read_b128 v[128:131], v4 offset:31744
    v_mul_f32 v81, v32, v31
    v_mul_f32 v82, v35, v34
    v_mul_f32 v83, v38, v37
    v_mul_f32 v28, v84, v84
    v_mul_f32 v31, v85, v85
    s_waitcnt lgkmcnt(3)
    v_mfma_f32_32x32x16_bf16 v[48:63], v[116:119], a[68:71], v[48:63]
    ds_read_b128 v[112:115], v4 offset:32768
    v_mul_f32 v34, v86, v86
    v_mul_f32 v37, v87, v87
    v_mul_f32 v29, v84, v92
    v_mul_f32 v32, v85, v93
    v_mul_f32 v35, v86, v94
    v_mfma_f32_32x32x16_bf16 v[48:63], v[120:123], a[72:75], v[48:63]
    ds_read_b128 v[116:119], v4 offset:33792
    s_add_u32 s58, s28, 4
    v_mov_b32 v7, s58
    s_waitcnt vmcnt(0)
    buffer_store_dword v7, off, s[8:11], s25
    s_waitcnt lgkmcnt(2)
    v_mfma_f32_32x32x16_bf16 v[48:63], v[124:127], a[76:79], v[48:63]
    ds_read_b128 v[120:123], v4 offset:34816
    v_mul_f32 v38, v87, v95
    v_fma_f32 v28, v28, v26, v25
    v_fma_f32 v31, v31, v26, v25
    v_fma_f32 v34, v34, v26, v25
    v_fma_f32 v37, v37, v26, v25
    v_mfma_f32_32x32x16_bf16 v[48:63], v[128:131], a[80:83], v[48:63]
    ds_read_b128 v[124:127], v4 offset:35840
    v_mul_f32 v28, v28, v84
    v_mul_f32 v31, v31, v85
    v_mul_f32 v34, v34, v86
    v_mul_f32 v37, v37, v87
    v_exp_f32 v28, v28
    s_waitcnt lgkmcnt(2)
    v_mfma_f32_32x32x16_bf16 v[48:63], v[112:115], a[84:87], v[48:63]
    ds_read_b128 v[128:131], v4 offset:36864
    ds_write_b128 v5, a[220:223] offset:4096
    v_exp_f32 v31, v31
    v_mfma_f32_32x32x16_bf16 v[48:63], v[116:119], a[88:91], v[48:63]
    ds_read_b128 v[112:115], v4 offset:37888
    ds_write_b128 v5, a[224:227] offset:8192
    v_exp_f32 v34, v34
    s_waitcnt lgkmcnt(4)
    v_mfma_f32_32x32x16_bf16 v[48:63], v[120:123], a[92:95], v[48:63]
    ds_read_b128 v[116:119], v4 offset:38912
    ds_write_b128 v5, a[228:231] offset:12288
    v_exp_f32 v37, v37
    v_mfma_f32_32x32x16_bf16 v[48:63], v[124:127], a[96:99], v[48:63]
    ds_read_b128 v[120:123], v4 offset:39936
    ds_write_b128 v5, a[232:235] offset:16384
    v_fma_f32 v28, v28, v27, v27
    s_waitcnt lgkmcnt(5)
    v_mfma_f32_32x32x16_bf16 v[48:63], v[128:131], a[100:103], v[48:63]
    ds_read_b128 v[124:127], v4 offset:40960
    v_fma_f32 v31, v31, v27, v27
    v_fma_f32 v34, v34, v27, v27
    v_fma_f32 v37, v37, v27, v27
    v_rcp_f32 v28, v28
    v_mfma_f32_32x32x16_bf16 v[48:63], v[112:115], a[104:107], v[48:63]
    ds_read_b128 v[128:131], v4 offset:41984
    v_rcp_f32 v31, v31
    v_rcp_f32 v34, v34
    v_rcp_f32 v37, v37
    s_waitcnt lgkmcnt(3)
    v_mfma_f32_32x32x16_bf16 v[48:63], v[116:119], a[108:111], v[48:63]
    ds_read_b128 v[112:115], v4 offset:43008
    buffer_load_dword v6, v2, s[8:11], s24 offen sc1
    v_mfma_f32_32x32x16_bf16 v[48:63], v[120:123], a[112:115], v[48:63]
    ds_read_b128 v[116:119], v4 offset:44032
    v_mul_f32 v84, v29, v28
    v_mul_f32 v85, v32, v31
    v_mul_f32 v86, v35, v34
    v_mul_f32 v87, v38, v37
    v_cvt_pk_bf16_f32 v40, v80, v81
    s_waitcnt lgkmcnt(2)
    v_mfma_f32_32x32x16_bf16 v[48:63], v[124:127], a[116:119], v[48:63]
    ds_read_b128 v[120:123], v4 offset:45056
    v_cvt_pk_bf16_f32 v41, v82, v83
    v_cvt_pk_bf16_f32 v42, v84, v85
    v_cvt_pk_bf16_f32 v43, v86, v87
    s_add_u32 s45, s46, 32768
    buffer_store_dwordx4 v[40:43], v0, s[8:11], s45 offen nt
    v_mfma_f32_32x32x16_bf16 v[48:63], v[128:131], a[120:123], v[48:63]
    ds_read_b128 v[124:127], v4 offset:46080
    s_waitcnt lgkmcnt(2)
    v_mfma_f32_32x32x16_bf16 v[48:63], v[112:115], a[124:127], v[48:63]
    ds_read_b128 v[128:131], v4 offset:47104
    v_mfma_f32_32x32x16_bf16 v[48:63], v[116:119], v[16:19], v[48:63]
    ds_read_b128 v[112:115], v4 offset:48128
    s_waitcnt lgkmcnt(2)
    v_mfma_f32_32x32x16_bf16 v[64:79], v[120:123], a[0:3], 0
    ds_read_b128 v[116:119], v4 offset:49152
    v_mfma_f32_32x32x16_bf16 v[64:79], v[124:127], a[4:7], v[64:79]
    ds_read_b128 v[120:123], v4 offset:50176
    s_waitcnt lgkmcnt(2)
    v_mfma_f32_32x32x16_bf16 v[64:79], v[128:131], a[8:11], v[64:79]
    ds_read_b128 v[124:127], v4 offset:51200
    s_nop 2
    v_mul_f32 v28, v48, v48
    v_mul_f32 v31, v49, v49
    v_mul_f32 v34, v50, v50
    v_mul_f32 v37, v51, v51
    v_mul_f32 v29, v48, v56
    v_mfma_f32_32x32x16_bf16 v[64:79], v[112:115], a[12:15], v[64:79]
    ds_read_b128 v[128:131], v4 offset:52224
    v_mul_f32 v32, v49, v57
    v_mul_f32 v35, v50, v58
    v_mul_f32 v38, v51, v59
    v_fma_f32 v28, v28, v26, v25
    v_fma_f32 v31, v31, v26, v25
    s_barrier
    s_waitcnt lgkmcnt(2)
    v_mfma_f32_32x32x16_bf16 v[64:79], v[116:119], a[16:19], v[64:79]
    ds_read_b128 v[112:115], v4 offset:53248
    v_fma_f32 v34, v34, v26, v25
    v_fma_f32 v37, v37, v26, v25
    v_mul_f32 v28, v28, v48
    v_mul_f32 v31, v31, v49
    v_mul_f32 v34, v34, v50
    v_mfma_f32_32x32x16_bf16 v[64:79], v[120:123], a[20:23], v[64:79]
    ds_read_b128 v[116:119], v4 offset:54272
    v_mul_f32 v37, v37, v51
    v_exp_f32 v28, v28
    v_exp_f32 v31, v31
    s_waitcnt lgkmcnt(2)
    v_mfma_f32_32x32x16_bf16 v[64:79], v[124:127], a[24:27], v[64:79]
    ds_read_b128 v[120:123], v4 offset:55296
    s_add_u32 s62, s28, 3
    s_waitcnt vmcnt(1)
    v_cmp_gt_u32 vcc, s62, v6
    s_cbranch_vccnz ob218
or219:
    s_add_u32 s64, s22, 0
    buffer_load_dwordx4 v[132:135], v0, s[8:11], s64 offen offset:0 sc1
    buffer_load_dwordx4 v[136:139], v0, s[8:11], s64 offen offset:1024 sc1
    buffer_load_dwordx4 v[140:143], v0, s[8:11], s64 offen offset:2048 sc1
    buffer_load_dwordx4 v[144:147], v0, s[8:11], s64 offen offset:3072 sc1
    s_add_u32 s64, s22, 4096
    buffer_load_dwordx4 v[148:151], v0, s[8:11], s64 offen offset:0 sc1
    buffer_load_dwordx4 v[152:155], v0, s[8:11], s64 offen offset:1024 sc1
    buffer_load_dwordx4 v[44:47], v0, s[8:11], s64 offen offset:2048 sc1
    buffer_load_dwordx4 v[8:11], v0, s[8:11], s64 offen offset:3072 sc1
    v_mfma_f32_32x32x16_bf16 v[64:79], v[128:131], a[28:31], v[64:79]
    ds_read_b128 v[124:127], v4 offset:56320
    v_exp_f32 v34, v34
    v_exp_f32 v37, v37
    v_fma_f32 v28, v28, v27, v27
    s_waitcnt lgkmcnt(2)
    v_mfma_f32_32x32x16_bf16 v[64:79], v[112:115], a[32:35], v[64:79]
    ds_read_b128 v[128:131], v4 offset:57344
    s_add_u32 s58, s28, 5
    v_mov_b32 v7, s58
    s_waitcnt vmcnt(8)
    buffer_store_dword v7, off, s[8:11], s25
    v_mfma_f32_32x32x16_bf16 v[64:79], v[116:119], a[36:39], v[64:79]
    ds_read_b128 v[112:115], v4 offset:58368
    ds_write_b128 v5, a[236:239] offset:20480
    v_fma_f32 v31, v31, v27, v27
    s_waitcnt lgkmcnt(3)
    v_mfma_f32_32x32x16_bf16 v[64:79], v[120:123], a[40:43], v[64:79]
    ds_read_b128 v[116:119], v4 offset:59392
    v_fma_f32 v34, v34, v27, v27
    v_fma_f32 v37, v37, v27, v27
    v_rcp_f32 v28, v28
    v_rcp_f32 v31, v31
    v_mfma_f32_32x32x16_bf16 v[64:79], v[124:127], a[44:47], v[64:79]
    ds_read_b128 v[120:123], v4 offset:60416
    v_rcp_f32 v34, v34
    v_rcp_f32 v37, v37
    v_mul_f32 v48, v29, v28
    s_waitcnt lgkmcnt(3)
    v_mfma_f32_32x32x16_bf16 v[64:79], v[128:131], a[48:51], v[64:79]
    ds_read_b128 v[124:127], v4 offset:0
    ds_write_b128 v5, a[240:243] offset:24576
    v_mul_f32 v49, v32, v31
    v_mfma_f32_32x32x16_bf16 v[64:79], v[112:115], a[52:55], v[64:79]
    ds_read_b128 v[128:131], v4 offset:1024
    v_mul_f32 v50, v35, v34
    v_mul_f32 v51, v38, v37
    v_mul_f32 v28, v52, v52
    v_mul_f32 v31, v53, v53
    v_mul_f32 v34, v54, v54
    s_waitcnt vmcnt(8) lgkmcnt(3)
    v_mfma_f32_32x32x16_bf16 v[96:111], v[116:119], v[132:135], 0
    ds_read_b128 v[112:115], v4 offset:2048
    s_add_u32 s64, s22, 8192
    buffer_load_dwordx4 v[12:15], v0, s[8:11], s64 offen offset:0 sc1
    v_mfma_f32_32x32x16_bf16 v[64:79], v[120:123], a[56:59], v[64:79]
    ds_read_b128 v[116:119], v4 offset:3072
    ds_write_b128 v5, a[244:247] offset:28672
    v_mul_f32 v37, v55, v55
    s_waitcnt vmcnt(8) lgkmcnt(3)
    v_mfma_f32_32x32x16_bf16 v[96:111], v[124:127], v[136:139], v[96:111]
    ds_read_b128 v[120:123], v4 offset:4096
    buffer_load_dwordx4 v[132:135], v0, s[8:11], s64 offen offset:1024 sc1
    ds_write_b128 v5, a[248:251] offset:32768
    v_mfma_f32_32x32x16_bf16 v[64:79], v[128:131], a[60:63], v[64:79]
    ds_read_b128 v[124:127], v4 offset:5120
    ds_write_b128 v5, a[252:255] offset:36864
    v_mul_f32 v29, v52, v60
    s_waitcnt vmcnt(8) lgkmcnt(5)
    v_mfma_f32_32x32x16_bf16 v[96:111], v[112:115], v[140:143], v[96:111]
    ds_read_b128 v[128:131], v4 offset:6144
    buffer_load_dwordx4 v[136:139], v0, s[8:11], s64 offen offset:2048 sc1
    ds_write_b128 v5, v[156:159] offset:40960
    v_mfma_f32_32x32x16_bf16 v[64:79], v[116:119], a[64:67], v[64:79]
    ds_read_b128 v[112:115], v4 offset:7168
    ds_write_b128 v5, v[160:163] offset:45056
    v_mul_f32 v32, v53, v61
    s_waitcnt vmcnt(8) lgkmcnt(5)
    v_mfma_f32_32x32x16_bf16 v[96:111], v[120:123], v[144:147], v[96:111]
    ds_read_b128 v[116:119], v4 offset:8192
    buffer_load_dwordx4 v[140:143], v0, s[8:11], s64 offen offset:3072 sc1
    buffer_load_dword v6, v2, s[8:11], s24 offen sc1
    v_mfma_f32_32x32x16_bf16 v[64:79], v[124:127], a[68:71], v[64:79]
    ds_read_b128 v[120:123], v4 offset:9216
    v_mul_f32 v35, v54, v62
    v_mul_f32 v38, v55, v63
    v_fma_f32 v28, v28, v26, v25
    v_fma_f32 v31, v31, v26, v25
    v_fma_f32 v34, v34, v26, v25
    s_waitcnt lgkmcnt(3)
    v_mfma_f32_32x32x16_bf16 v[64:79], v[128:131], a[72:75], v[64:79]
    ds_read_b128 v[124:127], v4 offset:10240
    v_fma_f32 v37, v37, v26, v25
    v_mul_f32 v28, v28, v52
    v_mul_f32 v31, v31, v53
    v_mul_f32 v34, v34, v54
    v_mul_f32 v37, v37, v55
    s_waitcnt vmcnt(9)
    v_mfma_f32_32x32x16_bf16 v[96:111], v[112:115], v[148:151], v[96:111]
    ds_read_b128 v[128:131], v4 offset:11264
    s_add_u32 s64, s22, 12288
    buffer_load_dwordx4 v[144:147], v0, s[8:11], s64 offen offset:0 sc1
    s_waitcnt lgkmcnt(2)
    v_mfma_f32_32x32x16_bf16 v[64:79], v[116:119], a[76:79], v[64:79]
    ds_read_b128 v[112:115], v4 offset:12288
    v_exp_f32 v28, v28
    v_exp_f32 v31, v31
    v_exp_f32 v34, v34
    s_waitcnt vmcnt(9)
    v_mfma_f32_32x32x16_bf16 v[96:111], v[120:123], v[152:155], v[96:111]
    ds_read_b128 v[116:119], v4 offset:13312
    buffer_load_dwordx4 v[148:151], v0, s[8:11], s64 offen offset:1024 sc1
    s_waitcnt lgkmcnt(2)
    v_mfma_f32_32x32x16_bf16 v[64:79], v[124:127], a[80:83], v[64:79]
    ds_read_b128 v[120:123], v4 offset:14336
    v_exp_f32 v37, v37
    v_fma_f32 v28, v28, v27, v27
    v_fma_f32 v31, v31, v27, v27
    v_fma_f32 v34, v34, v27, v27
    s_waitcnt vmcnt(9)
    v_mfma_f32_32x32x16_bf16 v[96:111], v[128:131], v[44:47], v[96:111]
    ds_read_b128 v[124:127], v4 offset:15360
    buffer_load_dwordx4 v[152:155], v0, s[8:11], s64 offen offset:2048 sc1
    s_waitcnt lgkmcnt(2)
    v_mfma_f32_32x32x16_bf16 v[64:79], v[112:115], a[84:87], v[64:79]
    ds_read_b128 v[128:131], v4 offset:16384
    v_fma_f32 v37, v37, v27, v27
    v_rcp_f32 v28, v28
    v_rcp_f32 v31, v31
    v_mfma_f32_32x32x16_bf16 v[64:79], v[116:119], a[88:91], v[64:79]
    ds_read_b128 v[112:115], v4 offset:17408
    v_rcp_f32 v34, v34
    v_rcp_f32 v37, v37
    v_mul_f32 v52, v29, v28
    s_waitcnt vmcnt(9) lgkmcnt(2)
    v_mfma_f32_32x32x16_bf16 v[96:111], v[120:123], v[8:11], v[96:111]
    ds_read_b128 v[116:119], v4 offset:18432
    buffer_load_dwordx4 v[44:47], v0, s[8:11], s64 offen offset:3072 sc1
    v_mfma_f32_32x32x16_bf16 v[64:79], v[124:127], a[92:95], v[64:79]
    ds_read_b128 v[120:123], v4 offset:19456
    v_mul_f32 v53, v32, v31
    v_mul_f32 v54, v35, v34
    v_mul_f32 v55, v38, v37
    v_cvt_pk_bf16_f32 v40, v48, v49
    v_cvt_pk_bf16_f32 v41, v50, v51
    s_barrier
    s_waitcnt vmcnt(8) lgkmcnt(2)
    v_mfma_f32_32x32x16_bf16 v[96:111], v[128:131], v[12:15], v[96:111]
    ds_read_b128 v[124:127], v4 offset:20480
    s_add_u32 s62, s28, 4
    s_waitcnt vmcnt(4)
    v_cmp_gt_u32 vcc, s62, v6
    s_cbranch_vccnz ob220
or221:
    s_add_u32 s64, s22, 16384
    buffer_load_dwordx4 v[8:11], v0, s[8:11], s64 offen offset:0 sc1
    v_mfma_f32_32x32x16_bf16 v[64:79], v[112:115], a[96:99], v[64:79]
    ds_read_b128 v[128:131], v4 offset:21504
    ds_write_b128 v5, v[164:167] offset:49152
    v_cvt_pk_bf16_f32 v42, v52, v53
    s_waitcnt lgkmcnt(3)
    v_mfma_f32_32x32x16_bf16 v[96:111], v[116:119], v[132:135], v[96:111]
    ds_read_b128 v[112:115], v4 offset:22528
    buffer_load_dwordx4 v[12:15], v0, s[8:11], s64 offen offset:1024 sc1
    v_mfma_f32_32x32x16_bf16 v[64:79], v[120:123], a[100:103], v[64:79]
    ds_read_b128 v[116:119], v4 offset:23552
    v_cvt_pk_bf16_f32 v43, v54, v55
    s_add_u32 s45, s46, 49152
    buffer_store_dwordx4 v[40:43], v0, s[8:11], s45 offen nt
    s_waitcnt lgkmcnt(3)
    v_mfma_f32_32x32x16_bf16 v[64:79], v[124:127], a[104:107], v[64:79]
    ds_read_b128 v[120:123], v4 offset:24576
    ds_write_b128 v5, v[168:171] offset:53248
    v_mfma_f32_32x32x16_bf16 v[96:111], v[128:131], v[136:139], v[96:111]
    ds_read_b128 v[124:127], v4 offset:25600
    buffer_load_dwordx4 v[132:135], v0, s[8:11], s64 offen offset:2048 sc1
    s_waitcnt lgkmcnt(3)
    v_mfma_f32_32x32x16_bf16 v[64:79], v[112:115], a[108:111], v[64:79]
    ds_read_b128 v[128:131], v4 offset:26624
    v_mfma_f32_32x32x16_bf16 v[96:111], v[116:119], v[140:143], v[96:111]
    ds_read_b128 v[112:115], v4 offset:27648
    buffer_load_dwordx4 v[136:139], v0, s[8:11], s64 offen offset:3072 sc1
    s_waitcnt lgkmcnt(2)
    v_mfma_f32_32x32x16_bf16 v[64:79], v[120:123], a[112:115], v[64:79]
    ds_read_b128 v[116:119], v4 offset:28672
    s_waitcnt vmcnt(8)
    v_mfma_f32_32x32x16_bf16 v[96:111], v[124:127], v[144:147], v[96:111]
    ds_read_b128 v[120:123], v4 offset:29696
    s_add_u32 s64, s22, 20480
    buffer_load_dwordx4 v[140:143], v0, s[8:11], s64 offen offset:0 sc1
    s_waitcnt lgkmcnt(2)
    v_mfma_f32_32x32x16_bf16 v[64:79], v[128:131], a[116:119], v[64:79]
    ds_read_b128 v[124:127], v4 offset:30720
    ds_write_b128 v5, v[172:175] offset:57344
    s_waitcnt vmcnt(8)
    v_mfma_f32_32x32x16_bf16 v[96:111], v[112:115], v[148:151], v[96:111]
    ds_read_b128 v[128:131], v4 offset:31744
    buffer_load_dwordx4 v[144:147], v0, s[8:11], s64 offen offset:1024 sc1
    s_waitcnt lgkmcnt(3)
    v_mfma_f32_32x32x16_bf16 v[64:79], v[116:119], a[120:123], v[64:79]
    ds_read_b128 v[112:115], v4 offset:32768
    ds_write_b128 v5, v[176:179] offset:0
    v_mfma_f32_32x32x16_bf16 v[64:79], v[120:123], a[124:127], v[64:79]
    ds_read_b128 v[116:119], v4 offset:33792
    ds_write_b128 v5, v[180:183] offset:4096
    s_waitcnt vmcnt(8) lgkmcnt(4)
    v_mfma_f32_32x32x16_bf16 v[96:111], v[124:127], v[152:155], v[96:111]
    ds_read_b128 v[120:123], v4 offset:34816
    buffer_load_dwordx4 v[148:151], v0, s[8:11], s64 offen offset:2048 sc1
    ds_write_b128 v5, v[184:187] offset:8192
    v_mfma_f32_32x32x16_bf16 v[64:79], v[128:131], v[16:19], v[64:79]
    ds_read_b128 v[124:127], v4 offset:35840
    s_add_u32 s58, s28, 6
    v_mov_b32 v7, s58
    s_waitcnt vmcnt(5)
    buffer_store_dword v7, off, s[8:11], s25
    s_waitcnt lgkmcnt(4)
    v_mfma_f32_32x32x16_bf16 v[96:111], v[112:115], v[44:47], v[96:111]
    ds_read_b128 v[128:131], v4 offset:36864
    buffer_load_dwordx4 v[152:155], v0, s[8:11], s64 offen offset:3072 sc1
    ds_write_b128 v5, v[188:191] offset:12288
    v_mfma_f32_32x32x16_bf16 v[80:95], v[116:119], a[0:3], 0
    ds_read_b128 v[112:115], v4 offset:37888
    s_waitcnt lgkmcnt(3)
    v_mfma_f32_32x32x16_bf16 v[96:111], v[120:123], v[8:11], v[96:111]
    ds_read_b128 v[116:119], v4 offset:38912
    s_add_u32 s64, s22, 24576
    buffer_load_dwordx4 v[44:47], v0, s[8:11], s64 offen offset:0 sc1
    v_mfma_f32_32x32x16_bf16 v[80:95], v[124:127], a[4:7], v[80:95]
    ds_read_b128 v[120:123], v4 offset:39936
    v_mul_f32 v28, v64, v64
    v_mul_f32 v31, v65, v65
    v_mul_f32 v34, v66, v66
    v_mul_f32 v37, v67, v67
    v_mul_f32 v29, v64, v72
    s_waitcnt lgkmcnt(2)
    v_mfma_f32_32x32x16_bf16 v[80:95], v[128:131], a[8:11], v[80:95]
    ds_read_b128 v[124:127], v4 offset:40960
    v_mul_f32 v32, v65, v73
    v_mul_f32 v35, v66, v74
    v_mul_f32 v38, v67, v75
    v_fma_f32 v28, v28, v26, v25
    v_fma_f32 v31, v31, v26, v25
    v_mfma_f32_32x32x16_bf16 v[96:111], v[112:115], v[12:15], v[96:111]
    ds_read_b128 v[128:131], v4 offset:41984
    buffer_load_dwordx4 v[8:11], v0, s[8:11], s64 offen offset:1024 sc1
    s_waitcnt lgkmcnt(2)
    v_mfma_f32_32x32x16_bf16 v[80:95], v[116:119], a[12:15], v[80:95]
    ds_read_b128 v[112:115], v4 offset:43008
    v_fma_f32 v34, v34, v26, v25
    v_fma_f32 v37, v37, v26, v25
    v_mul_f32 v28, v28, v64
    v_mul_f32 v31, v31, v65
    v_mul_f32 v34, v34, v66
    s_waitcnt vmcnt(8)
    v_mfma_f32_32x32x16_bf16 v[96:111], v[120:123], v[132:135], v[96:111]
    ds_read_b128 v[116:119], v4 offset:44032
    buffer_load_dwordx4 v[12:15], v0, s[8:11], s64 offen offset:2048 sc1
    s_waitcnt lgkmcnt(2)
    v_mfma_f32_32x32x16_bf16 v[80:95], v[124:127], a[16:19], v[80:95]
    ds_read_b128 v[120:123], v4 offset:45056
    v_mul_f32 v37, v37, v67
    v_exp_f32 v28, v28
    v_exp_f32 v31, v31
    s_waitcnt vmcnt(8)
    v_mfma_f32_32x32x16_bf16 v[96:111], v[128:131], v[136:139], v[96:111]
    ds_read_b128 v[124:127], v4 offset:46080
    buffer_load_dwordx4 v[132:135], v0, s[8:11], s64 offen offset:3072 sc1
    buffer_load_dword v6, v2, s[8:11], s24 offen sc1
    s_waitcnt lgkmcnt(2)
    v_mfma_f32_32x32x16_bf16 v[80:95], v[112:115], a[20:23], v[80:95]
    ds_read_b128 v[128:131], v4 offset:47104
    v_exp_f32 v34, v34
    v_exp_f32 v37, v37
    v_fma_f32 v28, v28, v27, v27
    v_mfma_f32_32x32x16_bf16 v[80:95], v[116:119], a[24:27], v[80:95]
    ds_read_b128 v[112:115], v4 offset:48128
    v_fma_f32 v31, v31, v27, v27
    v_fma_f32 v34, v34, v27, v27
    v_fma_f32 v37, v37, v27, v27
    v_rcp_f32 v28, v28
    s_barrier
    s_waitcnt vmcnt(9) lgkmcnt(2)
    v_mfma_f32_32x32x16_bf16 v[96:111], v[120:123], v[140:143], v[96:111]
    ds_read_b128 v[116:119], v4 offset:49152
    s_add_u32 s64, s22, 28672
    buffer_load_dwordx4 v[136:139], v0, s[8:11], s64 offen offset:0 sc1
    v_mfma_f32_32x32x16_bf16 v[80:95], v[124:127], a[28:31], v[80:95]
    ds_read_b128 v[120:123], v4 offset:50176
    v_rcp_f32 v31, v31
    v_rcp_f32 v34, v34
    v_rcp_f32 v37, v37
    s_waitcnt vmcnt(9) lgkmcnt(2)
    v_mfma_f32_32x32x16_bf16 v[96:111], v[128:131], v[144:147], v[96:111]
    ds_read_b128 v[124:127], v4 offset:51200
    buffer_load_dwordx4 v[140:143], v0, s[8:11], s64 offen offset:1024 sc1
    v_mfma_f32_32x32x16_bf16 v[80:95], v[112:115], a[32:35], v[80:95]
    ds_read_b128 v[128:131], v4 offset:52224
    ds_write_b128 v5, v[192:195] offset:16384
    v_mul_f32 v64, v29, v28
    s_waitcnt vmcnt(9) lgkmcnt(3)
    v_mfma_f32_32x32x16_bf16 v[96:111], v[116:119], v[148:151], v[96:111]
    ds_read_b128 v[112:115], v4 offset:53248
    buffer_load_dwordx4 v[144:147], v0, s[8:11], s64 offen offset:2048 sc1
    v_mfma_f32_32x32x16_bf16 v[80:95], v[120:123], a[36:39], v[80:95]
    ds_read_b128 v[116:119], v4 offset:54272
    v_mul_f32 v65, v32, v31
    v_mul_f32 v66, v35, v34
    v_mul_f32 v67, v38, v37
    v_mul_f32 v28, v68, v68
    v_mul_f32 v31, v69, v69
    s_waitcnt vmcnt(8) lgkmcnt(3)
    v_mfma_f32_32x32x16_bf16 v[96:111], v[124:127], v[152:155], v[96:111]
    ds_read_b128 v[120:123], v4 offset:55296
    buffer_load_dwordx4 v[148:151], v0, s[8:11], s64 offen offset:3072 sc1
    v_mfma_f32_32x32x16_bf16 v[80:95], v[128:131], a[40:43], v[80:95]
    ds_read_b128 v[124:127], v4 offset:56320
    v_mul_f32 v34, v70, v70
    v_mul_f32 v37, v71, v71
    v_mul_f32 v29, v68, v76
    v_mul_f32 v32, v69, v77
    v_mul_f32 v35, v70, v78
    s_waitcnt lgkmcnt(2)
    v_mfma_f32_32x32x16_bf16 v[80:95], v[112:115], a[44:47], v[80:95]
    ds_read_b128 v[128:131], v4 offset:57344
    v_mul_f32 v38, v71, v79
    v_fma_f32 v28, v28, v26, v25
    v_fma_f32 v31, v31, v26, v25
    v_fma_f32 v34, v34, v26, v25
    v_fma_f32 v37, v37, v26, v25
    s_waitcnt vmcnt(8)
    v_mfma_f32_32x32x16_bf16 v[96:111], v[116:119], v[44:47], v[96:111]
    ds_read_b128 v[112:115], v4 offset:58368
    s_add_u32 s62, s28, 5
    s_waitcnt vmcnt(4)
    v_cmp_gt_u32 vcc, s62, v6
    s_cbranch_vccnz ob222
or223:
    s_add_u32 s64, s22, 32768
    buffer_load_dwordx4 v[152:155], v0, s[8:11], s64 offen offset:0 sc1
    s_waitcnt lgkmcnt(2)
    v_mfma_f32_32x32x16_bf16 v[80:95], v[120:123], a[48:51], v[80:95]
    ds_read_b128 v[116:119], v4 offset:59392
    v_mul_f32 v28, v28, v68
    v_mul_f32 v31, v31, v69
    v_mul_f32 v34, v34, v70
    v_mul_f32 v37, v37, v71
    v_exp_f32 v28, v28
    v_mfma_f32_32x32x16_bf16 v[96:111], v[124:127], v[8:11], v[96:111]
    ds_read_b128 v[120:123], v4 offset:60416
    buffer_load_dwordx4 v[44:47], v0, s[8:11], s64 offen offset:1024 sc1
    s_waitcnt lgkmcnt(2)
    v_mfma_f32_32x32x16_bf16 v[80:95], v[128:131], a[52:55], v[80:95]
    ds_read_b128 v[124:127], v4 offset:0
    ds_write_b128 v5, v[196:199] offset:20480
    v_exp_f32 v31, v31
    v_mfma_f32_32x32x16_bf16 v[96:111], v[112:115], v[12:15], v[96:111]
    ds_read_b128 v[128:131], v4 offset:1024
    buffer_load_dwordx4 v[8:11], v0, s[8:11], s64 offen offset:2048 sc1
    ds_write_b128 v5, v[200:203] offset:24576
    s_waitcnt lgkmcnt(4)
    v_mfma_f32_32x32x16_bf16 v[80:95], v[116:119], a[56:59], v[80:95]
    ds_read_b128 v[112:115], v4 offset:2048
    ds_write_b128 v5, v[204:207] offset:28672
    v_exp_f32 v34, v34
    v_mfma_f32_32x32x16_bf16 v[80:95], v[120:123], a[60:63], v[80:95]
    ds_read_b128 v[116:119], v4 offset:3072
    ds_write_b128 v5, v[208:211] offset:32768
    v_exp_f32 v37, v37
    s_waitcnt lgkmcnt(5)
    v_mfma_f32_32x32x16_bf16 v[96:111], v[124:127], v[132:135], v[96:111]
    ds_read_b128 v[120:123], v4 offset:4096
    buffer_load_dwordx4 v[12:15], v0, s[8:11], s64 offen offset:3072 sc1
    ds_write_b128 v5, v[212:215] offset:36864
    v_mfma_f32_32x32x16_bf16 v[80:95], v[128:131], a[64:67], v[80:95]
    ds_read_b128 v[124:127], v4 offset:5120
    ds_write_b128 v5, v[216:219] offset:40960
    v_fma_f32 v28, v28, v27, v27
    s_waitcnt vmcnt(7) lgkmcnt(5)
    v_mfma_f32_32x32x16_bf16 v[96:111], v[112:115], v[136:139], v[96:111]
    ds_read_b128 v[128:131], v4 offset:6144
    s_add_u32 s64, s22, 36864
    buffer_load_dwordx4 v[132:135], v0, s[8:11], s64 offen offset:0 sc1
    v_mfma_f32_32x32x16_bf16 v[80:95], v[116:119], a[68:71], v[80:95]
    ds_read_b128 v[112:115], v4 offset:7168
    v_fma_f32 v31, v31, v27, v27
    v_fma_f32 v34, v34, v27, v27
    v_fma_f32 v37, v37, v27, v27
    v_rcp_f32 v28, v28
    s_waitcnt vmcnt(7) lgkmcnt(3)
    v_mfma_f32_32x32x16_bf16 v[96:111], v[120:123], v[140:143], v[96:111]
    ds_read_b128 v[116:119], v4 offset:8192
    buffer_load_dwordx4 v[136:139], v0, s[8:11], s64 offen offset:1024 sc1
    v_mfma_f32_32x32x16_bf16 v[80:95], v[124:127], a[72:75], v[80:95]
    ds_read_b128 v[120:123], v4 offset:9216
    v_rcp_f32 v31, v31
    v_rcp_f32 v34, v34
    v_rcp_f32 v37, v37
    s_waitcnt lgkmcnt(2)
    v_mfma_f32_32x32x16_bf16 v[80:95], v[128:131], a[76:79], v[80:95]
    ds_read_b128 v[124:127], v4 offset:10240
    v_mul_f32 v68, v29, v28
    v_mul_f32 v69, v32, v31
    v_mul_f32 v70, v35, v34
    v_mul_f32 v71, v38, v37
    v_cvt_pk_bf16_f32 v40, v64, v65
    s_waitcnt vmcnt(7)
    v_mfma_f32_32x32x16_bf16 v[96:111], v[112:115], v[144:147], v[96:111]
    ds_read_b128 v[128:131], v4 offset:11264
    buffer_load_dwordx4 v[140:143], v0, s[8:11], s64 offen offset:2048 sc1
    s_waitcnt lgkmcnt(2)
    v_mfma_f32_32x32x16_bf16 v[80:95], v[116:119], a[80:83], v[80:95]
    ds_read_b128 v[112:115], v4 offset:12288
    v_cvt_pk_bf16_f32 v41, v66, v67
    v_cvt_pk_bf16_f32 v42, v68, v69
    v_cvt_pk_bf16_f32 v43, v70, v71
    s_add_u32 s45, s46, 65536
    buffer_store_dwordx4 v[40:43], v0, s[8:11], s45 offen nt
    s_waitcnt vmcnt(8)
    v_mfma_f32_32x32x16_bf16 v[96:111], v[120:123], v[148:151], v[96:111]
    ds_read_b128 v[116:119], v4 offset:13312
    buffer_load_dwordx4 v[144:147], v0, s[8:11], s64 offen offset:3072 sc1
    s_waitcnt lgkmcnt(2)
    v_mfma_f32_32x32x16_bf16 v[80:95], v[124:127], a[84:87], v[80:95]
    ds_read_b128 v[120:123], v4 offset:14336
    s_waitcnt vmcnt(8)
    v_mfma_f32_32x32x16_bf16 v[96:111], v[128:131], v[152:155], v[96:111]
    ds_read_b128 v[124:127], v4 offset:15360
    s_add_u32 s64, s22, 40960
    buffer_load_dwordx4 v[148:151], v0, s[8:11], s64 offen offset:0 sc1
    s_barrier
    s_waitcnt lgkmcnt(2)
    v_mfma_f32_32x32x16_bf16 v[80:95], v[112:115], a[88:91], v[80:95]
    ds_read_b128 v[128:131], v4 offset:16384
    s_waitcnt vmcnt(8)
    v_mfma_f32_32x32x16_bf16 v[96:111], v[116:119], v[44:47], v[96:111]
    ds_read_b128 v[112:115], v4 offset:17408
    buffer_load_dwordx4 v[152:155], v0, s[8:11], s64 offen offset:1024 sc1
    s_waitcnt lgkmcnt(2)
    v_mfma_f32_32x32x16_bf16 v[80:95], v[120:123], a[92:95], v[80:95]
    ds_read_b128 v[116:119], v4 offset:18432
    ds_write_b128 v5, v[220:223] offset:45056
    v_mfma_f32_32x32x16_bf16 v[80:95], v[124:127], a[96:99], v[80:95]
    ds_read_b128 v[120:123], v4 offset:19456
    s_waitcnt vmcnt(8) lgkmcnt(3)
    v_mfma_f32_32x32x16_bf16 v[96:111], v[128:131], v[8:11], v[96:111]
    ds_read_b128 v[124:127], v4 offset:20480
    buffer_load_dwordx4 v[44:47], v0, s[8:11], s64 offen offset:2048 sc1
    v_mfma_f32_32x32x16_bf16 v[80:95], v[112:115], a[100:103], v[80:95]
    ds_read_b128 v[128:131], v4 offset:21504
    ds_write_b128 v5, v[224:227] offset:49152
    s_waitcnt vmcnt(8) lgkmcnt(3)
    v_mfma_f32_32x32x16_bf16 v[96:111], v[116:119], v[12:15], v[96:111]
    ds_read_b128 v[112:115], v4 offset:22528
    buffer_load_dwordx4 v[8:11], v0, s[8:11], s64 offen offset:3072 sc1
    buffer_load_dword v6, v2, s[8:11], s24 offen sc1
    v_mfma_f32_32x32x16_bf16 v[80:95], v[120:123], a[104:107], v[80:95]
    ds_read_b128 v[116:119], v4 offset:23552
    s_waitcnt vmcnt(9) lgkmcnt(3)
    v_mfma_f32_32x32x16_bf16 v[96:111], v[124:127], v[132:135], v[96:111]
    ds_read_b128 v[120:123], v4 offset:24576
    s_add_u32 s64, s22, 45056
    buffer_load_dwordx4 v[12:15], v0, s[8:11], s64 offen offset:0 sc1
    v_mfma_f32_32x32x16_bf16 v[80:95], v[128:131], a[108:111], v[80:95]
    ds_read_b128 v[124:127], v4 offset:25600
    s_add_u32 s58, s28, 7
    v_mov_b32 v7, s58
    s_waitcnt vmcnt(7)
    buffer_store_dword v7, off, s[8:11], s25
    s_waitcnt lgkmcnt(2)
    v_mfma_f32_32x32x16_bf16 v[80:95], v[112:115], a[112:115], v[80:95]
    ds_read_b128 v[128:131], v4 offset:26624
    v_mfma_f32_32x32x16_bf16 v[96:111], v[116:119], v[136:139], v[96:111]
    ds_read_b128 v[112:115], v4 offset:27648
    buffer_load_dwordx4 v[132:135], v0, s[8:11], s64 offen offset:1024 sc1
    s_waitcnt lgkmcnt(2)
    v_mfma_f32_32x32x16_bf16 v[80:95], v[120:123], a[116:119], v[80:95]
    ds_read_b128 v[116:119], v4 offset:28672
    ds_write_b128 v5, v[228:231] offset:53248
    v_mfma_f32_32x32x16_bf16 v[96:111], v[124:127], v[140:143], v[96:111]
    ds_read_b128 v[120:123], v4 offset:29696
    buffer_load_dwordx4 v[136:139], v0, s[8:11], s64 offen offset:2048 sc1
    ds_write_b128 v5, v[232:235] offset:57344
    s_waitcnt lgkmcnt(4)
    v_mfma_f32_32x32x16_bf16 v[80:95], v[128:131], a[120:123], v[80:95]
    ds_read_b128 v[124:127], v4 offset:30720
    ds_write_b128 v5, v[236:239] offset:0
    s_waitcnt vmcnt(9)
    v_mfma_f32_32x32x16_bf16 v[96:111], v[112:115], v[144:147], v[96:111]
    ds_read_b128 v[128:131], v4 offset:31744
    buffer_load_dwordx4 v[140:143], v0, s[8:11], s64 offen offset:3072 sc1
    ds_write_b128 v5, v[240:243] offset:4096
    s_waitcnt lgkmcnt(5)
    v_mfma_f32_32x32x16_bf16 v[80:95], v[116:119], a[124:127], v[80:95]
    ds_read_b128 v[112:115], v4 offset:32768
    ds_write_b128 v5, v[244:247] offset:8192
    v_mfma_f32_32x32x16_bf16 v[80:95], v[120:123], v[16:19], v[80:95]
    ds_read_b128 v[116:119], v4 offset:33792
    s_waitcnt vmcnt(9) lgkmcnt(4)
    v_mfma_f32_32x32x16_bf16 v[96:111], v[124:127], v[148:151], v[96:111]
    ds_read_b128 v[120:123], v4 offset:34816
    s_add_u32 s62, s28, 6
    s_waitcnt vmcnt(5)
    v_cmp_gt_u32 vcc, s62, v6
    s_cbranch_vccnz ob224
or225:
    s_add_u32 s64, s22, 49152
    buffer_load_dwordx4 v[144:147], v0, s[8:11], s64 offen offset:0 sc1
    v_mfma_f32_32x32x16_bf16 v[96:111], v[128:131], v[152:155], v[96:111]
    ds_read_b128 v[124:127], v4 offset:35840
    buffer_load_dwordx4 v[148:151], v0, s[8:11], s64 offen offset:1024 sc1
    s_waitcnt lgkmcnt(2)
    v_mfma_f32_32x32x16_bf16 v[96:111], v[112:115], v[44:47], v[96:111]
    ds_read_b128 v[128:131], v4 offset:36864
    buffer_load_dwordx4 v[152:155], v0, s[8:11], s64 offen offset:2048 sc1
    v_mfma_f32_32x32x16_bf16 v[96:111], v[116:119], v[8:11], v[96:111]
    ds_read_b128 v[112:115], v4 offset:37888
    buffer_load_dwordx4 v[44:47], v0, s[8:11], s64 offen offset:3072 sc1
    s_waitcnt vmcnt(8) lgkmcnt(2)
    v_mfma_f32_32x32x16_bf16 v[96:111], v[120:123], v[12:15], v[96:111]
    ds_read_b128 v[116:119], v4 offset:38912
    s_add_u32 s64, s22, 53248
    buffer_load_dwordx4 v[8:11], v0, s[8:11], s64 offen offset:0 sc1
    buffer_load_dword v6, v2, s[8:11], s24 offen sc1
    s_waitcnt vmcnt(8)
    v_mfma_f32_32x32x16_bf16 v[96:111], v[124:127], v[132:135], v[96:111]
    ds_read_b128 v[120:123], v4 offset:39936
    buffer_load_dwordx4 v[12:15], v0, s[8:11], s64 offen offset:1024 sc1
    s_waitcnt vmcnt(8) lgkmcnt(2)
    v_mfma_f32_32x32x16_bf16 v[96:111], v[128:131], v[136:139], v[96:111]
    ds_read_b128 v[124:127], v4 offset:40960
    buffer_load_dwordx4 v[132:135], v0, s[8:11], s64 offen offset:2048 sc1
    s_waitcnt vmcnt(8)
    v_mfma_f32_32x32x16_bf16 v[96:111], v[112:115], v[140:143], v[96:111]
    ds_read_b128 v[128:131], v4 offset:41984
    buffer_load_dwordx4 v[136:139], v0, s[8:11], s64 offen offset:3072 sc1
    s_waitcnt vmcnt(8) lgkmcnt(2)
    v_mfma_f32_32x32x16_bf16 v[96:111], v[116:119], v[144:147], v[96:111]
    ds_read_b128 v[112:115], v4 offset:43008
    s_add_u32 s64, s22, 57344
    buffer_load_dwordx4 v[140:143], v0, s[8:11], s64 offen offset:0 sc1
    s_waitcnt vmcnt(8)
    v_mfma_f32_32x32x16_bf16 v[96:111], v[120:123], v[148:151], v[96:111]
    ds_read_b128 v[116:119], v4 offset:44032
    buffer_load_dwordx4 v[144:147], v0, s[8:11], s64 offen offset:1024 sc1
    s_barrier
    s_waitcnt vmcnt(8) lgkmcnt(2)
    v_mfma_f32_32x32x16_bf16 v[96:111], v[124:127], v[152:155], v[96:111]
    ds_read_b128 v[120:123], v4 offset:45056
    buffer_load_dwordx4 v[148:151], v0, s[8:11], s64 offen offset:2048 sc1
    s_waitcnt vmcnt(8)
    v_mfma_f32_32x32x16_bf16 v[96:111], v[128:131], v[44:47], v[96:111]
    ds_read_b128 v[124:127], v4 offset:46080
    buffer_load_dwordx4 v[152:155], v0, s[8:11], s64 offen offset:3072 sc1
    s_waitcnt vmcnt(8) lgkmcnt(2)
    v_mfma_f32_32x32x16_bf16 v[96:111], v[112:115], v[8:11], v[96:111]
    ds_read_b128 v[128:131], v4 offset:47104
    s_add_u32 s64, s22, 61440
    buffer_load_dwordx4 v[44:47], v0, s[8:11], s64 offen offset:0 sc1
    s_waitcnt vmcnt(7)
    v_mfma_f32_32x32x16_bf16 v[96:111], v[116:119], v[12:15], v[96:111]
    ds_read_b128 v[112:115], v4 offset:48128
    buffer_load_dwordx4 v[8:11], v0, s[8:11], s64 offen offset:1024 sc1
    s_waitcnt vmcnt(7) lgkmcnt(2)
    v_mfma_f32_32x32x16_bf16 v[96:111], v[120:123], v[132:135], v[96:111]
    ds_read_b128 v[116:119], v4 offset:49152
    buffer_load_dwordx4 v[12:15], v0, s[8:11], s64 offen offset:2048 sc1
    s_waitcnt vmcnt(7)
    v_mfma_f32_32x32x16_bf16 v[96:111], v[124:127], v[136:139], v[96:111]
    ds_read_b128 v[120:123], v4 offset:50176
    buffer_load_dwordx4 v[132:135], v0, s[8:11], s64 offen offset:3072 sc1
    s_waitcnt vmcnt(7) lgkmcnt(2)
    v_mfma_f32_32x32x16_bf16 v[96:111], v[128:131], v[140:143], v[96:111]
    ds_read_b128 v[124:127], v4 offset:51200
    s_add_u32 s62, s28, 7
    v_cmp_gt_u32 vcc, s62, v6
    s_cbranch_vccnz ob226
or227:
    s_add_u32 s64, s22, 65536
    buffer_load_dwordx4 v[136:139], v0, s[8:11], s64 offen offset:0 sc1
    s_waitcnt vmcnt(7)
    v_mfma_f32_32x32x16_bf16 v[96:111], v[112:115], v[144:147], v[96:111]
    ds_read_b128 v[128:131], v4 offset:52224
    buffer_load_dwordx4 v[140:143], v0, s[8:11], s64 offen offset:1024 sc1
    s_waitcnt vmcnt(7) lgkmcnt(2)
    v_mfma_f32_32x32x16_bf16 v[96:111], v[116:119], v[148:151], v[96:111]
    ds_read_b128 v[112:115], v4 offset:53248
    buffer_load_dwordx4 v[144:147], v0, s[8:11], s64 offen offset:2048 sc1
    s_waitcnt vmcnt(7)
    v_mfma_f32_32x32x16_bf16 v[96:111], v[120:123], v[152:155], v[96:111]
    ds_read_b128 v[116:119], v4 offset:54272
    buffer_load_dwordx4 v[148:151], v0, s[8:11], s64 offen offset:3072 sc1
    s_waitcnt vmcnt(7) lgkmcnt(2)
    v_mfma_f32_32x32x16_bf16 v[96:111], v[124:127], v[44:47], v[96:111]
    ds_read_b128 v[120:123], v4 offset:55296
    s_add_u32 s64, s22, 69632
    buffer_load_dwordx4 v[152:155], v0, s[8:11], s64 offen offset:0 sc1
    v_mul_f32 v28, v80, v80
    v_mul_f32 v31, v81, v81
    v_mul_f32 v34, v82, v82
    v_mul_f32 v37, v83, v83
    v_mul_f32 v29, v80, v88
    v_mul_f32 v32, v81, v89
    v_mul_f32 v35, v82, v90
    v_mul_f32 v38, v83, v91
    v_fma_f32 v28, v28, v26, v25
    v_fma_f32 v31, v31, v26, v25
    v_fma_f32 v34, v34, v26, v25
    v_fma_f32 v37, v37, v26, v25
    v_mul_f32 v28, v28, v80
    v_mul_f32 v31, v31, v81
    v_mul_f32 v34, v34, v82
    v_mul_f32 v37, v37, v83
    v_exp_f32 v28, v28
    v_exp_f32 v31, v31
    v_exp_f32 v34, v34
    v_exp_f32 v37, v37
    v_fma_f32 v28, v28, v27, v27
    v_fma_f32 v31, v31, v27, v27
    v_fma_f32 v34, v34, v27, v27
    v_fma_f32 v37, v37, v27, v27
    v_rcp_f32 v28, v28
    v_rcp_f32 v31, v31
    v_rcp_f32 v34, v34
    v_rcp_f32 v37, v37
    v_mul_f32 v80, v29, v28
    v_mul_f32 v81, v32, v31
    v_mul_f32 v82, v35, v34
    v_mul_f32 v83, v38, v37
    v_mul_f32 v28, v84, v84
    v_mul_f32 v31, v85, v85
    v_mul_f32 v34, v86, v86
    v_mul_f32 v37, v87, v87
    v_mul_f32 v29, v84, v92
    v_mul_f32 v32, v85, v93
    v_mul_f32 v35, v86, v94
    v_mul_f32 v38, v87, v95
    v_fma_f32 v28, v28, v26, v25
    v_fma_f32 v31, v31, v26, v25
    v_fma_f32 v34, v34, v26, v25
    v_fma_f32 v37, v37, v26, v25
    v_mul_f32 v28, v28, v84
    v_mul_f32 v31, v31, v85
    v_mul_f32 v34, v34, v86
    v_mul_f32 v37, v37, v87
    v_exp_f32 v28, v28
    v_exp_f32 v31, v31
    v_exp_f32 v34, v34
    v_exp_f32 v37, v37
    v_fma_f32 v28, v28, v27, v27
    v_fma_f32 v31, v31, v27, v27
    v_fma_f32 v34, v34, v27, v27
    v_fma_f32 v37, v37, v27, v27
    v_rcp_f32 v28, v28
    v_rcp_f32 v31, v31
    v_rcp_f32 v34, v34
    v_rcp_f32 v37, v37
    v_mul_f32 v84, v29, v28
    v_mul_f32 v85, v32, v31
    v_mul_f32 v86, v35, v34
    v_mul_f32 v87, v38, v37
    v_cvt_pk_bf16_f32 v40, v80, v81
    v_cvt_pk_bf16_f32 v41, v82, v83
    v_cvt_pk_bf16_f32 v42, v84, v85
    v_cvt_pk_bf16_f32 v43, v86, v87
    s_add_u32 s45, s46, 81920
    buffer_store_dwordx4 v[40:43], v0, s[8:11], s45 offen nt
    s_add_u32 s58, s28, 8
    v_mov_b32 v7, s58
    s_waitcnt vmcnt(0)
    buffer_store_dword v7, off, s[8:11], s25
    buffer_load_dword v6, v2, s[8:11], s24 offen sc1
    v_mfma_f32_32x32x16_bf16 v[96:111], v[128:131], v[8:11], v[96:111]
    ds_read_b128 v[124:127], v4 offset:56320
    buffer_load_dwordx4 v[44:47], v0, s[8:11], s64 offen offset:1024 sc1
    s_waitcnt lgkmcnt(2)
    v_mfma_f32_32x32x16_bf16 v[96:111], v[112:115], v[12:15], v[96:111]
    ds_read_b128 v[128:131], v4 offset:57344
    buffer_load_dwordx4 v[8:11], v0, s[8:11], s64 offen offset:2048 sc1
    ds_write_b128 v5, v[248:251] offset:12288
    v_mfma_f32_32x32x16_bf16 v[96:111], v[116:119], v[132:135], v[96:111]
    ds_read_b128 v[112:115], v4 offset:58368
    buffer_load_dwordx4 v[12:15], v0, s[8:11], s64 offen offset:3072 sc1
    s_waitcnt lgkmcnt(3)
    v_mfma_f32_32x32x16_bf16 v[96:111], v[120:123], v[136:139], v[96:111]
    ds_read_b128 v[116:119], v4 offset:59392
    s_add_u32 s64, s22, 73728
    buffer_load_dwordx4 v[132:135], v0, s[8:11], s64 offen offset:0 sc1
    v_mfma_f32_32x32x16_bf16 v[96:111], v[124:127], v[140:143], v[96:111]
    ds_read_b128 v[120:123], v4 offset:60416
    buffer_load_dwordx4 v[136:139], v0, s[8:11], s64 offen offset:1024 sc1
    s_waitcnt lgkmcnt(2)
    v_mfma_f32_32x32x16_bf16 v[96:111], v[128:131], v[144:147], v[96:111]
    ds_read_b128 v[124:127], v4 offset:0
    buffer_load_dwordx4 v[140:143], v0, s[8:11], s64 offen offset:2048 sc1
    v_mfma_f32_32x32x16_bf16 v[96:111], v[112:115], v[148:151], v[96:111]
    ds_read_b128 v[128:131], v4 offset:1024
    buffer_load_dwordx4 v[144:147], v0, s[8:11], s64 offen offset:3072 sc1
    s_waitcnt lgkmcnt(2)
    v_mfma_f32_32x32x16_bf16 v[96:111], v[116:119], v[152:155], v[96:111]
    ds_read_b128 v[112:115], v4 offset:2048
    s_add_u32 s64, s22, 77824
    buffer_load_dwordx4 v[148:151], v0, s[8:11], s64 offen offset:0 sc1
    s_waitcnt vmcnt(7)
    v_mfma_f32_32x32x16_bf16 v[96:111], v[120:123], v[44:47], v[96:111]
    ds_read_b128 v[116:119], v4 offset:3072
    buffer_load_dwordx4 v[152:155], v0, s[8:11], s64 offen offset:1024 sc1
    s_waitcnt vmcnt(7) lgkmcnt(2)
    v_mfma_f32_32x32x16_bf16 v[96:111], v[124:127], v[8:11], v[96:111]
    ds_read_b128 v[120:123], v4 offset:4096
    buffer_load_dwordx4 v[44:47], v0, s[8:11], s64 offen offset:2048 sc1
    s_waitcnt vmcnt(7)
    v_mfma_f32_32x32x16_bf16 v[96:111], v[128:131], v[12:15], v[96:111]
    ds_read_b128 v[124:127], v4 offset:5120
    buffer_load_dwordx4 v[8:11], v0, s[8:11], s64 offen offset:3072 sc1
    s_waitcnt vmcnt(7) lgkmcnt(2)
    v_mfma_f32_32x32x16_bf16 v[96:111], v[112:115], v[132:135], v[96:111]
    ds_read_b128 v[128:131], v4 offset:6144
    s_add_u32 s62, s28, 8
    v_cmp_gt_u32 vcc, s62, v6
    s_cbranch_vccnz ob228
or229:
    s_add_u32 s64, s22, 81920
    buffer_load_dwordx4 v[12:15], v0, s[8:11], s64 offen offset:0 sc1
    s_lshl_b32 s47, s17, 11
    s_add_u32 s47, s47, s20
    buffer_load_dwordx4 v[48:51], v0, s[8:11], s47 offen sc1
    buffer_load_dwordx4 v[52:55], v0, s[8:11], s47 offen offset:1024 sc1
    s_waitcnt vmcnt(9)
    v_mfma_f32_32x32x16_bf16 v[96:111], v[116:119], v[136:139], v[96:111]
    ds_read_b128 v[112:115], v4 offset:7168
    buffer_load_dwordx4 v[132:135], v0, s[8:11], s64 offen offset:1024 sc1
    s_waitcnt vmcnt(9) lgkmcnt(2)
    v_mfma_f32_32x32x16_bf16 v[96:111], v[120:123], v[140:143], v[96:111]
    ds_read_b128 v[116:119], v4 offset:8192
    buffer_load_dwordx4 v[136:139], v0, s[8:11], s64 offen offset:2048 sc1
    s_waitcnt vmcnt(9)
    v_mfma_f32_32x32x16_bf16 v[96:111], v[124:127], v[144:147], v[96:111]
    ds_read_b128 v[120:123], v4 offset:9216
    buffer_load_dwordx4 v[140:143], v0, s[8:11], s64 offen offset:3072 sc1
    s_waitcnt vmcnt(9) lgkmcnt(2)
    v_mfma_f32_32x32x16_bf16 v[96:111], v[128:131], v[148:151], v[96:111]
    ds_read_b128 v[124:127], v4 offset:10240
    s_add_u32 s64, s22, 86016
    buffer_load_dwordx4 v[144:147], v0, s[8:11], s64 offen offset:0 sc1
    s_waitcnt vmcnt(9)
    v_mfma_f32_32x32x16_bf16 v[96:111], v[112:115], v[152:155], v[96:111]
    ds_read_b128 v[128:131], v4 offset:11264
    buffer_load_dwordx4 v[148:151], v0, s[8:11], s64 offen offset:1024 sc1
    s_barrier
    s_waitcnt vmcnt(9) lgkmcnt(2)
    v_mfma_f32_32x32x16_bf16 v[96:111], v[116:119], v[44:47], v[96:111]
    ds_read_b128 v[112:115], v4 offset:12288
    s_waitcnt vmcnt(8)
    v_mfma_f32_32x32x16_bf16 v[96:111], v[120:123], v[8:11], v[96:111]
    ds_read_b128 v[116:119], v4 offset:13312
    s_waitcnt vmcnt(7) lgkmcnt(2)
    v_mfma_f32_32x32x16_bf16 v[96:111], v[124:127], v[12:15], v[96:111]
    ds_read_b128 v[120:123], v4 offset:14336
    s_waitcnt vmcnt(4)
    v_mfma_f32_32x32x16_bf16 v[96:111], v[128:131], v[132:135], v[96:111]
    ds_read_b128 v[124:127], v4 offset:15360
    s_waitcnt vmcnt(3) lgkmcnt(2)
    v_mfma_f32_32x32x16_bf16 v[96:111], v[112:115], v[136:139], v[96:111]
    s_waitcnt vmcnt(2)
    v_mfma_f32_32x32x16_bf16 v[96:111], v[116:119], v[140:143], v[96:111]
    s_waitcnt vmcnt(1) lgkmcnt(0)
    v_mfma_f32_32x32x16_bf16 v[96:111], v[120:123], v[144:147], v[96:111]
    s_waitcnt vmcnt(0)
    v_mfma_f32_32x32x16_bf16 v[96:111], v[124:127], v[148:151], v[96:111]
    s_barrier
    v_lshlrev_b32 v64, 16, v48
    v_and_b32 v65, 0xffff0000, v48
    v_lshlrev_b32 v66, 16, v49
    v_and_b32 v67, 0xffff0000, v49
    v_lshlrev_b32 v68, 16, v50
    v_and_b32 v69, 0xffff0000, v50
    v_lshlrev_b32 v70, 16, v51
    v_and_b32 v71, 0xffff0000, v51
    v_lshlrev_b32 v72, 16, v52
    v_and_b32 v73, 0xffff0000, v52
    v_lshlrev_b32 v74, 16, v53
    v_and_b32 v75, 0xffff0000, v53
    v_lshlrev_b32 v76, 16, v54
    v_and_b32 v77, 0xffff0000, v54
    v_lshlrev_b32 v78, 16, v55
    v_and_b32 v79, 0xffff0000, v55
    v_add_f32 v96, v96, v64
    v_add_f32 v97, v97, v65
    v_add_f32 v98, v98, v66
    v_add_f32 v99, v99, v67
    v_add_f32 v100, v100, v68
    v_add_f32 v101, v101, v69
    v_add_f32 v102, v102, v70
    v_add_f32 v103, v103, v71
    v_add_f32 v104, v104, v72
    v_add_f32 v105, v105, v73
    v_add_f32 v106, v106, v74
    v_add_f32 v107, v107, v75
    v_add_f32 v108, v108, v76
    v_add_f32 v109, v109, v77
    v_add_f32 v110, v110, v78
    v_add_f32 v111, v111, v79
    v_cvt_pk_bf16_f32 v8, v96, v97
    v_cvt_pk_bf16_f32 v9, v98, v99
    v_cvt_pk_bf16_f32 v10, v100, v101
    v_cvt_pk_bf16_f32 v11, v102, v103
    v_cvt_pk_bf16_f32 v12, v104, v105
    v_cvt_pk_bf16_f32 v13, v106, v107
    v_cvt_pk_bf16_f32 v14, v108, v109
    v_cvt_pk_bf16_f32 v15, v110, v111
    s_cmp_eq_u32 s27, 1
    s_cbranch_scc1 main_fin_fast
    s_lshl_b32 s40, s17, 11
    s_add_u32 s40, s40, s20
    buffer_store_dwordx4 v[8:11], v0, s[8:11], s40 offen
    buffer_store_dwordx4 v[12:15], v0, s[8:11], s40 offen offset:1024
    v_mov_b32 v30, 0
    v_mov_b32 v31, 0
    v_mov_b32 v34, 0x3f803f80
    v_dot2_f32_bf16 v30, v8, v34, v30
    v_dot2_f32_bf16 v31, v8, v8, v31
    v_dot2_f32_bf16 v30, v9, v34, v30
    v_dot2_f32_bf16 v31, v9, v9, v31
    v_dot2_f32_bf16 v30, v10, v34, v30
    v_dot2_f32_bf16 v31, v10, v10, v31
    v_dot2_f32_bf16 v30, v11, v34, v30
    v_dot2_f32_bf16 v31, v11, v11, v31
    v_dot2_f32_bf16 v30, v12, v34, v30
    v_dot2_f32_bf16 v31, v12, v12, v31
    v_dot2_f32_bf16 v30, v13, v34, v30
    v_dot2_f32_bf16 v31, v13, v13, v31
    v_dot2_f32_bf16 v30, v14, v34, v30
    v_dot2_f32_bf16 v31, v14, v14, v31
    v_dot2_f32_bf16 v30, v15, v34, v30
    v_dot2_f32_bf16 v31, v15, v15, v31
    v_and_b32 v6, 0x1ff, v0
    s_nop 0
    v_mov_b32 v32, v30
    v_mov_b32 v33, v31
    s_nop 0
    v_permlane32_swap_b32 v30, v32
    v_permlane32_swap_b32 v31, v33
    s_nop 0
    v_add_f32 v30, v30, v32
    v_add_f32 v31, v31, v33
    buffer_store_dwordx2 v[30:31], v6, s[8:11], s73 offen
    s_add_u32 s58, s28, 9
    v_mov_b32 v7, s58
    s_waitcnt vmcnt(0)
    buffer_store_dword v7, off, s[8:11], s25
    buffer_load_dword v6, v2, s[8:11], s24 offen sc1
    s_add_u32 s62, s28, 9
    s_waitcnt vmcnt(0)
    v_cmp_gt_u32 vcc, s62, v6
    s_cbranch_vccnz ob230
or231:
    s_add_u32 s27, s27, 1
    s_add_u32 s28, s28, 9
    s_add_u32 s35, s35, 1048576
    s_add_u32 s36, s36, 1048576
    s_add_u32 s68, s20, s96
    buffer_load_dwordx4 a[0:3], v0, s[8:11], s68 offen offset:0 sc1
    buffer_load_dwordx4 a[4:7], v0, s[8:11], s68 offen offset:1024 sc1
    buffer_load_dwordx4 a[8:11], v0, s[8:11], s68 offen offset:2048 sc1
    buffer_load_dwordx4 a[12:15], v0, s[8:11], s68 offen offset:3072 sc1
    s_add_u32 s68, s20, s97
    buffer_load_dwordx4 a[16:19], v0, s[8:11], s68 offen offset:0 sc1
    s_branch main_loop_fast
main_fin_fast:
    v_permlane32_swap_b32 v8, v10
    v_permlane32_swap_b32 v9, v11
    v_permlane32_swap_b32 v12, v14
    v_permlane32_swap_b32 v13, v15
    s_nop 1
    buffer_store_dwordx4 v[8:11], v22, s[12:15], s70 offen offset:0
    buffer_store_dwordx4 v[12:15], v22, s[12:15], s70 offen offset:32
    s_waitcnt vmcnt(0)
    s_endpgm
ob209:
psp232:
    buffer_load_dword v6, v2, s[8:11], s24 offen sc1
    s_cmp_eq_u32 s34, 0
    s_cbranch_scc1 pex233
    s_sub_u32 s34, s34, 1
    s_waitcnt vmcnt(0)
    v_cmp_gt_u32 vcc, s62, v6
    s_cbranch_vccnz psp232
pex233:
    s_waitcnt vmcnt(0)
    s_branch or210
ob212:
psp234:
    buffer_load_dword v6, v2, s[8:11], s24 offen sc1
    s_cmp_eq_u32 s34, 0
    s_cbranch_scc1 pex235
    s_sub_u32 s34, s34, 1
    s_waitcnt vmcnt(0)
    v_cmp_gt_u32 vcc, s62, v6
    s_cbranch_vccnz psp234
pex235:
    s_waitcnt vmcnt(0)
    s_branch or213
ob214:
    s_bitcmp1_b32 s16, 0
    s_cbranch_scc1 po236
    s_add_u32 s49, s65, 167936
    buffer_load_dwordx4 v[192:195], v0, s[8:11], s49 offen
    s_add_u32 s49, s65, 172032
    buffer_load_dwordx4 v[196:199], v0, s[8:11], s49 offen
    s_add_u32 s49, s65, 176128
    buffer_load_dwordx4 v[200:203], v0, s[8:11], s49 offen
    s_cmp_eq_u32 s18, 1
    s_cbranch_scc1 bo238
    s_add_u32 s49, s65, 180224
    buffer_load_dwordx4 v[204:207], v0, s[8:11], s49 offen
bo238:
    s_add_u32 s49, s65, 184320
    buffer_load_dwordx4 v[208:211], v0, s[8:11], s49 offen
    s_add_u32 s49, s65, 188416
    buffer_load_dwordx4 v[212:215], v0, s[8:11], s49 offen
    s_add_u32 s49, s65, 192512
    buffer_load_dwordx4 v[216:219], v0, s[8:11], s49 offen
    v_lshrrev_b32 v244, 7, v0
    v_lshlrev_b32 v244, 14, v244
    v_and_b32 v245, 0x70, v0
    v_lshlrev_b32 v245, 3, v245
    v_add_u32 v244, v244, v245
    s_lshl_b32 s49, s17, 10
    s_add_u32 s49, s49, s22
    s_mov_b32 exec_hi, 0xffff
    buffer_load_dword v246, v244, s[8:11], s49 offen
    s_mov_b64 exec, -1
    s_branch pd237
po236:
    s_add_u32 s49, s65, 184320
    buffer_load_dwordx4 v[208:211], v0, s[8:11], s49 offen
    s_add_u32 s49, s65, 188416
    buffer_load_dwordx4 v[212:215], v0, s[8:11], s49 offen
    s_add_u32 s49, s65, 192512
    buffer_load_dwordx4 v[216:219], v0, s[8:11], s49 offen
    s_add_u32 s49, s65, 163840
    buffer_load_dwordx4 v[188:191], v0, s[8:11], s49 offen
    s_add_u32 s49, s65, 167936
    buffer_load_dwordx4 v[192:195], v0, s[8:11], s49 offen
    s_add_u32 s49, s65, 172032
    buffer_load_dwordx4 v[196:199], v0, s[8:11], s49 offen
    s_add_u32 s49, s65, 176128
    buffer_load_dwordx4 v[200:203], v0, s[8:11], s49 offen
    v_lshrrev_b32 v244, 7, v0
    v_lshlrev_b32 v244, 14, v244
    v_and_b32 v245, 0x70, v0
    v_lshlrev_b32 v245, 3, v245
    v_add_u32 v244, v244, v245
    s_lshl_b32 s49, s17, 10
    s_add_u32 s49, s49, s22
    s_mov_b32 exec_hi, 0xffff
    buffer_load_dword v246, v244, s[8:11], s49 offen
    s_mov_b64 exec, -1
pd237:
    s_branch or215
ob216:
    s_bitcmp1_b32 s16, 0
    s_cbranch_scc1 po239
    s_add_u32 s49, s65, 196608
    buffer_load_dwordx4 v[220:223], v0, s[8:11], s49 offen
    s_add_u32 s49, s65, 200704
    buffer_load_dwordx4 v[224:227], v0, s[8:11], s49 offen
    s_add_u32 s49, s65, 204800
    buffer_load_dwordx4 v[228:231], v0, s[8:11], s49 offen
    s_add_u32 s49, s65, 208896
    buffer_load_dwordx4 v[232:235], v0, s[8:11], s49 offen
    s_add_u32 s49, s65, 212992
    buffer_load_dwordx4 v[236:239], v0, s[8:11], s49 offen
    s_add_u32 s49, s65, 217088
    buffer_load_dwordx4 v[240:243], v0, s[8:11], s49 offen
    s_add_u32 s49, s65, 221184
    buffer_load_dwordx4 v[244:247], v0, s[8:11], s49 offen
    s_add_u32 s49, s65, 225280
    buffer_load_dwordx4 v[248:251], v0, s[8:11], s49 offen
    s_branch pd240
po239:
    s_add_u32 s49, s65, 212992
    buffer_load_dwordx4 v[236:239], v0, s[8:11], s49 offen
    s_add_u32 s49, s65, 217088
    buffer_load_dwordx4 v[240:243], v0, s[8:11], s49 offen
    s_add_u32 s49, s65, 221184
    buffer_load_dwordx4 v[244:247], v0, s[8:11], s49 offen
    s_add_u32 s49, s65, 225280
    buffer_load_dwordx4 v[248:251], v0, s[8:11], s49 offen
    s_add_u32 s49, s65, 196608
    buffer_load_dwordx4 v[220:223], v0, s[8:11], s49 offen
    s_add_u32 s49, s65, 200704
    buffer_load_dwordx4 v[224:227], v0, s[8:11], s49 offen
    s_add_u32 s49, s65, 204800
    buffer_load_dwordx4 v[228:231], v0, s[8:11], s49 offen
    s_add_u32 s49, s65, 208896
    buffer_load_dwordx4 v[232:235], v0, s[8:11], s49 offen
pd240:
    s_branch or217
ob218:
psp241:
    buffer_load_dword v6, v2, s[8:11], s24 offen sc1
    s_cmp_eq_u32 s34, 0
    s_cbranch_scc1 pex242
    s_sub_u32 s34, s34, 1
    s_waitcnt vmcnt(0)
    v_cmp_gt_u32 vcc, s62, v6
    s_cbranch_vccnz psp241
pex242:
    s_waitcnt vmcnt(0)
    s_branch or219
ob220:
psp243:
    buffer_load_dword v6, v2, s[8:11], s24 offen sc1
    s_cmp_eq_u32 s34, 0
    s_cbranch_scc1 pex244
    s_sub_u32 s34, s34, 1
    s_waitcnt vmcnt(0)
    v_cmp_gt_u32 vcc, s62, v6
    s_cbranch_vccnz psp243
pex244:
    s_waitcnt vmcnt(0)
    s_branch or221
ob222:
psp245:
    buffer_load_dword v6, v2, s[8:11], s24 offen sc1
    s_cmp_eq_u32 s34, 0
    s_cbranch_scc1 pex246
    s_sub_u32 s34, s34, 1
    s_waitcnt vmcnt(0)
    v_cmp_gt_u32 vcc, s62, v6
    s_cbranch_vccnz psp245
pex246:
    s_waitcnt vmcnt(0)
    s_branch or223
ob224:
psp247:
    buffer_load_dword v6, v2, s[8:11], s24 offen sc1
    s_cmp_eq_u32 s34, 0
    s_cbranch_scc1 pex248
    s_sub_u32 s34, s34, 1
    s_waitcnt vmcnt(0)
    v_cmp_gt_u32 vcc, s62, v6
    s_cbranch_vccnz psp247
pex248:
    s_waitcnt vmcnt(0)
    s_branch or225
ob226:
psp249:
    buffer_load_dword v6, v2, s[8:11], s24 offen sc1
    s_cmp_eq_u32 s34, 0
    s_cbranch_scc1 pex250
    s_sub_u32 s34, s34, 1
    s_waitcnt vmcnt(0)
    v_cmp_gt_u32 vcc, s62, v6
    s_cbranch_vccnz psp249
pex250:
    s_waitcnt vmcnt(0)
    s_branch or227
ob228:
psp251:
    buffer_load_dword v6, v2, s[8:11], s24 offen sc1
    s_cmp_eq_u32 s34, 0
    s_cbranch_scc1 pex252
    s_sub_u32 s34, s34, 1
    s_waitcnt vmcnt(0)
    v_cmp_gt_u32 vcc, s62, v6
    s_cbranch_vccnz psp251
pex252:
    s_waitcnt vmcnt(0)
    s_branch or229
ob230:
psp253:
    buffer_load_dword v6, v2, s[8:11], s24 offen sc1
    s_cmp_eq_u32 s34, 0
    s_cbranch_scc1 pex254
    s_sub_u32 s34, s34, 1
    s_waitcnt vmcnt(0)
    v_cmp_gt_u32 vcc, s62, v6
    s_cbranch_vccnz psp253
pex254:
    s_waitcnt vmcnt(0)
    s_branch or231
main_loop_slow:
    ds_read_b64_tr_b16 v[112:113], v3 offset:0
    ds_read_b64_tr_b16 v[114:115], v3 offset:512
    ds_read_b64_tr_b16 v[116:117], v3 offset:32768
    ds_read_b64_tr_b16 v[118:119], v3 offset:33280
    ds_read_b64_tr_b16 v[120:121], v3 offset:1024
    ds_read_b64_tr_b16 v[122:123], v3 offset:1536
    ds_read_b64_tr_b16 v[124:125], v3 offset:33792
    ds_read_b64_tr_b16 v[126:127], v3 offset:34304
    s_waitcnt vmcnt(4) lgkmcnt(4)
    v_mfma_f32_32x32x16_bf16 v[48:63], a[0:3], v[112:115], 0
    ds_read_b64_tr_b16 v[128:129], v3 offset:2048
    ds_read_b64_tr_b16 v[130:131], v3 offset:2560
    buffer_load_dwordx4 a[20:23], v0, s[8:11], s68 offen offset:1024 sc1
    buffer_load_dwordx4 a[24:27], v0, s[8:11], s68 offen offset:2048 sc1
    v_mfma_f32_32x32x16_bf16 v[64:79], a[0:3], v[116:119], 0
    ds_read_b64_tr_b16 v[112:113], v3 offset:34816
    ds_read_b64_tr_b16 v[114:115], v3 offset:35328
    s_waitcnt vmcnt(5) lgkmcnt(4)
    v_mfma_f32_32x32x16_bf16 v[48:63], a[4:7], v[120:123], v[48:63]
    ds_read_b64_tr_b16 v[116:117], v3 offset:3072
    ds_read_b64_tr_b16 v[118:119], v3 offset:3584
    buffer_load_dwordx4 a[28:31], v0, s[8:11], s68 offen offset:3072 sc1
    s_add_u32 s68, s20, s98
    buffer_load_dwordx4 a[32:35], v0, s[8:11], s68 offen offset:0 sc1
    v_mfma_f32_32x32x16_bf16 v[64:79], a[4:7], v[124:127], v[64:79]
    ds_read_b64_tr_b16 v[120:121], v3 offset:35840
    ds_read_b64_tr_b16 v[122:123], v3 offset:36352
    s_waitcnt vmcnt(6) lgkmcnt(4)
    v_mfma_f32_32x32x16_bf16 v[48:63], a[8:11], v[128:131], v[48:63]
    ds_read_b64_tr_b16 v[124:125], v3 offset:4096
    ds_read_b64_tr_b16 v[126:127], v3 offset:4608
    buffer_load_dwordx4 a[36:39], v0, s[8:11], s68 offen offset:1024 sc1
    buffer_load_dwordx4 a[40:43], v0, s[8:11], s68 offen offset:2048 sc1
    v_mfma_f32_32x32x16_bf16 v[64:79], a[8:11], v[112:115], v[64:79]
    ds_read_b64_tr_b16 v[128:129], v3 offset:36864
    ds_read_b64_tr_b16 v[130:131], v3 offset:37376
    s_waitcnt vmcnt(7) lgkmcnt(4)
    v_mfma_f32_32x32x16_bf16 v[48:63], a[12:15], v[116:119], v[48:63]
    ds_read_b64_tr_b16 v[112:113], v3 offset:5120
    ds_read_b64_tr_b16 v[114:115], v3 offset:5632
    buffer_load_dwordx4 a[44:47], v0, s[8:11], s68 offen offset:3072 sc1
    s_add_u32 s68, s20, s99
    buffer_load_dwordx4 a[48:51], v0, s[8:11], s68 offen offset:0 sc1
    v_mfma_f32_32x32x16_bf16 v[64:79], a[12:15], v[120:123], v[64:79]
    ds_read_b64_tr_b16 v[116:117], v3 offset:37888
    ds_read_b64_tr_b16 v[118:119], v3 offset:38400
    s_waitcnt vmcnt(8) lgkmcnt(4)
    v_mfma_f32_32x32x16_bf16 v[48:63], a[16:19], v[124:127], v[48:63]
    ds_read_b64_tr_b16 v[120:121], v3 offset:6144
    ds_read_b64_tr_b16 v[122:123], v3 offset:6656
    buffer_load_dwordx4 a[52:55], v0, s[8:11], s68 offen offset:1024 sc1
    v_mfma_f32_32x32x16_bf16 v[64:79], a[16:19], v[128:131], v[64:79]
    ds_read_b64_tr_b16 v[124:125], v3 offset:38912
    ds_read_b64_tr_b16 v[126:127], v3 offset:39424
    s_waitcnt vmcnt(8) lgkmcnt(4)
    v_mfma_f32_32x32x16_bf16 v[48:63], a[20:23], v[112:115], v[48:63]
    ds_read_b64_tr_b16 v[128:129], v3 offset:7168
    ds_read_b64_tr_b16 v[130:131], v3 offset:7680
    buffer_load_dwordx4 a[56:59], v0, s[8:11], s68 offen offset:2048 sc1
    v_mfma_f32_32x32x16_bf16 v[64:79], a[20:23], v[116:119], v[64:79]
    ds_read_b64_tr_b16 v[112:113], v3 offset:39936
    ds_read_b64_tr_b16 v[114:115], v3 offset:40448
    s_waitcnt vmcnt(8) lgkmcnt(4)
    v_mfma_f32_32x32x16_bf16 v[48:63], a[24:27], v[120:123], v[48:63]
    ds_read_b64_tr_b16 v[116:117], v3 offset:8192
    ds_read_b64_tr_b16 v[118:119], v3 offset:8704
    buffer_load_dwordx4 a[60:63], v0, s[8:11], s68 offen offset:3072 sc1
    v_mfma_f32_32x32x16_bf16 v[64:79], a[24:27], v[124:127], v[64:79]
    ds_read_b64_tr_b16 v[120:121], v3 offset:40960
    ds_read_b64_tr_b16 v[122:123], v3 offset:41472
    s_waitcnt vmcnt(8) lgkmcnt(4)
    v_mfma_f32_32x32x16_bf16 v[48:63], a[28:31], v[128:131], v[48:63]
    ds_read_b64_tr_b16 v[124:125], v3 offset:9216
    ds_read_b64_tr_b16 v[126:127], v3 offset:9728
    s_add_u32 s68, s20, s100
    buffer_load_dwordx4 a[64:67], v0, s[8:11], s68 offen offset:0 sc1
    v_mfma_f32_32x32x16_bf16 v[64:79], a[28:31], v[112:115], v[64:79]
    ds_read_b64_tr_b16 v[128:129], v3 offset:41984
    ds_read_b64_tr_b16 v[130:131], v3 offset:42496
    s_waitcnt vmcnt(8) lgkmcnt(4)
    v_mfma_f32_32x32x16_bf16 v[48:63], a[32:35], v[116:119], v[48:63]
    ds_read_b64_tr_b16 v[112:113], v3 offset:10240
    ds_read_b64_tr_b16 v[114:115], v3 offset:10752
    buffer_load_dwordx4 a[68:71], v0, s[8:11], s68 offen offset:1024 sc1
    buffer_load_dwordx4 v[28:31], v0, s[8:11], s23 offen offset:0 sc1
    buffer_load_dwordx4 v[32:35], v0, s[8:11], s23 offen offset:1024 sc1
    buffer_load_dwordx4 v[36:39], v0, s[8:11], s23 offen offset:2048 sc1
    buffer_load_dwordx4 v[40:43], v0, s[8:11], s23 offen offset:3072 sc1
    v_mfma_f32_32x32x16_bf16 v[64:79], a[32:35], v[120:123], v[64:79]
    ds_read_b64_tr_b16 v[116:117], v3 offset:43008
    ds_read_b64_tr_b16 v[118:119], v3 offset:43520
    s_waitcnt vmcnt(12) lgkmcnt(4)
    v_mfma_f32_32x32x16_bf16 v[48:63], a[36:39], v[124:127], v[48:63]
    ds_read_b64_tr_b16 v[120:121], v3 offset:11264
    ds_read_b64_tr_b16 v[122:123], v3 offset:11776
    buffer_load_dwordx4 a[72:75], v0, s[8:11], s68 offen offset:2048 sc1
    v_mfma_f32_32x32x16_bf16 v[64:79], a[36:39], v[128:131], v[64:79]
    ds_read_b64_tr_b16 v[124:125], v3 offset:44032
    ds_read_b64_tr_b16 v[126:127], v3 offset:44544
    s_waitcnt vmcnt(12) lgkmcnt(4)
    v_mfma_f32_32x32x16_bf16 v[48:63], a[40:43], v[112:115], v[48:63]
    ds_read_b64_tr_b16 v[128:129], v3 offset:12288
    ds_read_b64_tr_b16 v[130:131], v3 offset:12800
    buffer_load_dwordx4 a[76:79], v0, s[8:11], s68 offen offset:3072 sc1
    v_mfma_f32_32x32x16_bf16 v[64:79], a[40:43], v[116:119], v[64:79]
    ds_read_b64_tr_b16 v[112:113], v3 offset:45056
    ds_read_b64_tr_b16 v[114:115], v3 offset:45568
    s_waitcnt vmcnt(12) lgkmcnt(4)
    v_mfma_f32_32x32x16_bf16 v[48:63], a[44:47], v[120:123], v[48:63]
    ds_read_b64_tr_b16 v[116:117], v3 offset:13312
    ds_read_b64_tr_b16 v[118:119], v3 offset:13824
    s_add_u32 s68, s20, s101
    buffer_load_dwordx4 a[80:83], v0, s[8:11], s68 offen offset:0 sc1
    v_mfma_f32_32x32x16_bf16 v[64:79], a[44:47], v[124:127], v[64:79]
    ds_read_b64_tr_b16 v[120:121], v3 offset:46080
    ds_read_b64_tr_b16 v[122:123], v3 offset:46592
    s_waitcnt vmcnt(12) lgkmcnt(4)
    v_mfma_f32_32x32x16_bf16 v[48:63], a[48:51], v[128:131], v[48:63]
    ds_read_b64_tr_b16 v[124:125], v3 offset:14336
    ds_read_b64_tr_b16 v[126:127], v3 offset:14848
    buffer_load_dwordx4 a[84:87], v0, s[8:11], s68 offen offset:1024 sc1
    v_mfma_f32_32x32x16_bf16 v[64:79], a[48:51], v[112:115], v[64:79]
    ds_read_b64_tr_b16 v[128:129], v3 offset:47104
    ds_read_b64_tr_b16 v[130:131], v3 offset:47616
    s_waitcnt vmcnt(12) lgkmcnt(4)
    v_mfma_f32_32x32x16_bf16 v[48:63], a[52:55], v[116:119], v[48:63]
    ds_read_b64_tr_b16 v[112:113], v3 offset:15360
    ds_read_b64_tr_b16 v[114:115], v3 offset:15872
    buffer_load_dwordx4 a[88:91], v0, s[8:11], s68 offen offset:2048 sc1
    v_mfma_f32_32x32x16_bf16 v[64:79], a[52:55], v[120:123], v[64:79]
    ds_read_b64_tr_b16 v[116:117], v3 offset:48128
    ds_read_b64_tr_b16 v[118:119], v3 offset:48640
    s_waitcnt vmcnt(12) lgkmcnt(4)
    v_mfma_f32_32x32x16_bf16 v[48:63], a[56:59], v[124:127], v[48:63]
    ds_read_b64_tr_b16 v[120:121], v3 offset:16384
    ds_read_b64_tr_b16 v[122:123], v3 offset:16896
    buffer_load_dwordx4 a[92:95], v0, s[8:11], s68 offen offset:3072 sc1
    v_mfma_f32_32x32x16_bf16 v[64:79], a[56:59], v[128:131], v[64:79]
    ds_read_b64_tr_b16 v[124:125], v3 offset:49152
    ds_read_b64_tr_b16 v[126:127], v3 offset:49664
    s_waitcnt vmcnt(12) lgkmcnt(4)
    v_mfma_f32_32x32x16_bf16 v[48:63], a[60:63], v[112:115], v[48:63]
    ds_read_b64_tr_b16 v[128:129], v3 offset:17408
    ds_read_b64_tr_b16 v[130:131], v3 offset:17920
    s_add_u32 s68, s20, s29
    buffer_load_dwordx4 a[96:99], v0, s[8:11], s68 offen offset:0 sc1
    v_mfma_f32_32x32x16_bf16 v[64:79], a[60:63], v[116:119], v[64:79]
    ds_read_b64_tr_b16 v[112:113], v3 offset:50176
    ds_read_b64_tr_b16 v[114:115], v3 offset:50688
    s_waitcnt vmcnt(12) lgkmcnt(4)
    v_mfma_f32_32x32x16_bf16 v[48:63], a[64:67], v[120:123], v[48:63]
    ds_read_b64_tr_b16 v[116:117], v3 offset:18432
    ds_read_b64_tr_b16 v[118:119], v3 offset:18944
    buffer_load_dwordx4 a[100:103], v0, s[8:11], s68 offen offset:1024 sc1
    v_mfma_f32_32x32x16_bf16 v[64:79], a[64:67], v[124:127], v[64:79]
    ds_read_b64_tr_b16 v[120:121], v3 offset:51200
    ds_read_b64_tr_b16 v[122:123], v3 offset:51712
    s_waitcnt vmcnt(12) lgkmcnt(4)
    v_mfma_f32_32x32x16_bf16 v[48:63], a[68:71], v[128:131], v[48:63]
    ds_read_b64_tr_b16 v[124:125], v3 offset:19456
    ds_read_b64_tr_b16 v[126:127], v3 offset:19968
    buffer_load_dwordx4 a[104:107], v0, s[8:11], s68 offen offset:2048 sc1
    v_mfma_f32_32x32x16_bf16 v[64:79], a[68:71], v[112:115], v[64:79]
    ds_read_b64_tr_b16 v[128:129], v3 offset:52224
    ds_read_b64_tr_b16 v[130:131], v3 offset:52736
    s_waitcnt vmcnt(9)
    v_add_f32 v28, v28, v30
    v_add_f32 v29, v29, v31
    s_waitcnt vmcnt(8) lgkmcnt(4)
    v_mfma_f32_32x32x16_bf16 v[48:63], a[72:75], v[116:119], v[48:63]
    ds_read_b64_tr_b16 v[112:113], v3 offset:20480
    ds_read_b64_tr_b16 v[114:115], v3 offset:20992
    buffer_load_dwordx4 a[108:111], v0, s[8:11], s68 offen offset:3072 sc1
    v_mfma_f32_32x32x16_bf16 v[64:79], a[72:75], v[120:123], v[64:79]
    ds_read_b64_tr_b16 v[116:117], v3 offset:53248
    ds_read_b64_tr_b16 v[118:119], v3 offset:53760
    v_add_f32 v28, v28, v32
    v_add_f32 v29, v29, v33
    v_add_f32 v28, v28, v34
    s_waitcnt vmcnt(8) lgkmcnt(4)
    v_mfma_f32_32x32x16_bf16 v[48:63], a[76:79], v[124:127], v[48:63]
    ds_read_b64_tr_b16 v[120:121], v3 offset:21504
    ds_read_b64_tr_b16 v[122:123], v3 offset:22016
    s_add_u32 s68, s20, s39
    buffer_load_dwordx4 a[112:115], v0, s[8:11], s68 offen offset:0 sc1
    v_mfma_f32_32x32x16_bf16 v[64:79], a[76:79], v[128:131], v[64:79]
    ds_read_b64_tr_b16 v[124:125], v3 offset:54272
    ds_read_b64_tr_b16 v[126:127], v3 offset:54784
    v_add_f32 v29, v29, v35
    v_add_f32 v28, v28, v36
    v_add_f32 v29, v29, v37
    s_waitcnt vmcnt(8) lgkmcnt(4)
    v_mfma_f32_32x32x16_bf16 v[48:63], a[80:83], v[112:115], v[48:63]
    ds_read_b64_tr_b16 v[128:129], v3 offset:22528
    ds_read_b64_tr_b16 v[130:131], v3 offset:23040
    buffer_load_dwordx4 a[116:119], v0, s[8:11], s68 offen offset:1024 sc1
    v_mfma_f32_32x32x16_bf16 v[64:79], a[80:83], v[116:119], v[64:79]
    ds_read_b64_tr_b16 v[112:113], v3 offset:55296
    ds_read_b64_tr_b16 v[114:115], v3 offset:55808
    v_add_f32 v28, v28, v38
    v_add_f32 v29, v29, v39
    v_add_f32 v28, v28, v40
    s_waitcnt vmcnt(8) lgkmcnt(4)
    v_mfma_f32_32x32x16_bf16 v[48:63], a[84:87], v[120:123], v[48:63]
    ds_read_b64_tr_b16 v[116:117], v3 offset:23552
    ds_read_b64_tr_b16 v[118:119], v3 offset:24064
    buffer_load_dwordx4 a[120:123], v0, s[8:11], s68 offen offset:2048 sc1
    v_mfma_f32_32x32x16_bf16 v[64:79], a[84:87], v[124:127], v[64:79]
    ds_read_b64_tr_b16 v[120:121], v3 offset:56320
    ds_read_b64_tr_b16 v[122:123], v3 offset:56832
    v_add_f32 v29, v29, v41
    v_add_f32 v28, v28, v42
    v_add_f32 v29, v29, v43
    s_waitcnt vmcnt(8) lgkmcnt(4)
    v_mfma_f32_32x32x16_bf16 v[48:63], a[88:91], v[128:131], v[48:63]
    ds_read_b64_tr_b16 v[124:125], v3 offset:24576
    ds_read_b64_tr_b16 v[126:127], v3 offset:25088
    buffer_load_dwordx4 a[124:127], v0, s[8:11], s68 offen offset:3072 sc1
    v_mfma_f32_32x32x16_bf16 v[64:79], a[88:91], v[112:115], v[64:79]
    ds_read_b64_tr_b16 v[128:129], v3 offset:57344
    ds_read_b64_tr_b16 v[130:131], v3 offset:57856
    v_mov_b32 v30, v28
    v_mov_b32 v31, v29
    v_mov_b32 v18, 0
    s_waitcnt vmcnt(8) lgkmcnt(4)
    v_mfma_f32_32x32x16_bf16 v[48:63], a[92:95], v[116:119], v[48:63]
    ds_read_b64_tr_b16 v[112:113], v3 offset:25600
    ds_read_b64_tr_b16 v[114:115], v3 offset:26112
    v_mov_b32 v19, 0
    v_permlane32_swap_b32 v28, v30
    v_permlane32_swap_b32 v29, v31
    v_mfma_f32_32x32x16_bf16 v[64:79], a[92:95], v[120:123], v[64:79]
    ds_read_b64_tr_b16 v[116:117], v3 offset:58368
    ds_read_b64_tr_b16 v[118:119], v3 offset:58880
    v_mov_b32 v32, 0
    v_add_f32 v28, v28, v30
    v_add_f32 v29, v29, v31
    s_waitcnt vmcnt(7) lgkmcnt(4)
    v_mfma_f32_32x32x16_bf16 v[48:63], a[96:99], v[124:127], v[48:63]
    ds_read_b64_tr_b16 v[120:121], v3 offset:26624
    ds_read_b64_tr_b16 v[122:123], v3 offset:27136
    v_mul_f32 v28, 0x3b000000, v28
    v_mul_f32 v29, 0x3b000000, v29
    v_fma_f32 v29, -v28, v28, v29
    v_mfma_f32_32x32x16_bf16 v[64:79], a[96:99], v[128:131], v[64:79]
    ds_read_b64_tr_b16 v[124:125], v3 offset:59392
    ds_read_b64_tr_b16 v[126:127], v3 offset:59904
    v_cvt_pk_bf16_f32 v16, v28, v28
    v_max_f32 v29, 0, v29
    v_and_b32 v30, 0xffff0000, v16
    s_waitcnt vmcnt(6) lgkmcnt(4)
    v_mfma_f32_32x32x16_bf16 v[48:63], a[100:103], v[112:115], v[48:63]
    ds_read_b64_tr_b16 v[128:129], v3 offset:27648
    ds_read_b64_tr_b16 v[130:131], v3 offset:28160
    v_add_f32 v27, 0x3727c5ac, v29
    v_sub_f32 v30, v28, v30
    v_rsq_f32 v24, v27
    v_mfma_f32_32x32x16_bf16 v[64:79], a[100:103], v[116:119], v[64:79]
    ds_read_b64_tr_b16 v[112:113], v3 offset:60416
    ds_read_b64_tr_b16 v[114:115], v3 offset:60928
    v_cvt_pk_bf16_f32 v17, v30, v32
    v_cndmask_b32_e64 v16, v16, 0, s[32:33]
    v_cndmask_b32_e64 v17, v17, 0, s[32:33]
    s_waitcnt vmcnt(5) lgkmcnt(4)
    v_mfma_f32_32x32x16_bf16 v[48:63], a[104:107], v[120:123], v[48:63]
    ds_read_b64_tr_b16 v[116:117], v3 offset:28672
    ds_read_b64_tr_b16 v[118:119], v3 offset:29184
    v_mul_f32 v32, 0x3fb8aa3b, v24
    ds_write_b32 v21, v32
    s_waitcnt lgkmcnt(0)
    v_mfma_f32_32x32x16_bf16 v[64:79], a[104:107], v[124:127], v[64:79]
    ds_read_b64_tr_b16 v[120:121], v3 offset:61440
    ds_read_b64_tr_b16 v[122:123], v3 offset:61952
    ds_read_b128 v[80:83], v20 offset:0
    ds_read_b128 v[84:87], v20 offset:32
    ds_read_b128 v[88:91], v20 offset:64
    s_waitcnt vmcnt(4)
    v_mfma_f32_32x32x16_bf16 v[48:63], a[108:111], v[128:131], v[48:63]
    ds_read_b64_tr_b16 v[124:125], v3 offset:29696
    ds_read_b64_tr_b16 v[126:127], v3 offset:30208
    ds_read_b128 v[92:95], v20 offset:96
    v_mfma_f32_32x32x16_bf16 v[64:79], a[108:111], v[112:115], v[64:79]
    ds_read_b64_tr_b16 v[128:129], v3 offset:62464
    ds_read_b64_tr_b16 v[130:131], v3 offset:62976
    s_waitcnt vmcnt(3)
    v_mfma_f32_32x32x16_bf16 v[48:63], a[112:115], v[116:119], v[48:63]
    ds_read_b64_tr_b16 v[112:113], v3 offset:30720
    ds_read_b64_tr_b16 v[114:115], v3 offset:31232
    s_waitcnt lgkmcnt(5)
    v_mfma_f32_32x32x16_bf16 v[64:79], a[112:115], v[120:123], v[64:79]
    ds_read_b64_tr_b16 v[116:117], v3 offset:63488
    ds_read_b64_tr_b16 v[118:119], v3 offset:64000
    s_waitcnt vmcnt(2)
    v_mfma_f32_32x32x16_bf16 v[48:63], a[116:119], v[124:127], v[48:63]
    ds_read_b64_tr_b16 v[120:121], v3 offset:31744
    ds_read_b64_tr_b16 v[122:123], v3 offset:32256
    s_waitcnt lgkmcnt(4)
    v_mfma_f32_32x32x16_bf16 v[64:79], a[116:119], v[128:131], v[64:79]
    ds_read_b64_tr_b16 v[124:125], v3 offset:64512
    ds_read_b64_tr_b16 v[126:127], v3 offset:65024
    s_waitcnt vmcnt(1)
    v_mfma_f32_32x32x16_bf16 v[48:63], a[120:123], v[112:115], v[48:63]
    ds_read_b128 v[128:131], v1 offset:32768
    s_waitcnt lgkmcnt(3)
    v_mfma_f32_32x32x16_bf16 v[64:79], a[120:123], v[116:119], v[64:79]
    ds_read_b128 v[112:115], v1 offset:33792
    s_waitcnt vmcnt(0)
    v_mfma_f32_32x32x16_bf16 v[48:63], a[124:127], v[120:123], v[48:63]
    s_waitcnt lgkmcnt(1)
    v_mfma_f32_32x32x16_bf16 v[64:79], a[124:127], v[124:127], v[64:79]
    v_mfma_f32_32x32x16_bf16 v[48:63], v[16:19], v[128:131], v[48:63]
    s_waitcnt lgkmcnt(0)
    v_mfma_f32_32x32x16_bf16 v[64:79], v[16:19], v[112:115], v[64:79]
    s_nop 9
    v_mul_f32 v48, v48, v80
    v_mul_f32 v49, v49, v81
    v_mul_f32 v50, v50, v82
    v_mul_f32 v51, v51, v83
    v_mul_f32 v52, v52, v84
    v_mul_f32 v53, v53, v85
    v_mul_f32 v54, v54, v86
    v_mul_f32 v55, v55, v87
    v_mul_f32 v56, v56, v88
    v_mul_f32 v57, v57, v89
    v_mul_f32 v58, v58, v90
    v_mul_f32 v59, v59, v91
    v_mul_f32 v60, v60, v92
    v_mul_f32 v61, v61, v93
    v_mul_f32 v62, v62, v94
    v_mul_f32 v63, v63, v95
    v_mul_f32 v64, v64, v80
    v_mul_f32 v65, v65, v81
    v_mul_f32 v66, v66, v82
    v_mul_f32 v67, v67, v83
    v_mul_f32 v68, v68, v84
    v_mul_f32 v69, v69, v85
    v_mul_f32 v70, v70, v86
    v_mul_f32 v71, v71, v87
    v_mul_f32 v72, v72, v88
    v_mul_f32 v73, v73, v89
    v_mul_f32 v74, v74, v90
    v_mul_f32 v75, v75, v91
    v_mul_f32 v76, v76, v92
    v_mul_f32 v77, v77, v93
    v_mul_f32 v78, v78, v94
    v_mul_f32 v79, v79, v95
    v_exp_f32_e64 v80, v48 clamp
    v_max_f32 v48, 0, v48
    v_exp_f32_e64 v81, v49 clamp
    v_max_f32 v49, 0, v49
    v_exp_f32_e64 v82, v50 clamp
    v_max_f32 v50, 0, v50
    v_exp_f32_e64 v83, v51 clamp
    v_max_f32 v51, 0, v51
    v_exp_f32_e64 v84, v52 clamp
    v_max_f32 v52, 0, v52
    v_exp_f32_e64 v85, v53 clamp
    v_max_f32 v53, 0, v53
    v_exp_f32_e64 v86, v54 clamp
    v_max_f32 v54, 0, v54
    v_exp_f32_e64 v87, v55 clamp
    v_max_f32 v55, 0, v55
    v_exp_f32_e64 v88, v56 clamp
    v_max_f32 v56, 0, v56
    v_exp_f32_e64 v89, v57 clamp
    v_max_f32 v57, 0, v57
    v_exp_f32_e64 v90, v58 clamp
    v_max_f32 v58, 0, v58
    v_exp_f32_e64 v91, v59 clamp
    v_max_f32 v59, 0, v59
    v_exp_f32_e64 v92, v60 clamp
    v_max_f32 v60, 0, v60
    v_exp_f32_e64 v93, v61 clamp
    v_max_f32 v61, 0, v61
    v_exp_f32_e64 v94, v62 clamp
    v_max_f32 v62, 0, v62
    v_exp_f32_e64 v95, v63 clamp
    v_max_f32 v63, 0, v63
    v_cvt_pk_bf16_f32 v36, v64, v65
    v_cvt_pk_bf16_f32 v37, v66, v67
    v_cvt_pk_bf16_f32 v38, v68, v69
    v_cvt_pk_bf16_f32 v39, v70, v71
    v_cvt_pk_bf16_f32 v40, v72, v73
    v_cvt_pk_bf16_f32 v41, v74, v75
    v_cvt_pk_bf16_f32 v42, v76, v77
    v_cvt_pk_bf16_f32 v43, v78, v79
    v_fma_f32 v48, v48, s37, v80
    v_fma_f32 v49, v49, s37, v81
    v_fma_f32 v50, v50, s37, v82
    v_fma_f32 v51, v51, s37, v83
    v_fma_f32 v52, v52, s37, v84
    v_fma_f32 v53, v53, s37, v85
    v_fma_f32 v54, v54, s37, v86
    v_fma_f32 v55, v55, s37, v87
    v_fma_f32 v56, v56, s37, v88
    v_fma_f32 v57, v57, s37, v89
    v_fma_f32 v58, v58, s37, v90
    v_fma_f32 v59, v59, s37, v91
    v_fma_f32 v60, v60, s37, v92
    v_fma_f32 v61, v61, s37, v93
    v_fma_f32 v62, v62, s37, v94
    v_fma_f32 v63, v63, s37, v95
    v_add_f32 v48, s38, v48
    v_add_f32 v49, s38, v49
    v_add_f32 v50, s38, v50
    v_add_f32 v51, s38, v51
    v_add_f32 v52, s38, v52
    v_add_f32 v53, s38, v53
    v_add_f32 v54, s38, v54
    v_add_f32 v55, s38, v55
    v_add_f32 v56, s38, v56
    v_add_f32 v57, s38, v57
    v_add_f32 v58, s38, v58
    v_add_f32 v59, s38, v59
    v_add_f32 v60, s38, v60
    v_add_f32 v61, s38, v61
    v_add_f32 v62, s38, v62
    v_add_f32 v63, s38, v63
    v_mov_b32 v44, 0x3f803f80
    v_mov_b32 v45, 0x3f803f80
    v_mov_b32 v46, 0x3f803f80
    v_mov_b32 v47, 0x3f803f80
    v_cvt_pk_bf16_f32 v28, v48, v49
    v_cvt_pk_bf16_f32 v29, v50, v51
    v_cvt_pk_bf16_f32 v30, v52, v53
    v_cvt_pk_bf16_f32 v31, v54, v55
    v_cvt_pk_bf16_f32 v32, v56, v57
    v_cvt_pk_bf16_f32 v33, v58, v59
    v_cvt_pk_bf16_f32 v34, v60, v61
    v_cvt_pk_bf16_f32 v35, v62, v63
    s_mul_i32 s40, s18, 2304
    v_add_u32 v6, s40, v4
    v_mfma_f32_32x32x16_bf16 v[48:63], v[28:31], v[36:39], 0
    v_mfma_f32_32x32x16_bf16 v[64:79], v[44:47], v[28:31], 0
    v_mfma_f32_32x32x16_bf16 v[48:63], v[32:35], v[40:43], v[48:63]
    v_mfma_f32_32x32x16_bf16 v[64:79], v[44:47], v[32:35], v[64:79]
    v_lshrrev_b32 v7, 2, v0
    s_add_u32 s41, s40, 101376
    v_add_u32 v7, s41, v7
    s_nop 7
    v_cndmask_b32_e64 v80, v48, v56, s[30:31]
    v_cndmask_b32_e64 v81, v49, v57, s[30:31]
    v_cndmask_b32_e64 v82, v50, v58, s[30:31]
    v_cndmask_b32_e64 v83, v51, v59, s[30:31]
    v_cndmask_b32_e64 v84, v52, v60, s[30:31]
    v_cndmask_b32_e64 v85, v53, v61, s[30:31]
    v_cndmask_b32_e64 v86, v54, v62, s[30:31]
    v_cndmask_b32_e64 v87, v55, v63, s[30:31]
    ds_write_b128 v6, v[80:83] offset:49152
    ds_write_b128 v6, v[84:87] offset:50176
    ds_write_b32 v7, v64 offset:51200
    s_waitcnt lgkmcnt(0)
    s_barrier
    s_cmp_ge_u32 s18, 2
    s_cbranch_scc1 kd257
    s_cmp_eq_u32 s18, 1
    s_cbranch_scc1 kz256
    ds_read_b128 v[48:51], v4 offset:49152
    ds_read_b128 v[52:55], v4 offset:50176
    ds_read_b128 v[56:59], v4 offset:51456
    ds_read_b128 v[60:63], v4 offset:52480
    ds_read_b128 v[64:67], v4 offset:53760
    ds_read_b128 v[68:71], v4 offset:54784
    ds_read_b128 v[72:75], v4 offset:56064
    ds_read_b128 v[76:79], v4 offset:57088
    s_waitcnt lgkmcnt(0)
    v_add_f32 v48, v48, v56
    v_add_f32 v64, v64, v72
    v_add_f32 v49, v49, v57
    v_add_f32 v65, v65, v73
    v_add_f32 v50, v50, v58
    v_add_f32 v66, v66, v74
    v_add_f32 v51, v51, v59
    v_add_f32 v67, v67, v75
    v_add_f32 v52, v52, v60
    v_add_f32 v68, v68, v76
    v_add_f32 v53, v53, v61
    v_add_f32 v69, v69, v77
    v_add_f32 v54, v54, v62
    v_add_f32 v70, v70, v78
    v_add_f32 v55, v55, v63
    v_add_f32 v71, v71, v79
    v_add_f32 v48, v48, v64
    v_add_f32 v49, v49, v65
    v_add_f32 v50, v50, v66
    v_add_f32 v51, v51, v67
    v_add_f32 v52, v52, v68
    v_add_f32 v53, v53, v69
    v_add_f32 v54, v54, v70
    v_add_f32 v55, v55, v71
    v_cvt_pk_bf16_f32 v56, v48, v49
    v_cvt_pk_bf16_f32 v57, v50, v51
    v_cvt_pk_bf16_f32 v58, v52, v53
    v_cvt_pk_bf16_f32 v59, v54, v55
    buffer_store_dwordx4 v[56:59], v0, s[8:11], s35 offen sc1
    s_branch kd257
kz256:
    v_lshrrev_b32 v7, 2, v0
    v_add_u32 v6, 101376, v7
    ds_read_b32 v48, v6 offset:51200
    ds_read_b32 v49, v6 offset:53504
    ds_read_b32 v50, v6 offset:55808
    ds_read_b32 v51, v6 offset:58112
    s_waitcnt lgkmcnt(0)
    v_add_f32 v48, v48, v49
    v_add_f32 v50, v50, v51
    v_add_f32 v48, v48, v50
    s_mov_b64 exec, 0xffffffff
    buffer_store_dword v48, v7, s[8:11], s35 offen offset:1024 sc1
    s_mov_b64 exec, -1
kd257:
    s_barrier
    v_add_u32 v153, 0x10000, v3
    ds_read_b64_tr_b16 v[112:113], v153 offset:0
    ds_read_b64_tr_b16 v[114:115], v153 offset:512
    ds_read_b64_tr_b16 v[116:117], v153 offset:1024
    ds_read_b64_tr_b16 v[118:119], v153 offset:1536
    ds_read_b64_tr_b16 v[120:121], v153 offset:2048
    ds_read_b64_tr_b16 v[122:123], v153 offset:2560
    ds_read_b64_tr_b16 v[124:125], v153 offset:3072
    ds_read_b64_tr_b16 v[126:127], v153 offset:3584
    s_waitcnt lgkmcnt(4)
    v_mfma_f32_32x32x16_bf16 v[96:111], v[112:115], a[0:3], 0
    ds_read_b64_tr_b16 v[128:129], v153 offset:4096
    ds_read_b64_tr_b16 v[130:131], v153 offset:4608
    v_mfma_f32_32x32x16_bf16 v[96:111], v[116:119], a[4:7], v[96:111]
    ds_read_b64_tr_b16 v[112:113], v153 offset:5120
    ds_read_b64_tr_b16 v[114:115], v153 offset:5632
    s_bitcmp1_b32 s16, 0
    s_cbranch_scc1 po259
    s_add_u32 m0, s60, 0
    s_add_u32 s42, s61, 101376
    buffer_load_dwordx4 v0, s[8:11], s42 offen offset:0 lds
    buffer_load_dwordx4 v0, s[8:11], s42 offen offset:1024 lds
    buffer_load_dwordx4 v0, s[8:11], s42 offen offset:2048 lds
    buffer_load_dwordx4 v0, s[8:11], s42 offen offset:3072 lds
    s_add_u32 m0, s60, 4096
    s_add_u32 s42, s61, 105472
    buffer_load_dwordx4 v0, s[8:11], s42 offen offset:0 lds
    buffer_load_dwordx4 v0, s[8:11], s42 offen offset:1024 lds
    buffer_load_dwordx4 v0, s[8:11], s42 offen offset:2048 lds
    buffer_load_dwordx4 v0, s[8:11], s42 offen offset:3072 lds
    s_branch pd260
po259:
    s_lshl_b32 s43, s18, 12
    s_add_u32 s43, s43, s26
    s_add_u32 s43, s43, 134144
    v_lshlrev_b32 v154, 3, v0
    s_mov_b64 exec, 0xffffffff
    buffer_load_dword v152, v154, s[8:11], s43 offen
    s_mov_b64 exec, -1
pd260:
    s_waitcnt lgkmcnt(4)
    v_mfma_f32_32x32x16_bf16 v[96:111], v[120:123], a[8:11], v[96:111]
    ds_read_b64_tr_b16 v[116:117], v153 offset:6144
    ds_read_b64_tr_b16 v[118:119], v153 offset:6656
    v_mfma_f32_32x32x16_bf16 v[96:111], v[124:127], a[12:15], v[96:111]
    ds_read_b64_tr_b16 v[120:121], v153 offset:7168
    ds_read_b64_tr_b16 v[122:123], v153 offset:7680
    s_waitcnt lgkmcnt(4)
    v_mfma_f32_32x32x16_bf16 v[96:111], v[128:131], a[16:19], v[96:111]
    ds_read_b64_tr_b16 v[124:125], v153 offset:8192
    ds_read_b64_tr_b16 v[126:127], v153 offset:8704
    v_mfma_f32_32x32x16_bf16 v[96:111], v[112:115], a[20:23], v[96:111]
    ds_read_b64_tr_b16 v[128:129], v153 offset:9216
    ds_read_b64_tr_b16 v[130:131], v153 offset:9728
    s_waitcnt lgkmcnt(4)
    v_mfma_f32_32x32x16_bf16 v[96:111], v[116:119], a[24:27], v[96:111]
    ds_read_b64_tr_b16 v[112:113], v153 offset:10240
    ds_read_b64_tr_b16 v[114:115], v153 offset:10752
    v_mfma_f32_32x32x16_bf16 v[96:111], v[120:123], a[28:31], v[96:111]
    ds_read_b64_tr_b16 v[116:117], v153 offset:11264
    ds_read_b64_tr_b16 v[118:119], v153 offset:11776
    s_waitcnt lgkmcnt(4)
    v_mfma_f32_32x32x16_bf16 v[96:111], v[124:127], a[32:35], v[96:111]
    ds_read_b64_tr_b16 v[120:121], v153 offset:12288
    ds_read_b64_tr_b16 v[122:123], v153 offset:12800
    v_mfma_f32_32x32x16_bf16 v[96:111], v[128:131], a[36:39], v[96:111]
    ds_read_b64_tr_b16 v[124:125], v153 offset:13312
    ds_read_b64_tr_b16 v[126:127], v153 offset:13824
    s_waitcnt lgkmcnt(4)
    v_mfma_f32_32x32x16_bf16 v[96:111], v[112:115], a[40:43], v[96:111]
    ds_read_b64_tr_b16 v[128:129], v153 offset:14336
    ds_read_b64_tr_b16 v[130:131], v153 offset:14848
    v_mfma_f32_32x32x16_bf16 v[96:111], v[116:119], a[44:47], v[96:111]
    ds_read_b64_tr_b16 v[112:113], v153 offset:15360
    ds_read_b64_tr_b16 v[114:115], v153 offset:15872
    s_waitcnt lgkmcnt(4)
    v_mfma_f32_32x32x16_bf16 v[96:111], v[120:123], a[48:51], v[96:111]
    ds_read_b64_tr_b16 v[116:117], v153 offset:16384
    ds_read_b64_tr_b16 v[118:119], v153 offset:16896
    v_mfma_f32_32x32x16_bf16 v[96:111], v[124:127], a[52:55], v[96:111]
    ds_read_b64_tr_b16 v[120:121], v153 offset:17408
    ds_read_b64_tr_b16 v[122:123], v153 offset:17920
    s_waitcnt lgkmcnt(4)
    v_mfma_f32_32x32x16_bf16 v[96:111], v[128:131], a[56:59], v[96:111]
    ds_read_b64_tr_b16 v[124:125], v153 offset:18432
    ds_read_b64_tr_b16 v[126:127], v153 offset:18944
    v_mfma_f32_32x32x16_bf16 v[96:111], v[112:115], a[60:63], v[96:111]
    ds_read_b64_tr_b16 v[128:129], v153 offset:19456
    ds_read_b64_tr_b16 v[130:131], v153 offset:19968
    s_waitcnt lgkmcnt(4)
    v_mfma_f32_32x32x16_bf16 v[96:111], v[116:119], a[64:67], v[96:111]
    ds_read_b64_tr_b16 v[112:113], v153 offset:20480
    ds_read_b64_tr_b16 v[114:115], v153 offset:20992
    v_mfma_f32_32x32x16_bf16 v[96:111], v[120:123], a[68:71], v[96:111]
    ds_read_b64_tr_b16 v[116:117], v153 offset:21504
    ds_read_b64_tr_b16 v[118:119], v153 offset:22016
    s_waitcnt lgkmcnt(4)
    v_mfma_f32_32x32x16_bf16 v[96:111], v[124:127], a[72:75], v[96:111]
    ds_read_b64_tr_b16 v[120:121], v153 offset:22528
    ds_read_b64_tr_b16 v[122:123], v153 offset:23040
    v_mfma_f32_32x32x16_bf16 v[96:111], v[128:131], a[76:79], v[96:111]
    ds_read_b64_tr_b16 v[124:125], v153 offset:23552
    ds_read_b64_tr_b16 v[126:127], v153 offset:24064
    s_waitcnt lgkmcnt(4)
    v_mfma_f32_32x32x16_bf16 v[96:111], v[112:115], a[80:83], v[96:111]
    ds_read_b64_tr_b16 v[128:129], v153 offset:24576
    ds_read_b64_tr_b16 v[130:131], v153 offset:25088
    v_mfma_f32_32x32x16_bf16 v[96:111], v[116:119], a[84:87], v[96:111]
    ds_read_b64_tr_b16 v[112:113], v153 offset:25600
    ds_read_b64_tr_b16 v[114:115], v153 offset:26112
    s_waitcnt lgkmcnt(4)
    v_mfma_f32_32x32x16_bf16 v[96:111], v[120:123], a[88:91], v[96:111]
    ds_read_b64_tr_b16 v[116:117], v153 offset:26624
    ds_read_b64_tr_b16 v[118:119], v153 offset:27136
    v_mfma_f32_32x32x16_bf16 v[96:111], v[124:127], a[92:95], v[96:111]
    ds_read_b64_tr_b16 v[120:121], v153 offset:27648
    ds_read_b64_tr_b16 v[122:123], v153 offset:28160
    s_waitcnt lgkmcnt(4)
    v_mfma_f32_32x32x16_bf16 v[96:111], v[128:131], a[96:99], v[96:111]
    ds_read_b64_tr_b16 v[124:125], v153 offset:28672
    ds_read_b64_tr_b16 v[126:127], v153 offset:29184
    v_mfma_f32_32x32x16_bf16 v[96:111], v[112:115], a[100:103], v[96:111]
    ds_read_b64_tr_b16 v[128:129], v153 offset:29696
    ds_read_b64_tr_b16 v[130:131], v153 offset:30208
    s_waitcnt lgkmcnt(4)
    v_mfma_f32_32x32x16_bf16 v[96:111], v[116:119], a[104:107], v[96:111]
    ds_read_b64_tr_b16 v[112:113], v153 offset:30720
    ds_read_b64_tr_b16 v[114:115], v153 offset:31232
    v_mfma_f32_32x32x16_bf16 v[96:111], v[120:123], a[108:111], v[96:111]
    ds_read_b64_tr_b16 v[116:117], v153 offset:31744
    ds_read_b64_tr_b16 v[118:119], v153 offset:32256
    s_waitcnt lgkmcnt(4)
    v_mfma_f32_32x32x16_bf16 v[96:111], v[124:127], a[112:115], v[96:111]
    ds_read_b128 v[120:123], v1 offset:34816
    v_mfma_f32_32x32x16_bf16 v[96:111], v[128:131], a[116:119], v[96:111]
    s_waitcnt lgkmcnt(1)
    v_mfma_f32_32x32x16_bf16 v[96:111], v[112:115], a[120:123], v[96:111]
    v_mfma_f32_32x32x16_bf16 v[96:111], v[116:119], a[124:127], v[96:111]
    s_waitcnt lgkmcnt(0)
    v_mfma_f32_32x32x16_bf16 v[96:111], v[120:123], v[16:19], v[96:111]
    s_bitcmp1_b32 s16, 0
    s_cbranch_scc1 po261
    s_lshl_b32 s43, s18, 12
    s_add_u32 s44, s43, 134144
    s_add_u32 s45, s43, s26
    s_add_u32 m0, s44, 0
    s_add_u32 s42, s45, 134144
    buffer_load_dwordx4 v0, s[8:11], s42 offen offset:0 lds
    buffer_load_dwordx4 v0, s[8:11], s42 offen offset:1024 lds
    buffer_load_dwordx4 v0, s[8:11], s42 offen offset:2048 lds
    buffer_load_dwordx4 v0, s[8:11], s42 offen offset:3072 lds
    s_branch pd262
po261:
    s_add_u32 m0, s60, 0
    s_add_u32 s42, s61, 101376
    buffer_load_dwordx4 v0, s[8:11], s42 offen offset:0 lds
    buffer_load_dwordx4 v0, s[8:11], s42 offen offset:1024 lds
    buffer_load_dwordx4 v0, s[8:11], s42 offen offset:2048 lds
    buffer_load_dwordx4 v0, s[8:11], s42 offen offset:3072 lds
    s_add_u32 m0, s60, 4096
    s_add_u32 s42, s61, 105472
    buffer_load_dwordx4 v0, s[8:11], s42 offen offset:0 lds
    buffer_load_dwordx4 v0, s[8:11], s42 offen offset:1024 lds
    buffer_load_dwordx4 v0, s[8:11], s42 offen offset:2048 lds
    buffer_load_dwordx4 v0, s[8:11], s42 offen offset:3072 lds
    s_lshl_b32 s43, s18, 12
    s_add_u32 s44, s43, 134144
    s_add_u32 s45, s43, s26
    s_add_u32 m0, s44, 0
    s_add_u32 s42, s45, 134144
    buffer_load_dwordx4 v0, s[8:11], s42 offen offset:0 lds
    buffer_load_dwordx4 v0, s[8:11], s42 offen offset:1024 lds
    buffer_load_dwordx4 v0, s[8:11], s42 offen offset:2048 lds
    buffer_load_dwordx4 v0, s[8:11], s42 offen offset:3072 lds
pd262:
    v_mul_f32 v28, 0x3fb8aa3b, v24
    v_mul_f32 v96, v96, v28
    v_mul_f32 v97, v97, v28
    v_mul_f32 v98, v98, v28
    v_mul_f32 v99, v99, v28
    v_mul_f32 v100, v100, v28
    v_mul_f32 v101, v101, v28
    v_mul_f32 v102, v102, v28
    v_mul_f32 v103, v103, v28
    v_mul_f32 v104, v104, v28
    v_mul_f32 v105, v105, v28
    v_mul_f32 v106, v106, v28
    v_mul_f32 v107, v107, v28
    v_mul_f32 v108, v108, v28
    v_mul_f32 v109, v109, v28
    v_mul_f32 v110, v110, v28
    v_mul_f32 v111, v111, v28
    v_exp_f32_e64 v80, v96 clamp
    v_max_f32 v96, 0, v96
    v_exp_f32_e64 v81, v97 clamp
    v_max_f32 v97, 0, v97
    v_exp_f32_e64 v82, v98 clamp
    v_max_f32 v98, 0, v98
    v_exp_f32_e64 v83, v99 clamp
    v_max_f32 v99, 0, v99
    v_exp_f32_e64 v84, v100 clamp
    v_max_f32 v100, 0, v100
    v_exp_f32_e64 v85, v101 clamp
    v_max_f32 v101, 0, v101
    v_exp_f32_e64 v86, v102 clamp
    v_max_f32 v102, 0, v102
    v_exp_f32_e64 v87, v103 clamp
    v_max_f32 v103, 0, v103
    v_exp_f32_e64 v88, v104 clamp
    v_max_f32 v104, 0, v104
    v_exp_f32_e64 v89, v105 clamp
    v_max_f32 v105, 0, v105
    v_exp_f32_e64 v90, v106 clamp
    v_max_f32 v106, 0, v106
    v_exp_f32_e64 v91, v107 clamp
    v_max_f32 v107, 0, v107
    v_exp_f32_e64 v92, v108 clamp
    v_max_f32 v108, 0, v108
    v_exp_f32_e64 v93, v109 clamp
    v_max_f32 v109, 0, v109
    v_exp_f32_e64 v94, v110 clamp
    v_max_f32 v110, 0, v110
    v_exp_f32_e64 v95, v111 clamp
    v_max_f32 v111, 0, v111
    v_fma_f32 v96, v96, s37, v80
    v_fma_f32 v97, v97, s37, v81
    v_fma_f32 v98, v98, s37, v82
    v_fma_f32 v99, v99, s37, v83
    v_fma_f32 v100, v100, s37, v84
    v_fma_f32 v101, v101, s37, v85
    v_fma_f32 v102, v102, s37, v86
    v_fma_f32 v103, v103, s37, v87
    v_fma_f32 v104, v104, s37, v88
    v_fma_f32 v105, v105, s37, v89
    v_fma_f32 v106, v106, s37, v90
    v_fma_f32 v107, v107, s37, v91
    v_fma_f32 v108, v108, s37, v92
    v_fma_f32 v109, v109, s37, v93
    v_fma_f32 v110, v110, s37, v94
    v_fma_f32 v111, v111, s37, v95
    v_add_f32 v96, s38, v96
    v_add_f32 v97, s38, v97
    v_add_f32 v98, s38, v98
    v_add_f32 v99, s38, v99
    v_add_f32 v100, s38, v100
    v_add_f32 v101, s38, v101
    v_add_f32 v102, s38, v102
    v_add_f32 v103, s38, v103
    v_add_f32 v104, s38, v104
    v_add_f32 v105, s38, v105
    v_add_f32 v106, s38, v106
    v_add_f32 v107, s38, v107
    v_add_f32 v108, s38, v108
    v_add_f32 v109, s38, v109
    v_add_f32 v110, s38, v110
    v_add_f32 v111, s38, v111
    v_cvt_pk_bf16_f32 v132, v96, v97
    v_cvt_pk_bf16_f32 v133, v98, v99
    v_cvt_pk_bf16_f32 v134, v100, v101
    v_cvt_pk_bf16_f32 v135, v102, v103
    v_cvt_pk_bf16_f32 v136, v104, v105
    v_cvt_pk_bf16_f32 v137, v106, v107
    v_cvt_pk_bf16_f32 v138, v108, v109
    v_cvt_pk_bf16_f32 v139, v110, v111
    v_lshrrev_b32 v7, 2, v0
    v_and_b32 v6, 0x7f, v7
    v_mov_b32 v28, v6
s1r263:
    s_add_u32 s40, s36, 0
    buffer_load_dwordx4 v[64:67], v0, s[8:11], s40 offen sc1
    buffer_load_dword v80, v28, s[8:11], s40 offen offset:1024 sc1
    s_add_u32 s40, s36, 4096
    buffer_load_dwordx4 v[68:71], v0, s[8:11], s40 offen sc1
    buffer_load_dword v81, v28, s[8:11], s40 offen offset:1024 sc1
    s_add_u32 s40, s36, 8192
    buffer_load_dwordx4 v[72:75], v0, s[8:11], s40 offen sc1
    buffer_load_dword v82, v28, s[8:11], s40 offen offset:1024 sc1
    s_add_u32 s40, s36, 12288
    buffer_load_dwordx4 v[76:79], v0, s[8:11], s40 offen sc1
    buffer_load_dword v83, v28, s[8:11], s40 offen offset:1024 sc1
    s_waitcnt vmcnt(0)
    v_max3_u32 v6, v64, v65, v66
    v_max3_u32 v6, v6, v67, v68
    v_max3_u32 v6, v6, v69, v70
    v_max3_u32 v6, v6, v71, v72
    v_max3_u32 v6, v6, v73, v74
    v_max3_u32 v6, v6, v75, v76
    v_max3_u32 v6, v6, v77, v78
    v_max3_u32 v6, v6, v79, v80
    v_max3_u32 v6, v6, v81, v82
    v_max_u32 v6, v6, v83
    v_cmp_eq_u32 vcc, -1, v6
    s_cmp_eq_u32 s34, 0
    s_cbranch_scc1 s1ok264
    s_sub_u32 s34, s34, 1
    s_cbranch_vccnz s1r263
s1ok264:
    s_and_b32 s43, s16, 1
    s_mul_i32 s43, s43, 22528
    s_mul_i32 s44, s18, 5632
    s_add_u32 s43, s43, s44
    s_add_u32 s43, s43, s26
    s_add_u32 s43, s43, 150528
    v_lshlrev_b32 v155, 3, v0
    s_mov_b32 exec_hi, 0xfff
    buffer_load_dword v152, v155, s[8:11], s43 offen
    s_mov_b64 exec, -1
    v_lshlrev_b32 v48, 16, v64
    v_and_b32 v49, 0xffff0000, v64
    v_lshlrev_b32 v50, 16, v65
    v_and_b32 v51, 0xffff0000, v65
    v_lshlrev_b32 v52, 16, v66
    v_and_b32 v53, 0xffff0000, v66
    v_lshlrev_b32 v54, 16, v67
    v_and_b32 v55, 0xffff0000, v67
    v_lshlrev_b32 v56, 16, v68
    v_and_b32 v57, 0xffff0000, v68
    v_lshlrev_b32 v58, 16, v69
    v_and_b32 v59, 0xffff0000, v69
    v_lshlrev_b32 v60, 16, v70
    v_and_b32 v61, 0xffff0000, v70
    v_lshlrev_b32 v62, 16, v71
    v_and_b32 v63, 0xffff0000, v71
    v_add_f32 v48, v48, v56
    v_add_f32 v49, v49, v57
    v_add_f32 v50, v50, v58
    v_add_f32 v51, v51, v59
    v_add_f32 v52, v52, v60
    v_add_f32 v53, v53, v61
    v_add_f32 v54, v54, v62
    v_add_f32 v55, v55, v63
    v_lshlrev_b32 v56, 16, v72
    v_and_b32 v57, 0xffff0000, v72
    v_lshlrev_b32 v58, 16, v73
    v_and_b32 v59, 0xffff0000, v73
    v_lshlrev_b32 v60, 16, v74
    v_and_b32 v61, 0xffff0000, v74
    v_lshlrev_b32 v62, 16, v75
    v_and_b32 v63, 0xffff0000, v75
    v_add_f32 v48, v48, v56
    v_add_f32 v49, v49, v57
    v_add_f32 v50, v50, v58
    v_add_f32 v51, v51, v59
    v_add_f32 v52, v52, v60
    v_add_f32 v53, v53, v61
    v_add_f32 v54, v54, v62
    v_add_f32 v55, v55, v63
    v_lshlrev_b32 v56, 16, v76
    v_and_b32 v57, 0xffff0000, v76
    v_lshlrev_b32 v58, 16, v77
    v_and_b32 v59, 0xffff0000, v77
    v_lshlrev_b32 v60, 16, v78
    v_and_b32 v61, 0xffff0000, v78
    v_lshlrev_b32 v62, 16, v79
    v_and_b32 v63, 0xffff0000, v79
    v_add_f32 v48, v48, v56
    v_add_f32 v49, v49, v57
    v_add_f32 v50, v50, v58
    v_add_f32 v51, v51, v59
    v_add_f32 v52, v52, v60
    v_add_f32 v53, v53, v61
    v_add_f32 v54, v54, v62
    v_add_f32 v55, v55, v63
    v_add_f32 v80, v80, v81
    v_add_f32 v82, v82, v83
    v_add_f32 v80, v80, v82
    s_mul_i32 s40, s18, 2304
    v_add_u32 v6, s40, v4
    s_add_u32 s41, s40, 101376
    v_add_u32 v7, s41, v7
    ds_write_b128 v6, v[48:51] offset:49152
    ds_write_b128 v6, v[52:55] offset:50176
    ds_write_b32 v7, v80 offset:51200
    s_waitcnt lgkmcnt(0)
    s_barrier
    ds_read_b128 v[48:51], v4 offset:49152
    ds_read_b128 v[52:55], v4 offset:50176
    ds_read_b128 v[56:59], v4 offset:51456
    ds_read_b128 v[60:63], v4 offset:52480
    ds_read_b128 v[64:67], v4 offset:53760
    ds_read_b128 v[68:71], v4 offset:54784
    ds_read_b128 v[72:75], v4 offset:56064
    ds_read_b128 v[76:79], v4 offset:57088
    ds_read_b128 v[112:115], v23 offset:51200
    ds_read_b128 v[116:119], v23 offset:51232
    ds_read_b128 v[120:123], v23 offset:53504
    ds_read_b128 v[124:127], v23 offset:53536
    ds_read_b128 v[128:131], v23 offset:55808
    ds_read_b128 v[44:47], v23 offset:55840
    ds_read_b128 v[28:31], v23 offset:58112
    ds_read_b128 v[32:35], v23 offset:58144
    s_waitcnt lgkmcnt(8)
    v_add_f32 v48, v48, v56
    v_add_f32 v64, v64, v72
    v_add_f32 v49, v49, v57
    v_add_f32 v65, v65, v73
    v_add_f32 v50, v50, v58
    v_add_f32 v66, v66, v74
    v_add_f32 v51, v51, v59
    v_add_f32 v67, v67, v75
    v_add_f32 v52, v52, v60
    v_add_f32 v68, v68, v76
    v_add_f32 v53, v53, v61
    v_add_f32 v69, v69, v77
    v_add_f32 v54, v54, v62
    v_add_f32 v70, v70, v78
    v_add_f32 v55, v55, v63
    v_add_f32 v71, v71, v79
    v_add_f32 v48, v48, v64
    v_add_f32 v49, v49, v65
    v_add_f32 v50, v50, v66
    v_add_f32 v51, v51, v67
    v_add_f32 v52, v52, v68
    v_add_f32 v53, v53, v69
    v_add_f32 v54, v54, v70
    v_add_f32 v55, v55, v71
    s_waitcnt lgkmcnt(0)
    s_barrier
main_mode_slow:
    v_add_f32 v112, v112, v120
    v_add_f32 v116, v116, v124
    v_add_f32 v128, v128, v28
    v_add_f32 v44, v44, v32
    v_add_f32 v113, v113, v121
    v_add_f32 v117, v117, v125
    v_add_f32 v129, v129, v29
    v_add_f32 v45, v45, v33
    v_add_f32 v114, v114, v122
    v_add_f32 v118, v118, v126
    v_add_f32 v130, v130, v30
    v_add_f32 v46, v46, v34
    v_add_f32 v115, v115, v123
    v_add_f32 v119, v119, v127
    v_add_f32 v131, v131, v31
    v_add_f32 v47, v47, v35
    v_cvt_pk_bf16_f32 v36, v48, v49
    v_cvt_pk_bf16_f32 v37, v50, v51
    v_cvt_pk_bf16_f32 v38, v52, v53
    v_cvt_pk_bf16_f32 v39, v54, v55
    v_add_f32 v112, v112, v128
    v_add_f32 v116, v116, v44
    v_add_f32 v113, v113, v129
    v_add_f32 v117, v117, v45
    v_add_f32 v114, v114, v130
    v_add_f32 v118, v118, v46
    v_add_f32 v115, v115, v131
    v_add_f32 v119, v119, v47
    v_cndmask_b32_e64 v80, v36, 0, s[30:31]
    v_cndmask_b32_e64 v84, 0, v36, s[30:31]
    v_cndmask_b32_e64 v81, v37, 0, s[30:31]
    v_cndmask_b32_e64 v85, 0, v37, s[30:31]
    v_cndmask_b32_e64 v82, v38, 0, s[30:31]
    v_cndmask_b32_e64 v86, 0, v38, s[30:31]
    v_cndmask_b32_e64 v83, v39, 0, s[30:31]
    v_cndmask_b32_e64 v87, 0, v39, s[30:31]
    v_cvt_pk_bf16_f32 v40, v112, v113
    v_cvt_pk_bf16_f32 v41, v114, v115
    v_cvt_pk_bf16_f32 v42, v116, v117
    v_cvt_pk_bf16_f32 v43, v118, v119
    v_mfma_f32_32x32x16_bf16 v[48:63], v[80:83], v[132:135], 0
    v_cndmask_b32_e64 v88, v40, 0, s[30:31]
    v_cndmask_b32_e64 v92, 0, v40, s[30:31]
    v_cndmask_b32_e64 v89, v41, 0, s[30:31]
    v_cndmask_b32_e64 v93, 0, v41, s[30:31]
    v_cndmask_b32_e64 v90, v42, 0, s[30:31]
    v_cndmask_b32_e64 v94, 0, v42, s[30:31]
    v_cndmask_b32_e64 v91, v43, 0, s[30:31]
    v_cndmask_b32_e64 v95, 0, v43, s[30:31]
    v_mfma_f32_32x32x16_bf16 v[48:63], v[84:87], v[136:139], v[48:63]
    v_mfma_f32_32x32x16_bf16 v[64:79], v[88:91], v[132:135], 0
    v_mfma_f32_32x32x16_bf16 v[64:79], v[92:95], v[136:139], v[64:79]
    s_lshl_b32 s40, s17, 11
    s_add_u32 s40, s40, s21
    s_nop 9
    v_add_f32 v28, s38, v64
    v_add_f32 v29, s38, v72
    v_rcp_f32 v28, v28
    v_rcp_f32 v29, v29
    v_mul_f32 v28, s37, v28
    v_mul_f32 v29, s37, v29
    v_mul_f32 v48, v48, v28
    v_mul_f32 v49, v49, v28
    v_mul_f32 v50, v50, v28
    v_mul_f32 v51, v51, v28
    v_mul_f32 v52, v52, v28
    v_mul_f32 v53, v53, v28
    v_mul_f32 v54, v54, v28
    v_mul_f32 v55, v55, v28
    v_cvt_pk_bf16_f32 v36, v48, v49
    v_cvt_pk_bf16_f32 v37, v50, v51
    v_cvt_pk_bf16_f32 v38, v52, v53
    v_cvt_pk_bf16_f32 v39, v54, v55
    buffer_store_dwordx4 v[36:39], v0, s[8:11], s40 offen sc1
    v_mul_f32 v56, v56, v29
    v_mul_f32 v57, v57, v29
    v_mul_f32 v58, v58, v29
    v_mul_f32 v59, v59, v29
    v_mul_f32 v60, v60, v29
    v_mul_f32 v61, v61, v29
    v_mul_f32 v62, v62, v29
    v_mul_f32 v63, v63, v29
    v_cvt_pk_bf16_f32 v40, v56, v57
    v_cvt_pk_bf16_f32 v41, v58, v59
    v_cvt_pk_bf16_f32 v42, v60, v61
    v_cvt_pk_bf16_f32 v43, v62, v63
    buffer_store_dwordx4 v[40:43], v0, s[8:11], s40 offen offset:1024 sc1
    s_mul_i32 s43, s18, 3072
    s_add_u32 s44, s43, 150528
    s_add_u32 s45, s43, s26
    s_add_u32 m0, s44, 0
    s_add_u32 s42, s45, 150528
    buffer_load_dwordx4 v0, s[8:11], s42 offen offset:0 lds
    buffer_load_dwordx4 v0, s[8:11], s42 offen offset:1024 lds
    buffer_load_dwordx4 v0, s[8:11], s42 offen offset:2048 lds
    s_add_u32 s58, s28, 1
    v_mov_b32 v7, s58
    s_waitcnt vmcnt(3)
    buffer_store_dword v7, off, s[8:11], s25 sc1
    buffer_load_dword v6, v2, s[8:11], s24 offen sc1
    s_add_u32 s62, s28, 1
    s_waitcnt vmcnt(0)
    v_cmp_gt_u32 vcc, s62, v6
    s_cbranch_vccnz ob265
or266:
    s_add_u32 s68, s21, 0
    buffer_load_dwordx4 a[0:3], v0, s[8:11], s68 offen offset:0 sc1
    buffer_load_dwordx4 a[4:7], v0, s[8:11], s68 offen offset:1024 sc1
    buffer_load_dwordx4 a[8:11], v0, s[8:11], s68 offen offset:2048 sc1
    buffer_load_dwordx4 a[12:15], v0, s[8:11], s68 offen offset:3072 sc1
    s_add_u32 s68, s21, 4096
    buffer_load_dwordx4 a[16:19], v0, s[8:11], s68 offen offset:0 sc1
    ds_read_b128 v[112:115], v4 offset:0
    ds_read_b128 v[116:119], v4 offset:1024
    ds_read_b128 v[120:123], v4 offset:2048
    ds_read_b128 v[124:127], v4 offset:3072
    s_waitcnt vmcnt(4) lgkmcnt(2)
    v_mfma_f32_32x32x16_bf16 v[96:111], v[112:115], a[0:3], 0
    ds_read_b128 v[128:131], v4 offset:4096
    buffer_load_dwordx4 a[20:23], v0, s[8:11], s68 offen offset:1024 sc1
    buffer_load_dwordx4 a[24:27], v0, s[8:11], s68 offen offset:2048 sc1
    s_waitcnt vmcnt(5)
    v_mfma_f32_32x32x16_bf16 v[96:111], v[116:119], a[4:7], v[96:111]
    ds_read_b128 v[112:115], v4 offset:5120
    buffer_load_dwordx4 a[28:31], v0, s[8:11], s68 offen offset:3072 sc1
    s_add_u32 s68, s21, 8192
    buffer_load_dwordx4 a[32:35], v0, s[8:11], s68 offen offset:0 sc1
    s_waitcnt vmcnt(6) lgkmcnt(2)
    v_mfma_f32_32x32x16_bf16 v[96:111], v[120:123], a[8:11], v[96:111]
    ds_read_b128 v[116:119], v4 offset:6144
    buffer_load_dwordx4 a[36:39], v0, s[8:11], s68 offen offset:1024 sc1
    buffer_load_dwordx4 a[40:43], v0, s[8:11], s68 offen offset:2048 sc1
    s_waitcnt vmcnt(7)
    v_mfma_f32_32x32x16_bf16 v[96:111], v[124:127], a[12:15], v[96:111]
    ds_read_b128 v[120:123], v4 offset:7168
    buffer_load_dwordx4 a[44:47], v0, s[8:11], s68 offen offset:3072 sc1
    s_add_u32 s68, s21, 12288
    buffer_load_dwordx4 a[48:51], v0, s[8:11], s68 offen offset:0 sc1
    s_waitcnt vmcnt(8) lgkmcnt(2)
    v_mfma_f32_32x32x16_bf16 v[96:111], v[128:131], a[16:19], v[96:111]
    ds_read_b128 v[124:127], v4 offset:8192
    buffer_load_dwordx4 a[52:55], v0, s[8:11], s68 offen offset:1024 sc1
    s_waitcnt vmcnt(8)
    v_mfma_f32_32x32x16_bf16 v[96:111], v[112:115], a[20:23], v[96:111]
    ds_read_b128 v[128:131], v4 offset:9216
    buffer_load_dwordx4 a[56:59], v0, s[8:11], s68 offen offset:2048 sc1
    s_waitcnt vmcnt(8) lgkmcnt(2)
    v_mfma_f32_32x32x16_bf16 v[96:111], v[116:119], a[24:27], v[96:111]
    ds_read_b128 v[112:115], v4 offset:10240
    buffer_load_dwordx4 a[60:63], v0, s[8:11], s68 offen offset:3072 sc1
    s_waitcnt vmcnt(8)
    v_mfma_f32_32x32x16_bf16 v[96:111], v[120:123], a[28:31], v[96:111]
    ds_read_b128 v[116:119], v4 offset:11264
    s_add_u32 s68, s21, 16384
    buffer_load_dwordx4 a[64:67], v0, s[8:11], s68 offen offset:0 sc1
    s_waitcnt vmcnt(8) lgkmcnt(2)
    v_mfma_f32_32x32x16_bf16 v[96:111], v[124:127], a[32:35], v[96:111]
    ds_read_b128 v[120:123], v4 offset:12288
    buffer_load_dwordx4 a[68:71], v0, s[8:11], s68 offen offset:1024 sc1
    s_waitcnt vmcnt(8)
    v_mfma_f32_32x32x16_bf16 v[96:111], v[128:131], a[36:39], v[96:111]
    ds_read_b128 v[124:127], v4 offset:13312
    buffer_load_dwordx4 a[72:75], v0, s[8:11], s68 offen offset:2048 sc1
    s_waitcnt vmcnt(8) lgkmcnt(2)
    v_mfma_f32_32x32x16_bf16 v[96:111], v[112:115], a[40:43], v[96:111]
    ds_read_b128 v[128:131], v4 offset:14336
    buffer_load_dwordx4 a[76:79], v0, s[8:11], s68 offen offset:3072 sc1
    s_waitcnt vmcnt(8)
    v_mfma_f32_32x32x16_bf16 v[96:111], v[116:119], a[44:47], v[96:111]
    ds_read_b128 v[112:115], v4 offset:15360
    s_add_u32 s68, s21, 20480
    buffer_load_dwordx4 a[80:83], v0, s[8:11], s68 offen offset:0 sc1
    s_waitcnt vmcnt(8) lgkmcnt(2)
    v_mfma_f32_32x32x16_bf16 v[96:111], v[120:123], a[48:51], v[96:111]
    ds_read_b128 v[116:119], v4 offset:16384
    buffer_load_dwordx4 a[84:87], v0, s[8:11], s68 offen offset:1024 sc1
    s_waitcnt vmcnt(8)
    v_mfma_f32_32x32x16_bf16 v[96:111], v[124:127], a[52:55], v[96:111]
    ds_read_b128 v[120:123], v4 offset:17408
    buffer_load_dwordx4 a[88:91], v0, s[8:11], s68 offen offset:2048 sc1
    s_waitcnt vmcnt(8) lgkmcnt(2)
    v_mfma_f32_32x32x16_bf16 v[96:111], v[128:131], a[56:59], v[96:111]
    ds_read_b128 v[124:127], v4 offset:18432
    buffer_load_dwordx4 a[92:95], v0, s[8:11], s68 offen offset:3072 sc1
    s_waitcnt vmcnt(8)
    v_mfma_f32_32x32x16_bf16 v[96:111], v[112:115], a[60:63], v[96:111]
    ds_read_b128 v[128:131], v4 offset:19456
    s_add_u32 s68, s21, 24576
    buffer_load_dwordx4 a[96:99], v0, s[8:11], s68 offen offset:0 sc1
    s_waitcnt vmcnt(8) lgkmcnt(2)
    v_mfma_f32_32x32x16_bf16 v[96:111], v[116:119], a[64:67], v[96:111]
    ds_read_b128 v[112:115], v4 offset:20480
    buffer_load_dwordx4 a[100:103], v0, s[8:11], s68 offen offset:1024 sc1
    s_waitcnt vmcnt(8)
    v_mfma_f32_32x32x16_bf16 v[96:111], v[120:123], a[68:71], v[96:111]
    ds_read_b128 v[116:119], v4 offset:21504
    buffer_load_dwordx4 a[104:107], v0, s[8:11], s68 offen offset:2048 sc1
    s_waitcnt vmcnt(8) lgkmcnt(2)
    v_mfma_f32_32x32x16_bf16 v[96:111], v[124:127], a[72:75], v[96:111]
    ds_read_b128 v[120:123], v4 offset:22528
    buffer_load_dwordx4 a[108:111], v0, s[8:11], s68 offen offset:3072 sc1
    s_waitcnt vmcnt(8)
    v_mfma_f32_32x32x16_bf16 v[96:111], v[128:131], a[76:79], v[96:111]
    ds_read_b128 v[124:127], v4 offset:23552
    s_add_u32 s68, s21, 28672
    buffer_load_dwordx4 a[112:115], v0, s[8:11], s68 offen offset:0 sc1
    s_waitcnt vmcnt(8) lgkmcnt(2)
    v_mfma_f32_32x32x16_bf16 v[96:111], v[112:115], a[80:83], v[96:111]
    ds_read_b128 v[128:131], v4 offset:24576
    buffer_load_dwordx4 a[116:119], v0, s[8:11], s68 offen offset:1024 sc1
    s_waitcnt vmcnt(8)
    v_mfma_f32_32x32x16_bf16 v[96:111], v[116:119], a[84:87], v[96:111]
    ds_read_b128 v[112:115], v4 offset:25600
    buffer_load_dwordx4 a[120:123], v0, s[8:11], s68 offen offset:2048 sc1
    s_waitcnt vmcnt(8) lgkmcnt(2)
    v_mfma_f32_32x32x16_bf16 v[96:111], v[120:123], a[88:91], v[96:111]
    ds_read_b128 v[116:119], v4 offset:26624
    buffer_load_dwordx4 a[124:127], v0, s[8:11], s68 offen offset:3072 sc1
    s_waitcnt vmcnt(8)
    v_mfma_f32_32x32x16_bf16 v[96:111], v[124:127], a[92:95], v[96:111]
    ds_read_b128 v[120:123], v4 offset:27648
    s_waitcnt vmcnt(7) lgkmcnt(2)
    v_mfma_f32_32x32x16_bf16 v[96:111], v[128:131], a[96:99], v[96:111]
    ds_read_b128 v[124:127], v4 offset:28672
    s_waitcnt vmcnt(6)
    v_mfma_f32_32x32x16_bf16 v[96:111], v[112:115], a[100:103], v[96:111]
    ds_read_b128 v[128:131], v4 offset:29696
    s_waitcnt vmcnt(5) lgkmcnt(2)
    v_mfma_f32_32x32x16_bf16 v[96:111], v[116:119], a[104:107], v[96:111]
    ds_read_b128 v[112:115], v4 offset:30720
    s_waitcnt vmcnt(4)
    v_mfma_f32_32x32x16_bf16 v[96:111], v[120:123], a[108:111], v[96:111]
    ds_read_b128 v[116:119], v4 offset:31744
    s_waitcnt vmcnt(3) lgkmcnt(2)
    v_mfma_f32_32x32x16_bf16 v[96:111], v[124:127], a[112:115], v[96:111]
    s_waitcnt vmcnt(2)
    v_mfma_f32_32x32x16_bf16 v[96:111], v[128:131], a[116:119], v[96:111]
    s_waitcnt vmcnt(1) lgkmcnt(0)
    v_mfma_f32_32x32x16_bf16 v[96:111], v[112:115], a[120:123], v[96:111]
    s_waitcnt vmcnt(0)
    v_mfma_f32_32x32x16_bf16 v[96:111], v[116:119], a[124:127], v[96:111]
    s_barrier
    v_lshlrev_b32 v28, 16, v8
    v_and_b32 v29, 0xffff0000, v8
    v_lshlrev_b32 v30, 16, v9
    v_and_b32 v31, 0xffff0000, v9
    v_lshlrev_b32 v32, 16, v10
    v_and_b32 v33, 0xffff0000, v10
    v_lshlrev_b32 v34, 16, v11
    v_and_b32 v35, 0xffff0000, v11
    v_lshlrev_b32 v36, 16, v12
    v_and_b32 v37, 0xffff0000, v12
    v_lshlrev_b32 v38, 16, v13
    v_and_b32 v39, 0xffff0000, v13
    v_lshlrev_b32 v40, 16, v14
    v_and_b32 v41, 0xffff0000, v14
    v_lshlrev_b32 v42, 16, v15
    v_and_b32 v43, 0xffff0000, v15
    v_add_f32 v96, v96, v28
    v_add_f32 v97, v97, v29
    v_add_f32 v98, v98, v30
    v_add_f32 v99, v99, v31
    v_add_f32 v100, v100, v32
    v_add_f32 v101, v101, v33
    v_add_f32 v102, v102, v34
    v_add_f32 v103, v103, v35
    v_add_f32 v104, v104, v36
    v_add_f32 v105, v105, v37
    v_add_f32 v106, v106, v38
    v_add_f32 v107, v107, v39
    v_add_f32 v108, v108, v40
    v_add_f32 v109, v109, v41
    v_add_f32 v110, v110, v42
    v_add_f32 v111, v111, v43
    v_cvt_pk_bf16_f32 v8, v96, v97
    v_cvt_pk_bf16_f32 v9, v98, v99
    v_cvt_pk_bf16_f32 v10, v100, v101
    v_cvt_pk_bf16_f32 v11, v102, v103
    v_cvt_pk_bf16_f32 v12, v104, v105
    v_cvt_pk_bf16_f32 v13, v106, v107
    v_cvt_pk_bf16_f32 v14, v108, v109
    v_cvt_pk_bf16_f32 v15, v110, v111
    s_lshl_b32 s40, s17, 11
    s_add_u32 s40, s40, s20
    buffer_store_dwordx4 v[8:11], v0, s[8:11], s40 offen sc1
    buffer_store_dwordx4 v[12:15], v0, s[8:11], s40 offen offset:1024 sc1
    v_mov_b32 v30, 0
    v_mov_b32 v31, 0
    v_mov_b32 v34, 0x3f803f80
    v_dot2_f32_bf16 v30, v8, v34, v30
    v_dot2_f32_bf16 v31, v8, v8, v31
    v_dot2_f32_bf16 v30, v9, v34, v30
    v_dot2_f32_bf16 v31, v9, v9, v31
    v_dot2_f32_bf16 v30, v10, v34, v30
    v_dot2_f32_bf16 v31, v10, v10, v31
    v_dot2_f32_bf16 v30, v11, v34, v30
    v_dot2_f32_bf16 v31, v11, v11, v31
    v_dot2_f32_bf16 v30, v12, v34, v30
    v_dot2_f32_bf16 v31, v12, v12, v31
    v_dot2_f32_bf16 v30, v13, v34, v30
    v_dot2_f32_bf16 v31, v13, v13, v31
    v_dot2_f32_bf16 v30, v14, v34, v30
    v_dot2_f32_bf16 v31, v14, v14, v31
    v_dot2_f32_bf16 v30, v15, v34, v30
    v_dot2_f32_bf16 v31, v15, v15, v31
    v_and_b32 v6, 0x1ff, v0
    s_nop 0
    v_mov_b32 v32, v30
    v_mov_b32 v33, v31
    s_nop 0
    v_permlane32_swap_b32 v30, v32
    v_permlane32_swap_b32 v31, v33
    s_nop 0
    v_add_f32 v30, v30, v32
    v_add_f32 v31, v31, v33
    buffer_store_dwordx2 v[30:31], v6, s[8:11], s73 offen sc1
    s_add_u32 m0, s60, 0
    s_add_u32 s42, s61, 162816
    buffer_load_dwordx4 v0, s[8:11], s42 offen offset:0 lds
    buffer_load_dwordx4 v0, s[8:11], s42 offen offset:1024 lds
    buffer_load_dwordx4 v0, s[8:11], s42 offen offset:2048 lds
    buffer_load_dwordx4 v0, s[8:11], s42 offen offset:3072 lds
    s_add_u32 s58, s28, 2
    v_mov_b32 v7, s58
    s_waitcnt vmcnt(4)
    buffer_store_dword v7, off, s[8:11], s25 sc1
    s_add_u32 m0, s60, 4096
    s_add_u32 s42, s61, 166912
    buffer_load_dwordx4 v0, s[8:11], s42 offen offset:0 lds
    buffer_load_dwordx4 v0, s[8:11], s42 offen offset:1024 lds
    buffer_load_dwordx4 v0, s[8:11], s42 offen offset:2048 lds
    buffer_load_dwordx4 v0, s[8:11], s42 offen offset:3072 lds
    buffer_load_dword v6, v2, s[8:11], s24 offen sc1
    s_add_u32 s62, s28, 2
    s_waitcnt vmcnt(0)
    v_cmp_gt_u32 vcc, s62, v6
    s_cbranch_vccnz ob268
or269:
    s_add_u32 s68, s20, 0
    buffer_load_dwordx4 a[0:3], v0, s[8:11], s68 offen offset:0 sc1
    buffer_load_dwordx4 a[4:7], v0, s[8:11], s68 offen offset:1024 sc1
    buffer_load_dwordx4 a[8:11], v0, s[8:11], s68 offen offset:2048 sc1
    buffer_load_dwordx4 a[12:15], v0, s[8:11], s68 offen offset:3072 sc1
    s_add_u32 s68, s20, 4096
    buffer_load_dwordx4 a[16:19], v0, s[8:11], s68 offen offset:0 sc1
    s_lshl_b32 s46, s17, 10
    s_add_u32 s46, s46, s22
    s_barrier
    ds_read_b128 v[112:115], v4 offset:32768
    ds_read_b128 v[116:119], v4 offset:33792
    ds_read_b128 v[120:123], v4 offset:34816
    ds_read_b128 v[124:127], v4 offset:35840
    s_waitcnt vmcnt(4) lgkmcnt(2)
    v_mfma_f32_32x32x16_bf16 v[48:63], v[112:115], a[0:3], 0
    ds_read_b128 v[128:131], v4 offset:36864
    buffer_load_dwordx4 a[20:23], v0, s[8:11], s68 offen offset:1024 sc1
    buffer_load_dwordx4 a[24:27], v0, s[8:11], s68 offen offset:2048 sc1
    v_mfma_f32_32x32x16_bf16 v[64:79], v[116:119], a[0:3], 0
    ds_read_b128 v[112:115], v4 offset:37888
    s_waitcnt vmcnt(5) lgkmcnt(2)
    v_mfma_f32_32x32x16_bf16 v[48:63], v[120:123], a[4:7], v[48:63]
    ds_read_b128 v[116:119], v4 offset:38912
    buffer_load_dwordx4 a[28:31], v0, s[8:11], s68 offen offset:3072 sc1
    s_add_u32 s68, s20, 8192
    buffer_load_dwordx4 a[32:35], v0, s[8:11], s68 offen offset:0 sc1
    v_mfma_f32_32x32x16_bf16 v[64:79], v[124:127], a[4:7], v[64:79]
    ds_read_b128 v[120:123], v4 offset:39936
    s_waitcnt vmcnt(6) lgkmcnt(2)
    v_mfma_f32_32x32x16_bf16 v[48:63], v[128:131], a[8:11], v[48:63]
    ds_read_b128 v[124:127], v4 offset:40960
    buffer_load_dwordx4 a[36:39], v0, s[8:11], s68 offen offset:1024 sc1
    buffer_load_dwordx4 a[40:43], v0, s[8:11], s68 offen offset:2048 sc1
    v_mfma_f32_32x32x16_bf16 v[64:79], v[112:115], a[8:11], v[64:79]
    ds_read_b128 v[128:131], v4 offset:41984
    s_waitcnt vmcnt(7) lgkmcnt(2)
    v_mfma_f32_32x32x16_bf16 v[48:63], v[116:119], a[12:15], v[48:63]
    ds_read_b128 v[112:115], v4 offset:43008
    buffer_load_dwordx4 a[44:47], v0, s[8:11], s68 offen offset:3072 sc1
    s_add_u32 s68, s20, 12288
    buffer_load_dwordx4 a[48:51], v0, s[8:11], s68 offen offset:0 sc1
    v_mfma_f32_32x32x16_bf16 v[64:79], v[120:123], a[12:15], v[64:79]
    ds_read_b128 v[116:119], v4 offset:44032
    s_waitcnt vmcnt(8) lgkmcnt(2)
    v_mfma_f32_32x32x16_bf16 v[48:63], v[124:127], a[16:19], v[48:63]
    ds_read_b128 v[120:123], v4 offset:45056
    buffer_load_dwordx4 a[52:55], v0, s[8:11], s68 offen offset:1024 sc1
    v_mfma_f32_32x32x16_bf16 v[64:79], v[128:131], a[16:19], v[64:79]
    ds_read_b128 v[124:127], v4 offset:46080
    s_waitcnt vmcnt(8) lgkmcnt(2)
    v_mfma_f32_32x32x16_bf16 v[48:63], v[112:115], a[20:23], v[48:63]
    ds_read_b128 v[128:131], v4 offset:47104
    buffer_load_dwordx4 a[56:59], v0, s[8:11], s68 offen offset:2048 sc1
    v_mfma_f32_32x32x16_bf16 v[64:79], v[116:119], a[20:23], v[64:79]
    ds_read_b128 v[112:115], v4 offset:48128
    s_waitcnt vmcnt(8) lgkmcnt(2)
    v_mfma_f32_32x32x16_bf16 v[48:63], v[120:123], a[24:27], v[48:63]
    ds_read_b128 v[116:119], v4 offset:49152
    buffer_load_dwordx4 a[60:63], v0, s[8:11], s68 offen offset:3072 sc1
    v_mfma_f32_32x32x16_bf16 v[64:79], v[124:127], a[24:27], v[64:79]
    ds_read_b128 v[120:123], v4 offset:50176
    s_waitcnt vmcnt(8) lgkmcnt(2)
    v_mfma_f32_32x32x16_bf16 v[48:63], v[128:131], a[28:31], v[48:63]
    ds_read_b128 v[124:127], v4 offset:51200
    s_add_u32 s68, s20, 16384
    buffer_load_dwordx4 a[64:67], v0, s[8:11], s68 offen offset:0 sc1
    v_mfma_f32_32x32x16_bf16 v[64:79], v[112:115], a[28:31], v[64:79]
    ds_read_b128 v[128:131], v4 offset:52224
    s_waitcnt vmcnt(8) lgkmcnt(2)
    v_mfma_f32_32x32x16_bf16 v[48:63], v[116:119], a[32:35], v[48:63]
    ds_read_b128 v[112:115], v4 offset:53248
    buffer_load_dwordx4 a[68:71], v0, s[8:11], s68 offen offset:1024 sc1
    buffer_load_dwordx4 v[28:31], v0, s[8:11], s23 offen offset:0 sc1
    buffer_load_dwordx4 v[32:35], v0, s[8:11], s23 offen offset:1024 sc1
    buffer_load_dwordx4 v[36:39], v0, s[8:11], s23 offen offset:2048 sc1
    buffer_load_dwordx4 v[40:43], v0, s[8:11], s23 offen offset:3072 sc1
    v_mfma_f32_32x32x16_bf16 v[64:79], v[120:123], a[32:35], v[64:79]
    ds_read_b128 v[116:119], v4 offset:54272
    s_waitcnt vmcnt(12) lgkmcnt(2)
    v_mfma_f32_32x32x16_bf16 v[48:63], v[124:127], a[36:39], v[48:63]
    ds_read_b128 v[120:123], v4 offset:55296
    buffer_load_dwordx4 a[72:75], v0, s[8:11], s68 offen offset:2048 sc1
    v_mfma_f32_32x32x16_bf16 v[64:79], v[128:131], a[36:39], v[64:79]
    ds_read_b128 v[124:127], v4 offset:56320
    s_waitcnt vmcnt(12) lgkmcnt(2)
    v_mfma_f32_32x32x16_bf16 v[48:63], v[112:115], a[40:43], v[48:63]
    ds_read_b128 v[128:131], v4 offset:57344
    buffer_load_dwordx4 a[76:79], v0, s[8:11], s68 offen offset:3072 sc1
    v_mfma_f32_32x32x16_bf16 v[64:79], v[116:119], a[40:43], v[64:79]
    ds_read_b128 v[112:115], v4 offset:58368
    s_waitcnt vmcnt(12) lgkmcnt(2)
    v_mfma_f32_32x32x16_bf16 v[48:63], v[120:123], a[44:47], v[48:63]
    ds_read_b128 v[116:119], v4 offset:59392
    s_add_u32 s68, s20, 20480
    buffer_load_dwordx4 a[80:83], v0, s[8:11], s68 offen offset:0 sc1
    v_mfma_f32_32x32x16_bf16 v[64:79], v[124:127], a[44:47], v[64:79]
    ds_read_b128 v[120:123], v4 offset:60416
    s_barrier
    s_waitcnt vmcnt(12) lgkmcnt(2)
    v_mfma_f32_32x32x16_bf16 v[48:63], v[128:131], a[48:51], v[48:63]
    ds_read_b128 v[124:127], v4 offset:0
    buffer_load_dwordx4 a[84:87], v0, s[8:11], s68 offen offset:1024 sc1
    v_mfma_f32_32x32x16_bf16 v[64:79], v[112:115], a[48:51], v[64:79]
    ds_read_b128 v[128:131], v4 offset:1024
    s_waitcnt vmcnt(12) lgkmcnt(2)
    v_mfma_f32_32x32x16_bf16 v[48:63], v[116:119], a[52:55], v[48:63]
    ds_read_b128 v[112:115], v4 offset:2048
    buffer_load_dwordx4 a[88:91], v0, s[8:11], s68 offen offset:2048 sc1
    v_mfma_f32_32x32x16_bf16 v[64:79], v[120:123], a[52:55], v[64:79]
    ds_read_b128 v[116:119], v4 offset:3072
    ds_write_b128 v5, a[128:131] offset:32768
    s_waitcnt vmcnt(12) lgkmcnt(3)
    v_mfma_f32_32x32x16_bf16 v[48:63], v[124:127], a[56:59], v[48:63]
    ds_read_b128 v[120:123], v4 offset:4096
    buffer_load_dwordx4 a[92:95], v0, s[8:11], s68 offen offset:3072 sc1
    v_mfma_f32_32x32x16_bf16 v[64:79], v[128:131], a[56:59], v[64:79]
    ds_read_b128 v[124:127], v4 offset:5120
    s_waitcnt vmcnt(12) lgkmcnt(3)
    v_mfma_f32_32x32x16_bf16 v[48:63], v[112:115], a[60:63], v[48:63]
    ds_read_b128 v[128:131], v4 offset:6144
    s_add_u32 s68, s20, 24576
    buffer_load_dwordx4 a[96:99], v0, s[8:11], s68 offen offset:0 sc1
    v_mfma_f32_32x32x16_bf16 v[64:79], v[116:119], a[60:63], v[64:79]
    ds_read_b128 v[112:115], v4 offset:7168
    s_waitcnt vmcnt(7)
    v_add_f32 v28, v28, v30
    v_add_f32 v29, v29, v31
    v_add_f32 v28, v28, v32
    v_add_f32 v29, v29, v33
    s_waitcnt lgkmcnt(2)
    v_mfma_f32_32x32x16_bf16 v[48:63], v[120:123], a[64:67], v[48:63]
    ds_read_b128 v[116:119], v4 offset:8192
    buffer_load_dwordx4 a[100:103], v0, s[8:11], s68 offen offset:1024 sc1
    v_mfma_f32_32x32x16_bf16 v[64:79], v[124:127], a[64:67], v[64:79]
    ds_read_b128 v[120:123], v4 offset:9216
    ds_write_b128 v5, a[132:135] offset:36864
    v_add_f32 v28, v28, v34
    s_waitcnt lgkmcnt(3)
    v_mfma_f32_32x32x16_bf16 v[48:63], v[128:131], a[68:71], v[48:63]
    ds_read_b128 v[124:127], v4 offset:10240
    buffer_load_dwordx4 a[104:107], v0, s[8:11], s68 offen offset:2048 sc1
    v_mfma_f32_32x32x16_bf16 v[64:79], v[112:115], a[68:71], v[64:79]
    ds_read_b128 v[128:131], v4 offset:11264
    v_add_f32 v29, v29, v35
    v_add_f32 v28, v28, v36
    v_add_f32 v29, v29, v37
    v_add_f32 v28, v28, v38
    v_add_f32 v29, v29, v39
    s_waitcnt vmcnt(8) lgkmcnt(3)
    v_mfma_f32_32x32x16_bf16 v[48:63], v[116:119], a[72:75], v[48:63]
    ds_read_b128 v[112:115], v4 offset:12288
    buffer_load_dwordx4 a[108:111], v0, s[8:11], s68 offen offset:3072 sc1
    ds_write_b128 v5, a[136:139] offset:40960
    v_mfma_f32_32x32x16_bf16 v[64:79], v[120:123], a[72:75], v[64:79]
    ds_read_b128 v[116:119], v4 offset:13312
    ds_write_b128 v5, a[140:143] offset:45056
    v_add_f32 v28, v28, v40
    s_waitcnt vmcnt(8) lgkmcnt(4)
    v_mfma_f32_32x32x16_bf16 v[48:63], v[124:127], a[76:79], v[48:63]
    ds_read_b128 v[120:123], v4 offset:14336
    s_add_u32 s68, s20, 28672
    buffer_load_dwordx4 a[112:115], v0, s[8:11], s68 offen offset:0 sc1
    ds_write_b128 v5, a[144:147] offset:49152
    v_mfma_f32_32x32x16_bf16 v[64:79], v[128:131], a[76:79], v[64:79]
    ds_read_b128 v[124:127], v4 offset:15360
    ds_write_b128 v5, a[148:151] offset:53248
    v_add_f32 v29, v29, v41
    s_waitcnt vmcnt(8) lgkmcnt(5)
    v_mfma_f32_32x32x16_bf16 v[48:63], v[112:115], a[80:83], v[48:63]
    ds_read_b128 v[128:131], v4 offset:16384
    buffer_load_dwordx4 a[116:119], v0, s[8:11], s68 offen offset:1024 sc1
    v_mfma_f32_32x32x16_bf16 v[64:79], v[116:119], a[80:83], v[64:79]
    ds_read_b128 v[112:115], v4 offset:17408
    v_add_f32 v28, v28, v42
    v_add_f32 v29, v29, v43
    v_mov_b32 v30, v28
    v_mov_b32 v31, v29
    v_mov_b32 v18, 0
    s_waitcnt vmcnt(8) lgkmcnt(3)
    v_mfma_f32_32x32x16_bf16 v[48:63], v[120:123], a[84:87], v[48:63]
    ds_read_b128 v[116:119], v4 offset:18432
    buffer_load_dwordx4 a[120:123], v0, s[8:11], s68 offen offset:2048 sc1
    v_mfma_f32_32x32x16_bf16 v[64:79], v[124:127], a[84:87], v[64:79]
    ds_read_b128 v[120:123], v4 offset:19456
    v_mov_b32 v19, 0
    v_permlane32_swap_b32 v28, v30
    v_permlane32_swap_b32 v29, v31
    v_mov_b32 v32, 0
    v_add_f32 v28, v28, v30
    s_waitcnt vmcnt(8) lgkmcnt(2)
    v_mfma_f32_32x32x16_bf16 v[48:63], v[128:131], a[88:91], v[48:63]
    ds_read_b128 v[124:127], v4 offset:20480
    buffer_load_dwordx4 a[124:127], v0, s[8:11], s68 offen offset:3072 sc1
    v_mfma_f32_32x32x16_bf16 v[64:79], v[112:115], a[88:91], v[64:79]
    ds_read_b128 v[128:131], v4 offset:21504
    v_add_f32 v29, v29, v31
    v_mul_f32 v28, 0x3b000000, v28
    v_mul_f32 v29, 0x3b000000, v29
    v_fma_f32 v29, -v28, v28, v29
    v_cvt_pk_bf16_f32 v16, v28, v28
    s_waitcnt vmcnt(8) lgkmcnt(2)
    v_mfma_f32_32x32x16_bf16 v[48:63], v[116:119], a[92:95], v[48:63]
    ds_read_b128 v[112:115], v4 offset:22528
    v_max_f32 v29, 0, v29
    v_and_b32 v30, 0xffff0000, v16
    v_add_f32 v27, 0x3727c5ac, v29
    v_sub_f32 v30, v28, v30
    v_rsq_f32 v24, v27
    v_mfma_f32_32x32x16_bf16 v[64:79], v[120:123], a[92:95], v[64:79]
    ds_read_b128 v[116:119], v4 offset:23552
    v_cvt_pk_bf16_f32 v17, v30, v32
    v_cndmask_b32_e64 v16, v16, 0, s[32:33]
    v_cndmask_b32_e64 v17, v17, 0, s[32:33]
    v_mul_f32 v26, v24, v24
    v_mul_f32 v25, 0xc0135761, v24
    s_waitcnt vmcnt(7) lgkmcnt(2)
    v_mfma_f32_32x32x16_bf16 v[48:63], v[124:127], a[96:99], v[48:63]
    ds_read_b128 v[120:123], v4 offset:24576
    v_mul_f32 v26, v26, v24
    v_mul_f32 v26, 0xbdd2d3e8, v26
    v_mfma_f32_32x32x16_bf16 v[64:79], v[128:131], a[96:99], v[64:79]
    ds_read_b128 v[124:127], v4 offset:25600
    s_waitcnt vmcnt(6) lgkmcnt(2)
    v_mfma_f32_32x32x16_bf16 v[48:63], v[112:115], a[100:103], v[48:63]
    ds_read_b128 v[128:131], v4 offset:26624
    v_mfma_f32_32x32x16_bf16 v[64:79], v[116:119], a[100:103], v[64:79]
    ds_read_b128 v[112:115], v4 offset:27648
    s_barrier
    s_waitcnt vmcnt(5) lgkmcnt(2)
    v_mfma_f32_32x32x16_bf16 v[48:63], v[120:123], a[104:107], v[48:63]
    ds_read_b128 v[116:119], v4 offset:28672
    v_mfma_f32_32x32x16_bf16 v[64:79], v[124:127], a[104:107], v[64:79]
    ds_read_b128 v[120:123], v4 offset:29696
    s_waitcnt vmcnt(4) lgkmcnt(2)
    v_mfma_f32_32x32x16_bf16 v[48:63], v[128:131], a[108:111], v[48:63]
    ds_read_b128 v[124:127], v4 offset:30720
    ds_write_b128 v5, a[152:155] offset:57344
    v_mfma_f32_32x32x16_bf16 v[64:79], v[112:115], a[108:111], v[64:79]
    ds_read_b128 v[128:131], v4 offset:31744
    s_waitcnt vmcnt(3) lgkmcnt(3)
    v_mfma_f32_32x32x16_bf16 v[48:63], v[116:119], a[112:115], v[48:63]
    ds_read_b128 v[112:115], v4 offset:32768
    v_mfma_f32_32x32x16_bf16 v[64:79], v[120:123], a[112:115], v[64:79]
    ds_read_b128 v[116:119], v4 offset:33792
    ds_write_b128 v5, a[156:159] offset:0
    s_waitcnt vmcnt(2) lgkmcnt(3)
    v_mfma_f32_32x32x16_bf16 v[48:63], v[124:127], a[116:119], v[48:63]
    ds_read_b128 v[120:123], v4 offset:34816
    v_mfma_f32_32x32x16_bf16 v[64:79], v[128:131], a[116:119], v[64:79]
    ds_read_b128 v[124:127], v4 offset:35840
    s_waitcnt vmcnt(1) lgkmcnt(3)
    v_mfma_f32_32x32x16_bf16 v[48:63], v[112:115], a[120:123], v[48:63]
    ds_read_b128 v[128:131], v4 offset:36864
    ds_write_b128 v5, a[160:163] offset:4096
    v_mfma_f32_32x32x16_bf16 v[64:79], v[116:119], a[120:123], v[64:79]
    ds_read_b128 v[112:115], v4 offset:37888
    s_waitcnt vmcnt(0) lgkmcnt(3)
    v_mfma_f32_32x32x16_bf16 v[48:63], v[120:123], a[124:127], v[48:63]
    ds_read_b128 v[116:119], v4 offset:38912
    v_mfma_f32_32x32x16_bf16 v[64:79], v[124:127], a[124:127], v[64:79]
    ds_read_b128 v[120:123], v4 offset:39936
    ds_write_b128 v5, a[164:167] offset:8192
    s_waitcnt lgkmcnt(3)
    v_mfma_f32_32x32x16_bf16 v[48:63], v[128:131], v[16:19], v[48:63]
    ds_read_b128 v[124:127], v4 offset:40960
    ds_write_b128 v5, a[168:171] offset:12288
    v_mfma_f32_32x32x16_bf16 v[64:79], v[112:115], v[16:19], v[64:79]
    ds_read_b128 v[128:131], v4 offset:41984
    ds_write_b128 v5, a[172:175] offset:16384
    s_waitcnt lgkmcnt(5)
    v_mfma_f32_32x32x16_bf16 v[80:95], v[116:119], a[0:3], 0
    ds_read_b128 v[112:115], v4 offset:43008
    s_cmp_eq_u32 s27, 0
    s_cbranch_scc1 ob270
or271:
    ds_write_b128 v5, a[176:179] offset:20480
    v_mfma_f32_32x32x16_bf16 v[80:95], v[120:123], a[4:7], v[80:95]
    ds_read_b128 v[116:119], v4 offset:44032
    v_mul_f32 v28, v48, v48
    v_mul_f32 v31, v49, v49
    v_mul_f32 v34, v50, v50
    v_mul_f32 v37, v51, v51
    v_mul_f32 v29, v48, v56
    s_waitcnt lgkmcnt(4)
    v_mfma_f32_32x32x16_bf16 v[80:95], v[124:127], a[8:11], v[80:95]
    ds_read_b128 v[120:123], v4 offset:45056
    v_mul_f32 v32, v49, v57
    v_mul_f32 v35, v50, v58
    v_mul_f32 v38, v51, v59
    v_fma_f32 v28, v28, v26, v25
    v_fma_f32 v31, v31, v26, v25
    v_mfma_f32_32x32x16_bf16 v[80:95], v[128:131], a[12:15], v[80:95]
    ds_read_b128 v[124:127], v4 offset:46080
    v_fma_f32 v34, v34, v26, v25
    v_fma_f32 v37, v37, v26, v25
    v_mul_f32 v28, v28, v48
    v_mul_f32 v31, v31, v49
    v_mul_f32 v34, v34, v50
    s_waitcnt lgkmcnt(2)
    v_mfma_f32_32x32x16_bf16 v[80:95], v[112:115], a[16:19], v[80:95]
    ds_read_b128 v[128:131], v4 offset:47104
    v_mul_f32 v37, v37, v51
    v_exp_f32 v28, v28
    v_exp_f32 v31, v31
    v_mfma_f32_32x32x16_bf16 v[80:95], v[116:119], a[20:23], v[80:95]
    ds_read_b128 v[112:115], v4 offset:48128
    v_exp_f32 v34, v34
    v_exp_f32 v37, v37
    v_fma_f32 v28, v28, v27, v27
    s_waitcnt lgkmcnt(2)
    v_mfma_f32_32x32x16_bf16 v[80:95], v[120:123], a[24:27], v[80:95]
    ds_read_b128 v[116:119], v4 offset:49152
    v_fma_f32 v31, v31, v27, v27
    v_fma_f32 v34, v34, v27, v27
    v_fma_f32 v37, v37, v27, v27
    v_rcp_f32 v28, v28
    v_mfma_f32_32x32x16_bf16 v[80:95], v[124:127], a[28:31], v[80:95]
    ds_read_b128 v[120:123], v4 offset:50176
    v_rcp_f32 v31, v31
    v_rcp_f32 v34, v34
    v_rcp_f32 v37, v37
    s_waitcnt lgkmcnt(2)
    v_mfma_f32_32x32x16_bf16 v[80:95], v[128:131], a[32:35], v[80:95]
    ds_read_b128 v[124:127], v4 offset:51200
    v_mul_f32 v48, v29, v28
    v_mul_f32 v49, v32, v31
    v_mul_f32 v50, v35, v34
    v_mul_f32 v51, v38, v37
    v_mul_f32 v28, v52, v52
    v_mfma_f32_32x32x16_bf16 v[80:95], v[112:115], a[36:39], v[80:95]
    ds_read_b128 v[128:131], v4 offset:52224
    v_mul_f32 v31, v53, v53
    v_mul_f32 v34, v54, v54
    v_mul_f32 v37, v55, v55
    v_mul_f32 v29, v52, v60
    v_mul_f32 v32, v53, v61
    s_waitcnt lgkmcnt(2)
    v_mfma_f32_32x32x16_bf16 v[80:95], v[116:119], a[40:43], v[80:95]
    ds_read_b128 v[112:115], v4 offset:53248
    v_mul_f32 v35, v54, v62
    v_mul_f32 v38, v55, v63
    v_fma_f32 v28, v28, v26, v25
    v_fma_f32 v31, v31, v26, v25
    v_fma_f32 v34, v34, v26, v25
    v_mfma_f32_32x32x16_bf16 v[80:95], v[120:123], a[44:47], v[80:95]
    ds_read_b128 v[116:119], v4 offset:54272
    v_fma_f32 v37, v37, v26, v25
    v_mul_f32 v28, v28, v52
    v_mul_f32 v31, v31, v53
    v_mul_f32 v34, v34, v54
    v_mul_f32 v37, v37, v55
    s_waitcnt lgkmcnt(2)
    v_mfma_f32_32x32x16_bf16 v[80:95], v[124:127], a[48:51], v[80:95]
    ds_read_b128 v[120:123], v4 offset:55296
    v_exp_f32 v28, v28
    v_exp_f32 v31, v31
    v_exp_f32 v34, v34
    v_mfma_f32_32x32x16_bf16 v[80:95], v[128:131], a[52:55], v[80:95]
    ds_read_b128 v[124:127], v4 offset:56320
    v_exp_f32 v37, v37
    v_fma_f32 v28, v28, v27, v27
    v_fma_f32 v31, v31, v27, v27
    v_fma_f32 v34, v34, v27, v27
    s_barrier
    s_waitcnt lgkmcnt(2)
    v_mfma_f32_32x32x16_bf16 v[80:95], v[112:115], a[56:59], v[80:95]
    ds_read_b128 v[128:131], v4 offset:57344
    v_fma_f32 v37, v37, v27, v27
    v_rcp_f32 v28, v28
    v_rcp_f32 v31, v31
    v_mfma_f32_32x32x16_bf16 v[80:95], v[116:119], a[60:63], v[80:95]
    ds_read_b128 v[112:115], v4 offset:58368
    ds_write_b128 v5, a[180:183] offset:24576
    v_rcp_f32 v34, v34
    s_waitcnt lgkmcnt(3)
    v_mfma_f32_32x32x16_bf16 v[80:95], v[120:123], a[64:67], v[80:95]
    ds_read_b128 v[116:119], v4 offset:59392
    v_rcp_f32 v37, v37
    v_mul_f32 v52, v29, v28
    v_mul_f32 v53, v32, v31
    v_mul_f32 v54, v35, v34
    v_mfma_f32_32x32x16_bf16 v[80:95], v[124:127], a[68:71], v[80:95]
    ds_read_b128 v[120:123], v4 offset:60416
    v_mul_f32 v55, v38, v37
    v_cvt_pk_bf16_f32 v40, v48, v49
    v_cvt_pk_bf16_f32 v41, v50, v51
    v_cvt_pk_bf16_f32 v42, v52, v53
    v_cvt_pk_bf16_f32 v43, v54, v55
    s_waitcnt lgkmcnt(3)
    v_mfma_f32_32x32x16_bf16 v[80:95], v[128:131], a[72:75], v[80:95]
    ds_read_b128 v[124:127], v4 offset:0
    ds_write_b128 v5, a[184:187] offset:28672
    s_add_u32 s45, s46, 0
    buffer_store_dwordx4 v[40:43], v0, s[8:11], s45 offen sc1
    v_mfma_f32_32x32x16_bf16 v[80:95], v[112:115], a[76:79], v[80:95]
    ds_read_b128 v[128:131], v4 offset:1024
    v_mul_f32 v28, v64, v64
    v_mul_f32 v31, v65, v65
    v_mul_f32 v34, v66, v66
    v_mul_f32 v37, v67, v67
    v_mul_f32 v29, v64, v72
    s_waitcnt lgkmcnt(3)
    v_mfma_f32_32x32x16_bf16 v[80:95], v[116:119], a[80:83], v[80:95]
    ds_read_b128 v[112:115], v4 offset:2048
    v_mul_f32 v32, v65, v73
    v_mul_f32 v35, v66, v74
    v_mul_f32 v38, v67, v75
    v_fma_f32 v28, v28, v26, v25
    v_fma_f32 v31, v31, v26, v25
    v_mfma_f32_32x32x16_bf16 v[80:95], v[120:123], a[84:87], v[80:95]
    ds_read_b128 v[116:119], v4 offset:3072
    ds_write_b128 v5, a[188:191] offset:32768
    v_fma_f32 v34, v34, v26, v25
    s_waitcnt lgkmcnt(3)
    v_mfma_f32_32x32x16_bf16 v[80:95], v[124:127], a[88:91], v[80:95]
    ds_read_b128 v[120:123], v4 offset:4096
    v_fma_f32 v37, v37, v26, v25
    v_mul_f32 v28, v28, v64
    v_mul_f32 v31, v31, v65
    v_mul_f32 v34, v34, v66
    v_mul_f32 v37, v37, v67
    v_mfma_f32_32x32x16_bf16 v[80:95], v[128:131], a[92:95], v[80:95]
    ds_read_b128 v[124:127], v4 offset:5120
    v_exp_f32 v28, v28
    v_exp_f32 v31, v31
    v_exp_f32 v34, v34
    s_waitcnt lgkmcnt(3)
    v_mfma_f32_32x32x16_bf16 v[80:95], v[112:115], a[96:99], v[80:95]
    ds_read_b128 v[128:131], v4 offset:6144
    ds_write_b128 v5, a[192:195] offset:36864
    v_exp_f32 v37, v37
    v_mfma_f32_32x32x16_bf16 v[80:95], v[116:119], a[100:103], v[80:95]
    ds_read_b128 v[112:115], v4 offset:7168
    v_fma_f32 v28, v28, v27, v27
    v_fma_f32 v31, v31, v27, v27
    v_fma_f32 v34, v34, v27, v27
    v_fma_f32 v37, v37, v27, v27
    v_rcp_f32 v28, v28
    s_waitcnt lgkmcnt(3)
    v_mfma_f32_32x32x16_bf16 v[80:95], v[120:123], a[104:107], v[80:95]
    ds_read_b128 v[116:119], v4 offset:8192
    ds_write_b128 v5, a[196:199] offset:40960
    v_rcp_f32 v31, v31
    v_mfma_f32_32x32x16_bf16 v[80:95], v[124:127], a[108:111], v[80:95]
    ds_read_b128 v[120:123], v4 offset:9216
    ds_write_b128 v5, a[200:203] offset:45056
    v_rcp_f32 v34, v34
    s_waitcnt lgkmcnt(4)
    v_mfma_f32_32x32x16_bf16 v[80:95], v[128:131], a[112:115], v[80:95]
    ds_read_b128 v[124:127], v4 offset:10240
    ds_write_b128 v5, a[204:207] offset:49152
    v_rcp_f32 v37, v37
    v_mfma_f32_32x32x16_bf16 v[80:95], v[112:115], a[116:119], v[80:95]
    ds_read_b128 v[128:131], v4 offset:11264
    v_mul_f32 v64, v29, v28
    v_mul_f32 v65, v32, v31
    v_mul_f32 v66, v35, v34
    v_mul_f32 v67, v38, v37
    v_mul_f32 v28, v68, v68
    s_waitcnt lgkmcnt(4)
    v_mfma_f32_32x32x16_bf16 v[80:95], v[116:119], a[120:123], v[80:95]
    ds_read_b128 v[112:115], v4 offset:12288
    s_add_u32 s58, s28, 3
    v_mov_b32 v7, s58
    s_waitcnt vmcnt(0)
    buffer_store_dword v7, off, s[8:11], s25 sc1
    v_mfma_f32_32x32x16_bf16 v[80:95], v[120:123], a[124:127], v[80:95]
    ds_read_b128 v[116:119], v4 offset:13312
    v_mul_f32 v31, v69, v69
    v_mul_f32 v34, v70, v70
    v_mul_f32 v37, v71, v71
    v_mul_f32 v29, v68, v76
    v_mul_f32 v32, v69, v77
    s_waitcnt lgkmcnt(2)
    v_mfma_f32_32x32x16_bf16 v[80:95], v[124:127], v[16:19], v[80:95]
    ds_read_b128 v[120:123], v4 offset:14336
    v_mul_f32 v35, v70, v78
    v_mul_f32 v38, v71, v79
    v_fma_f32 v28, v28, v26, v25
    v_fma_f32 v31, v31, v26, v25
    v_fma_f32 v34, v34, v26, v25
    v_mfma_f32_32x32x16_bf16 v[48:63], v[128:131], a[0:3], 0
    ds_read_b128 v[124:127], v4 offset:15360
    v_fma_f32 v37, v37, v26, v25
    v_mul_f32 v28, v28, v68
    v_mul_f32 v31, v31, v69
    v_mul_f32 v34, v34, v70
    v_mul_f32 v37, v37, v71
    s_waitcnt lgkmcnt(2)
    v_mfma_f32_32x32x16_bf16 v[48:63], v[112:115], a[4:7], v[48:63]
    ds_read_b128 v[128:131], v4 offset:16384
    s_cmp_eq_u32 s27, 0
    s_cbranch_scc1 ob272
or273:
    v_exp_f32 v28, v28
    v_exp_f32 v31, v31
    v_mfma_f32_32x32x16_bf16 v[48:63], v[116:119], a[8:11], v[48:63]
    ds_read_b128 v[112:115], v4 offset:17408
    v_exp_f32 v34, v34
    v_exp_f32 v37, v37
    v_fma_f32 v28, v28, v27, v27
    s_waitcnt lgkmcnt(2)
    v_mfma_f32_32x32x16_bf16 v[48:63], v[120:123], a[12:15], v[48:63]
    ds_read_b128 v[116:119], v4 offset:18432
    v_fma_f32 v31, v31, v27, v27
    v_fma_f32 v34, v34, v27, v27
    v_fma_f32 v37, v37, v27, v27
    v_rcp_f32 v28, v28
    v_mfma_f32_32x32x16_bf16 v[48:63], v[124:127], a[16:19], v[48:63]
    ds_read_b128 v[120:123], v4 offset:19456
    v_rcp_f32 v31, v31
    v_rcp_f32 v34, v34
    v_rcp_f32 v37, v37
    s_waitcnt lgkmcnt(2)
    v_mfma_f32_32x32x16_bf16 v[48:63], v[128:131], a[20:23], v[48:63]
    ds_read_b128 v[124:127], v4 offset:20480
    v_mul_f32 v68, v29, v28
    v_mul_f32 v69, v32, v31
    v_mul_f32 v70, v35, v34
    v_mul_f32 v71, v38, v37
    v_cvt_pk_bf16_f32 v40, v64, v65
    v_mfma_f32_32x32x16_bf16 v[48:63], v[112:115], a[24:27], v[48:63]
    ds_read_b128 v[128:131], v4 offset:21504
    v_cvt_pk_bf16_f32 v41, v66, v67
    v_cvt_pk_bf16_f32 v42, v68, v69
    v_cvt_pk_bf16_f32 v43, v70, v71
    s_add_u32 s45, s46, 16384
    buffer_store_dwordx4 v[40:43], v0, s[8:11], s45 offen sc1
    s_waitcnt lgkmcnt(2)
    v_mfma_f32_32x32x16_bf16 v[48:63], v[116:119], a[28:31], v[48:63]
    ds_read_b128 v[112:115], v4 offset:22528
    v_mul_f32 v28, v80, v80
    v_mul_f32 v31, v81, v81
    v_mul_f32 v34, v82, v82
    v_mul_f32 v37, v83, v83
    v_mul_f32 v29, v80, v88
    v_mfma_f32_32x32x16_bf16 v[48:63], v[120:123], a[32:35], v[48:63]
    ds_read_b128 v[116:119], v4 offset:23552
    v_mul_f32 v32, v81, v89
    v_mul_f32 v35, v82, v90
    v_mul_f32 v38, v83, v91
    v_fma_f32 v28, v28, v26, v25
    v_fma_f32 v31, v31, v26, v25
    s_barrier
    s_waitcnt lgkmcnt(2)
    v_mfma_f32_32x32x16_bf16 v[48:63], v[124:127], a[36:39], v[48:63]
    ds_read_b128 v[120:123], v4 offset:24576
    ds_write_b128 v5, a[208:211] offset:53248
    v_fma_f32 v34, v34, v26, v25
    v_mfma_f32_32x32x16_bf16 v[48:63], v[128:131], a[40:43], v[48:63]
    ds_read_b128 v[124:127], v4 offset:25600
    v_fma_f32 v37, v37, v26, v25
    v_mul_f32 v28, v28, v80
    v_mul_f32 v31, v31, v81
    v_mul_f32 v34, v34, v82
    v_mul_f32 v37, v37, v83
    s_waitcnt lgkmcnt(3)
    v_mfma_f32_32x32x16_bf16 v[48:63], v[112:115], a[44:47], v[48:63]
    ds_read_b128 v[128:131], v4 offset:26624
    v_exp_f32 v28, v28
    v_exp_f32 v31, v31
    v_exp_f32 v34, v34
    v_mfma_f32_32x32x16_bf16 v[48:63], v[116:119], a[48:51], v[48:63]
    ds_read_b128 v[112:115], v4 offset:27648
    ds_write_b128 v5, a[212:215] offset:57344
    v_exp_f32 v37, v37
    s_waitcnt lgkmcnt(3)
    v_mfma_f32_32x32x16_bf16 v[48:63], v[120:123], a[52:55], v[48:63]
    ds_read_b128 v[116:119], v4 offset:28672
    v_fma_f32 v28, v28, v27, v27
    v_fma_f32 v31, v31, v27, v27
    v_fma_f32 v34, v34, v27, v27
    v_fma_f32 v37, v37, v27, v27
    v_rcp_f32 v28, v28
    v_mfma_f32_32x32x16_bf16 v[48:63], v[124:127], a[56:59], v[48:63]
    ds_read_b128 v[120:123], v4 offset:29696
    v_rcp_f32 v31, v31
    v_rcp_f32 v34, v34
    v_rcp_f32 v37, v37
    s_waitcnt lgkmcnt(3)
    v_mfma_f32_32x32x16_bf16 v[48:63], v[128:131], a[60:63], v[48:63]
    ds_read_b128 v[124:127], v4 offset:30720
    ds_write_b128 v5, a[216:219] offset:0
    v_mul_f32 v80, v29, v28
    v_mfma_f32_32x32x16_bf16 v[48:63], v[112:115], a[64:67], v[48:63]
    ds_read_b128 v[128:131], v4 offset:31744
    v_mul_f32 v81, v32, v31
    v_mul_f32 v82, v35, v34
    v_mul_f32 v83, v38, v37
    v_mul_f32 v28, v84, v84
    v_mul_f32 v31, v85, v85
    s_waitcnt lgkmcnt(3)
    v_mfma_f32_32x32x16_bf16 v[48:63], v[116:119], a[68:71], v[48:63]
    ds_read_b128 v[112:115], v4 offset:32768
    v_mul_f32 v34, v86, v86
    v_mul_f32 v37, v87, v87
    v_mul_f32 v29, v84, v92
    v_mul_f32 v32, v85, v93
    v_mul_f32 v35, v86, v94
    v_mfma_f32_32x32x16_bf16 v[48:63], v[120:123], a[72:75], v[48:63]
    ds_read_b128 v[116:119], v4 offset:33792
    s_add_u32 s58, s28, 4
    v_mov_b32 v7, s58
    s_waitcnt vmcnt(0)
    buffer_store_dword v7, off, s[8:11], s25 sc1
    s_waitcnt lgkmcnt(2)
    v_mfma_f32_32x32x16_bf16 v[48:63], v[124:127], a[76:79], v[48:63]
    ds_read_b128 v[120:123], v4 offset:34816
    v_mul_f32 v38, v87, v95
    v_fma_f32 v28, v28, v26, v25
    v_fma_f32 v31, v31, v26, v25
    v_fma_f32 v34, v34, v26, v25
    v_fma_f32 v37, v37, v26, v25
    v_mfma_f32_32x32x16_bf16 v[48:63], v[128:131], a[80:83], v[48:63]
    ds_read_b128 v[124:127], v4 offset:35840
    v_mul_f32 v28, v28, v84
    v_mul_f32 v31, v31, v85
    v_mul_f32 v34, v34, v86
    v_mul_f32 v37, v37, v87
    v_exp_f32 v28, v28
    s_waitcnt lgkmcnt(2)
    v_mfma_f32_32x32x16_bf16 v[48:63], v[112:115], a[84:87], v[48:63]
    ds_read_b128 v[128:131], v4 offset:36864
    ds_write_b128 v5, a[220:223] offset:4096
    v_exp_f32 v31, v31
    v_mfma_f32_32x32x16_bf16 v[48:63], v[116:119], a[88:91], v[48:63]
    ds_read_b128 v[112:115], v4 offset:37888
    ds_write_b128 v5, a[224:227] offset:8192
    v_exp_f32 v34, v34
    s_waitcnt lgkmcnt(4)
    v_mfma_f32_32x32x16_bf16 v[48:63], v[120:123], a[92:95], v[48:63]
    ds_read_b128 v[116:119], v4 offset:38912
    ds_write_b128 v5, a[228:231] offset:12288
    v_exp_f32 v37, v37
    v_mfma_f32_32x32x16_bf16 v[48:63], v[124:127], a[96:99], v[48:63]
    ds_read_b128 v[120:123], v4 offset:39936
    ds_write_b128 v5, a[232:235] offset:16384
    v_fma_f32 v28, v28, v27, v27
    s_waitcnt lgkmcnt(5)
    v_mfma_f32_32x32x16_bf16 v[48:63], v[128:131], a[100:103], v[48:63]
    ds_read_b128 v[124:127], v4 offset:40960
    v_fma_f32 v31, v31, v27, v27
    v_fma_f32 v34, v34, v27, v27
    v_fma_f32 v37, v37, v27, v27
    v_rcp_f32 v28, v28
    v_mfma_f32_32x32x16_bf16 v[48:63], v[112:115], a[104:107], v[48:63]
    ds_read_b128 v[128:131], v4 offset:41984
    v_rcp_f32 v31, v31
    v_rcp_f32 v34, v34
    v_rcp_f32 v37, v37
    s_waitcnt lgkmcnt(3)
    v_mfma_f32_32x32x16_bf16 v[48:63], v[116:119], a[108:111], v[48:63]
    ds_read_b128 v[112:115], v4 offset:43008
    buffer_load_dword v6, v2, s[8:11], s24 offen sc1
    v_mfma_f32_32x32x16_bf16 v[48:63], v[120:123], a[112:115], v[48:63]
    ds_read_b128 v[116:119], v4 offset:44032
    v_mul_f32 v84, v29, v28
    v_mul_f32 v85, v32, v31
    v_mul_f32 v86, v35, v34
    v_mul_f32 v87, v38, v37
    v_cvt_pk_bf16_f32 v40, v80, v81
    s_waitcnt lgkmcnt(2)
    v_mfma_f32_32x32x16_bf16 v[48:63], v[124:127], a[116:119], v[48:63]
    ds_read_b128 v[120:123], v4 offset:45056
    v_cvt_pk_bf16_f32 v41, v82, v83
    v_cvt_pk_bf16_f32 v42, v84, v85
    v_cvt_pk_bf16_f32 v43, v86, v87
    s_add_u32 s45, s46, 32768
    buffer_store_dwordx4 v[40:43], v0, s[8:11], s45 offen sc1
    v_mfma_f32_32x32x16_bf16 v[48:63], v[128:131], a[120:123], v[48:63]
    ds_read_b128 v[124:127], v4 offset:46080
    s_waitcnt lgkmcnt(2)
    v_mfma_f32_32x32x16_bf16 v[48:63], v[112:115], a[124:127], v[48:63]
    ds_read_b128 v[128:131], v4 offset:47104
    v_mfma_f32_32x32x16_bf16 v[48:63], v[116:119], v[16:19], v[48:63]
    ds_read_b128 v[112:115], v4 offset:48128
    s_waitcnt lgkmcnt(2)
    v_mfma_f32_32x32x16_bf16 v[64:79], v[120:123], a[0:3], 0
    ds_read_b128 v[116:119], v4 offset:49152
    v_mfma_f32_32x32x16_bf16 v[64:79], v[124:127], a[4:7], v[64:79]
    ds_read_b128 v[120:123], v4 offset:50176
    s_waitcnt lgkmcnt(2)
    v_mfma_f32_32x32x16_bf16 v[64:79], v[128:131], a[8:11], v[64:79]
    ds_read_b128 v[124:127], v4 offset:51200
    s_nop 2
    v_mul_f32 v28, v48, v48
    v_mul_f32 v31, v49, v49
    v_mul_f32 v34, v50, v50
    v_mul_f32 v37, v51, v51
    v_mul_f32 v29, v48, v56
    v_mfma_f32_32x32x16_bf16 v[64:79], v[112:115], a[12:15], v[64:79]
    ds_read_b128 v[128:131], v4 offset:52224
    v_mul_f32 v32, v49, v57
    v_mul_f32 v35, v50, v58
    v_mul_f32 v38, v51, v59
    v_fma_f32 v28, v28, v26, v25
    v_fma_f32 v31, v31, v26, v25
    s_barrier
    s_waitcnt lgkmcnt(2)
    v_mfma_f32_32x32x16_bf16 v[64:79], v[116:119], a[16:19], v[64:79]
    ds_read_b128 v[112:115], v4 offset:53248
    v_fma_f32 v34, v34, v26, v25
    v_fma_f32 v37, v37, v26, v25
    v_mul_f32 v28, v28, v48
    v_mul_f32 v31, v31, v49
    v_mul_f32 v34, v34, v50
    v_mfma_f32_32x32x16_bf16 v[64:79], v[120:123], a[20:23], v[64:79]
    ds_read_b128 v[116:119], v4 offset:54272
    v_mul_f32 v37, v37, v51
    v_exp_f32 v28, v28
    v_exp_f32 v31, v31
    s_waitcnt lgkmcnt(2)
    v_mfma_f32_32x32x16_bf16 v[64:79], v[124:127], a[24:27], v[64:79]
    ds_read_b128 v[120:123], v4 offset:55296
    s_add_u32 s62, s28, 3
    s_waitcnt vmcnt(1)
    v_cmp_gt_u32 vcc, s62, v6
    s_cbranch_vccnz ob274
or275:
    s_add_u32 s64, s22, 0
    buffer_load_dwordx4 v[132:135], v0, s[8:11], s64 offen offset:0 sc1
    buffer_load_dwordx4 v[136:139], v0, s[8:11], s64 offen offset:1024 sc1
    buffer_load_dwordx4 v[140:143], v0, s[8:11], s64 offen offset:2048 sc1
    buffer_load_dwordx4 v[144:147], v0, s[8:11], s64 offen offset:3072 sc1
    s_add_u32 s64, s22, 4096
    buffer_load_dwordx4 v[148:151], v0, s[8:11], s64 offen offset:0 sc1
    buffer_load_dwordx4 v[152:155], v0, s[8:11], s64 offen offset:1024 sc1
    buffer_load_dwordx4 v[44:47], v0, s[8:11], s64 offen offset:2048 sc1
    buffer_load_dwordx4 v[8:11], v0, s[8:11], s64 offen offset:3072 sc1
    v_mfma_f32_32x32x16_bf16 v[64:79], v[128:131], a[28:31], v[64:79]
    ds_read_b128 v[124:127], v4 offset:56320
    v_exp_f32 v34, v34
    v_exp_f32 v37, v37
    v_fma_f32 v28, v28, v27, v27
    s_waitcnt lgkmcnt(2)
    v_mfma_f32_32x32x16_bf16 v[64:79], v[112:115], a[32:35], v[64:79]
    ds_read_b128 v[128:131], v4 offset:57344
    s_add_u32 s58, s28, 5
    v_mov_b32 v7, s58
    s_waitcnt vmcnt(8)
    buffer_store_dword v7, off, s[8:11], s25 sc1
    v_mfma_f32_32x32x16_bf16 v[64:79], v[116:119], a[36:39], v[64:79]
    ds_read_b128 v[112:115], v4 offset:58368
    ds_write_b128 v5, a[236:239] offset:20480
    v_fma_f32 v31, v31, v27, v27
    s_waitcnt lgkmcnt(3)
    v_mfma_f32_32x32x16_bf16 v[64:79], v[120:123], a[40:43], v[64:79]
    ds_read_b128 v[116:119], v4 offset:59392
    v_fma_f32 v34, v34, v27, v27
    v_fma_f32 v37, v37, v27, v27
    v_rcp_f32 v28, v28
    v_rcp_f32 v31, v31
    v_mfma_f32_32x32x16_bf16 v[64:79], v[124:127], a[44:47], v[64:79]
    ds_read_b128 v[120:123], v4 offset:60416
    v_rcp_f32 v34, v34
    v_rcp_f32 v37, v37
    v_mul_f32 v48, v29, v28
    s_waitcnt lgkmcnt(3)
    v_mfma_f32_32x32x16_bf16 v[64:79], v[128:131], a[48:51], v[64:79]
    ds_read_b128 v[124:127], v4 offset:0
    ds_write_b128 v5, a[240:243] offset:24576
    v_mul_f32 v49, v32, v31
    v_mfma_f32_32x32x16_bf16 v[64:79], v[112:115], a[52:55], v[64:79]
    ds_read_b128 v[128:131], v4 offset:1024
    v_mul_f32 v50, v35, v34
    v_mul_f32 v51, v38, v37
    v_mul_f32 v28, v52, v52
    v_mul_f32 v31, v53, v53
    v_mul_f32 v34, v54, v54
    s_waitcnt vmcnt(8) lgkmcnt(3)
    v_mfma_f32_32x32x16_bf16 v[96:111], v[116:119], v[132:135], 0
    ds_read_b128 v[112:115], v4 offset:2048
    s_add_u32 s64, s22, 8192
    buffer_load_dwordx4 v[12:15], v0, s[8:11], s64 offen offset:0 sc1
    v_mfma_f32_32x32x16_bf16 v[64:79], v[120:123], a[56:59], v[64:79]
    ds_read_b128 v[116:119], v4 offset:3072
    ds_write_b128 v5, a[244:247] offset:28672
    v_mul_f32 v37, v55, v55
    s_waitcnt vmcnt(8) lgkmcnt(3)
    v_mfma_f32_32x32x16_bf16 v[96:111], v[124:127], v[136:139], v[96:111]
    ds_read_b128 v[120:123], v4 offset:4096
    buffer_load_dwordx4 v[132:135], v0, s[8:11], s64 offen offset:1024 sc1
    ds_write_b128 v5, a[248:251] offset:32768
    v_mfma_f32_32x32x16_bf16 v[64:79], v[128:131], a[60:63], v[64:79]
    ds_read_b128 v[124:127], v4 offset:5120
    ds_write_b128 v5, a[252:255] offset:36864
    v_mul_f32 v29, v52, v60
    s_waitcnt vmcnt(8) lgkmcnt(5)
    v_mfma_f32_32x32x16_bf16 v[96:111], v[112:115], v[140:143], v[96:111]
    ds_read_b128 v[128:131], v4 offset:6144
    buffer_load_dwordx4 v[136:139], v0, s[8:11], s64 offen offset:2048 sc1
    ds_write_b128 v5, v[156:159] offset:40960
    v_mfma_f32_32x32x16_bf16 v[64:79], v[116:119], a[64:67], v[64:79]
    ds_read_b128 v[112:115], v4 offset:7168
    ds_write_b128 v5, v[160:163] offset:45056
    v_mul_f32 v32, v53, v61
    s_waitcnt vmcnt(8) lgkmcnt(5)
    v_mfma_f32_32x32x16_bf16 v[96:111], v[120:123], v[144:147], v[96:111]
    ds_read_b128 v[116:119], v4 offset:8192
    buffer_load_dwordx4 v[140:143], v0, s[8:11], s64 offen offset:3072 sc1
    buffer_load_dword v6, v2, s[8:11], s24 offen sc1
    v_mfma_f32_32x32x16_bf16 v[64:79], v[124:127], a[68:71], v[64:79]
    ds_read_b128 v[120:123], v4 offset:9216
    v_mul_f32 v35, v54, v62
    v_mul_f32 v38, v55, v63
    v_fma_f32 v28, v28, v26, v25
    v_fma_f32 v31, v31, v26, v25
    v_fma_f32 v34, v34, v26, v25
    s_waitcnt lgkmcnt(3)
    v_mfma_f32_32x32x16_bf16 v[64:79], v[128:131], a[72:75], v[64:79]
    ds_read_b128 v[124:127], v4 offset:10240
    v_fma_f32 v37, v37, v26, v25
    v_mul_f32 v28, v28, v52
    v_mul_f32 v31, v31, v53
    v_mul_f32 v34, v34, v54
    v_mul_f32 v37, v37, v55
    s_waitcnt vmcnt(9)
    v_mfma_f32_32x32x16_bf16 v[96:111], v[112:115], v[148:151], v[96:111]
    ds_read_b128 v[128:131], v4 offset:11264
    s_add_u32 s64, s22, 12288
    buffer_load_dwordx4 v[144:147], v0, s[8:11], s64 offen offset:0 sc1
    s_waitcnt lgkmcnt(2)
    v_mfma_f32_32x32x16_bf16 v[64:79], v[116:119], a[76:79], v[64:79]
    ds_read_b128 v[112:115], v4 offset:12288
    v_exp_f32 v28, v28
    v_exp_f32 v31, v31
    v_exp_f32 v34, v34
    s_waitcnt vmcnt(9)
    v_mfma_f32_32x32x16_bf16 v[96:111], v[120:123], v[152:155], v[96:111]
    ds_read_b128 v[116:119], v4 offset:13312
    buffer_load_dwordx4 v[148:151], v0, s[8:11], s64 offen offset:1024 sc1
    s_waitcnt lgkmcnt(2)
    v_mfma_f32_32x32x16_bf16 v[64:79], v[124:127], a[80:83], v[64:79]
    ds_read_b128 v[120:123], v4 offset:14336
    v_exp_f32 v37, v37
    v_fma_f32 v28, v28, v27, v27
    v_fma_f32 v31, v31, v27, v27
    v_fma_f32 v34, v34, v27, v27
    s_waitcnt vmcnt(9)
    v_mfma_f32_32x32x16_bf16 v[96:111], v[128:131], v[44:47], v[96:111]
    ds_read_b128 v[124:127], v4 offset:15360
    buffer_load_dwordx4 v[152:155], v0, s[8:11], s64 offen offset:2048 sc1
    s_waitcnt lgkmcnt(2)
    v_mfma_f32_32x32x16_bf16 v[64:79], v[112:115], a[84:87], v[64:79]
    ds_read_b128 v[128:131], v4 offset:16384
    v_fma_f32 v37, v37, v27, v27
    v_rcp_f32 v28, v28
    v_rcp_f32 v31, v31
    v_mfma_f32_32x32x16_bf16 v[64:79], v[116:119], a[88:91], v[64:79]
    ds_read_b128 v[112:115], v4 offset:17408
    v_rcp_f32 v34, v34
    v_rcp_f32 v37, v37
    v_mul_f32 v52, v29, v28
    s_waitcnt vmcnt(9) lgkmcnt(2)
    v_mfma_f32_32x32x16_bf16 v[96:111], v[120:123], v[8:11], v[96:111]
    ds_read_b128 v[116:119], v4 offset:18432
    buffer_load_dwordx4 v[44:47], v0, s[8:11], s64 offen offset:3072 sc1
    v_mfma_f32_32x32x16_bf16 v[64:79], v[124:127], a[92:95], v[64:79]
    ds_read_b128 v[120:123], v4 offset:19456
    v_mul_f32 v53, v32, v31
    v_mul_f32 v54, v35, v34
    v_mul_f32 v55, v38, v37
    v_cvt_pk_bf16_f32 v40, v48, v49
    v_cvt_pk_bf16_f32 v41, v50, v51
    s_barrier
    s_waitcnt vmcnt(8) lgkmcnt(2)
    v_mfma_f32_32x32x16_bf16 v[96:111], v[128:131], v[12:15], v[96:111]
    ds_read_b128 v[124:127], v4 offset:20480
    s_add_u32 s62, s28, 4
    s_waitcnt vmcnt(4)
    v_cmp_gt_u32 vcc, s62, v6
    s_cbranch_vccnz ob276
or277:
    s_add_u32 s64, s22, 16384
    buffer_load_dwordx4 v[8:11], v0, s[8:11], s64 offen offset:0 sc1
    v_mfma_f32_32x32x16_bf16 v[64:79], v[112:115], a[96:99], v[64:79]
    ds_read_b128 v[128:131], v4 offset:21504
    ds_write_b128 v5, v[164:167] offset:49152
    v_cvt_pk_bf16_f32 v42, v52, v53
    s_waitcnt lgkmcnt(3)
    v_mfma_f32_32x32x16_bf16 v[96:111], v[116:119], v[132:135], v[96:111]
    ds_read_b128 v[112:115], v4 offset:22528
    buffer_load_dwordx4 v[12:15], v0, s[8:11], s64 offen offset:1024 sc1
    v_mfma_f32_32x32x16_bf16 v[64:79], v[120:123], a[100:103], v[64:79]
    ds_read_b128 v[116:119], v4 offset:23552
    v_cvt_pk_bf16_f32 v43, v54, v55
    s_add_u32 s45, s46, 49152
    buffer_store_dwordx4 v[40:43], v0, s[8:11], s45 offen sc1
    s_waitcnt lgkmcnt(3)
    v_mfma_f32_32x32x16_bf16 v[64:79], v[124:127], a[104:107], v[64:79]
    ds_read_b128 v[120:123], v4 offset:24576
    ds_write_b128 v5, v[168:171] offset:53248
    v_mfma_f32_32x32x16_bf16 v[96:111], v[128:131], v[136:139], v[96:111]
    ds_read_b128 v[124:127], v4 offset:25600
    buffer_load_dwordx4 v[132:135], v0, s[8:11], s64 offen offset:2048 sc1
    s_waitcnt lgkmcnt(3)
    v_mfma_f32_32x32x16_bf16 v[64:79], v[112:115], a[108:111], v[64:79]
    ds_read_b128 v[128:131], v4 offset:26624
    v_mfma_f32_32x32x16_bf16 v[96:111], v[116:119], v[140:143], v[96:111]
    ds_read_b128 v[112:115], v4 offset:27648
    buffer_load_dwordx4 v[136:139], v0, s[8:11], s64 offen offset:3072 sc1
    s_waitcnt lgkmcnt(2)
    v_mfma_f32_32x32x16_bf16 v[64:79], v[120:123], a[112:115], v[64:79]
    ds_read_b128 v[116:119], v4 offset:28672
    s_waitcnt vmcnt(8)
    v_mfma_f32_32x32x16_bf16 v[96:111], v[124:127], v[144:147], v[96:111]
    ds_read_b128 v[120:123], v4 offset:29696
    s_add_u32 s64, s22, 20480
    buffer_load_dwordx4 v[140:143], v0, s[8:11], s64 offen offset:0 sc1
    s_waitcnt lgkmcnt(2)
    v_mfma_f32_32x32x16_bf16 v[64:79], v[128:131], a[116:119], v[64:79]
    ds_read_b128 v[124:127], v4 offset:30720
    ds_write_b128 v5, v[172:175] offset:57344
    s_waitcnt vmcnt(8)
    v_mfma_f32_32x32x16_bf16 v[96:111], v[112:115], v[148:151], v[96:111]
    ds_read_b128 v[128:131], v4 offset:31744
    buffer_load_dwordx4 v[144:147], v0, s[8:11], s64 offen offset:1024 sc1
    s_waitcnt lgkmcnt(3)
    v_mfma_f32_32x32x16_bf16 v[64:79], v[116:119], a[120:123], v[64:79]
    ds_read_b128 v[112:115], v4 offset:32768
    ds_write_b128 v5, v[176:179] offset:0
    v_mfma_f32_32x32x16_bf16 v[64:79], v[120:123], a[124:127], v[64:79]
    ds_read_b128 v[116:119], v4 offset:33792
    ds_write_b128 v5, v[180:183] offset:4096
    s_waitcnt vmcnt(8) lgkmcnt(4)
    v_mfma_f32_32x32x16_bf16 v[96:111], v[124:127], v[152:155], v[96:111]
    ds_read_b128 v[120:123], v4 offset:34816
    buffer_load_dwordx4 v[148:151], v0, s[8:11], s64 offen offset:2048 sc1
    ds_write_b128 v5, v[184:187] offset:8192
    v_mfma_f32_32x32x16_bf16 v[64:79], v[128:131], v[16:19], v[64:79]
    ds_read_b128 v[124:127], v4 offset:35840
    s_add_u32 s58, s28, 6
    v_mov_b32 v7, s58
    s_waitcnt vmcnt(5)
    buffer_store_dword v7, off, s[8:11], s25 sc1
    s_waitcnt lgkmcnt(4)
    v_mfma_f32_32x32x16_bf16 v[96:111], v[112:115], v[44:47], v[96:111]
    ds_read_b128 v[128:131], v4 offset:36864
    buffer_load_dwordx4 v[152:155], v0, s[8:11], s64 offen offset:3072 sc1
    ds_write_b128 v5, v[188:191] offset:12288
    v_mfma_f32_32x32x16_bf16 v[80:95], v[116:119], a[0:3], 0
    ds_read_b128 v[112:115], v4 offset:37888
    s_waitcnt lgkmcnt(3)
    v_mfma_f32_32x32x16_bf16 v[96:111], v[120:123], v[8:11], v[96:111]
    ds_read_b128 v[116:119], v4 offset:38912
    s_add_u32 s64, s22, 24576
    buffer_load_dwordx4 v[44:47], v0, s[8:11], s64 offen offset:0 sc1
    v_mfma_f32_32x32x16_bf16 v[80:95], v[124:127], a[4:7], v[80:95]
    ds_read_b128 v[120:123], v4 offset:39936
    v_mul_f32 v28, v64, v64
    v_mul_f32 v31, v65, v65
    v_mul_f32 v34, v66, v66
    v_mul_f32 v37, v67, v67
    v_mul_f32 v29, v64, v72
    s_waitcnt lgkmcnt(2)
    v_mfma_f32_32x32x16_bf16 v[80:95], v[128:131], a[8:11], v[80:95]
    ds_read_b128 v[124:127], v4 offset:40960
    v_mul_f32 v32, v65, v73
    v_mul_f32 v35, v66, v74
    v_mul_f32 v38, v67, v75
    v_fma_f32 v28, v28, v26, v25
    v_fma_f32 v31, v31, v26, v25
    v_mfma_f32_32x32x16_bf16 v[96:111], v[112:115], v[12:15], v[96:111]
    ds_read_b128 v[128:131], v4 offset:41984
    buffer_load_dwordx4 v[8:11], v0, s[8:11], s64 offen offset:1024 sc1
    s_waitcnt lgkmcnt(2)
    v_mfma_f32_32x32x16_bf16 v[80:95], v[116:119], a[12:15], v[80:95]
    ds_read_b128 v[112:115], v4 offset:43008
    v_fma_f32 v34, v34, v26, v25
    v_fma_f32 v37, v37, v26, v25
    v_mul_f32 v28, v28, v64
    v_mul_f32 v31, v31, v65
    v_mul_f32 v34, v34, v66
    s_waitcnt vmcnt(8)
    v_mfma_f32_32x32x16_bf16 v[96:111], v[120:123], v[132:135], v[96:111]
    ds_read_b128 v[116:119], v4 offset:44032
    buffer_load_dwordx4 v[12:15], v0, s[8:11], s64 offen offset:2048 sc1
    s_waitcnt lgkmcnt(2)
    v_mfma_f32_32x32x16_bf16 v[80:95], v[124:127], a[16:19], v[80:95]
    ds_read_b128 v[120:123], v4 offset:45056
    v_mul_f32 v37, v37, v67
    v_exp_f32 v28, v28
    v_exp_f32 v31, v31
    s_waitcnt vmcnt(8)
    v_mfma_f32_32x32x16_bf16 v[96:111], v[128:131], v[136:139], v[96:111]
    ds_read_b128 v[124:127], v4 offset:46080
    buffer_load_dwordx4 v[132:135], v0, s[8:11], s64 offen offset:3072 sc1
    buffer_load_dword v6, v2, s[8:11], s24 offen sc1
    s_waitcnt lgkmcnt(2)
    v_mfma_f32_32x32x16_bf16 v[80:95], v[112:115], a[20:23], v[80:95]
    ds_read_b128 v[128:131], v4 offset:47104
    v_exp_f32 v34, v34
    v_exp_f32 v37, v37
    v_fma_f32 v28, v28, v27, v27
    v_mfma_f32_32x32x16_bf16 v[80:95], v[116:119], a[24:27], v[80:95]
    ds_read_b128 v[112:115], v4 offset:48128
    v_fma_f32 v31, v31, v27, v27
    v_fma_f32 v34, v34, v27, v27
    v_fma_f32 v37, v37, v27, v27
    v_rcp_f32 v28, v28
    s_barrier
    s_waitcnt vmcnt(9) lgkmcnt(2)
    v_mfma_f32_32x32x16_bf16 v[96:111], v[120:123], v[140:143], v[96:111]
    ds_read_b128 v[116:119], v4 offset:49152
    s_add_u32 s64, s22, 28672
    buffer_load_dwordx4 v[136:139], v0, s[8:11], s64 offen offset:0 sc1
    v_mfma_f32_32x32x16_bf16 v[80:95], v[124:127], a[28:31], v[80:95]
    ds_read_b128 v[120:123], v4 offset:50176
    v_rcp_f32 v31, v31
    v_rcp_f32 v34, v34
    v_rcp_f32 v37, v37
    s_waitcnt vmcnt(9) lgkmcnt(2)
    v_mfma_f32_32x32x16_bf16 v[96:111], v[128:131], v[144:147], v[96:111]
    ds_read_b128 v[124:127], v4 offset:51200
    buffer_load_dwordx4 v[140:143], v0, s[8:11], s64 offen offset:1024 sc1
    v_mfma_f32_32x32x16_bf16 v[80:95], v[112:115], a[32:35], v[80:95]
    ds_read_b128 v[128:131], v4 offset:52224
    ds_write_b128 v5, v[192:195] offset:16384
    v_mul_f32 v64, v29, v28
    s_waitcnt vmcnt(9) lgkmcnt(3)
    v_mfma_f32_32x32x16_bf16 v[96:111], v[116:119], v[148:151], v[96:111]
    ds_read_b128 v[112:115], v4 offset:53248
    buffer_load_dwordx4 v[144:147], v0, s[8:11], s64 offen offset:2048 sc1
    v_mfma_f32_32x32x16_bf16 v[80:95], v[120:123], a[36:39], v[80:95]
    ds_read_b128 v[116:119], v4 offset:54272
    v_mul_f32 v65, v32, v31
    v_mul_f32 v66, v35, v34
    v_mul_f32 v67, v38, v37
    v_mul_f32 v28, v68, v68
    v_mul_f32 v31, v69, v69
    s_waitcnt vmcnt(8) lgkmcnt(3)
    v_mfma_f32_32x32x16_bf16 v[96:111], v[124:127], v[152:155], v[96:111]
    ds_read_b128 v[120:123], v4 offset:55296
    buffer_load_dwordx4 v[148:151], v0, s[8:11], s64 offen offset:3072 sc1
    v_mfma_f32_32x32x16_bf16 v[80:95], v[128:131], a[40:43], v[80:95]
    ds_read_b128 v[124:127], v4 offset:56320
    v_mul_f32 v34, v70, v70
    v_mul_f32 v37, v71, v71
    v_mul_f32 v29, v68, v76
    v_mul_f32 v32, v69, v77
    v_mul_f32 v35, v70, v78
    s_waitcnt lgkmcnt(2)
    v_mfma_f32_32x32x16_bf16 v[80:95], v[112:115], a[44:47], v[80:95]
    ds_read_b128 v[128:131], v4 offset:57344
    v_mul_f32 v38, v71, v79
    v_fma_f32 v28, v28, v26, v25
    v_fma_f32 v31, v31, v26, v25
    v_fma_f32 v34, v34, v26, v25
    v_fma_f32 v37, v37, v26, v25
    s_waitcnt vmcnt(8)
    v_mfma_f32_32x32x16_bf16 v[96:111], v[116:119], v[44:47], v[96:111]
    ds_read_b128 v[112:115], v4 offset:58368
    s_add_u32 s62, s28, 5
    s_waitcnt vmcnt(4)
    v_cmp_gt_u32 vcc, s62, v6
    s_cbranch_vccnz ob278
or279:
    s_add_u32 s64, s22, 32768
    buffer_load_dwordx4 v[152:155], v0, s[8:11], s64 offen offset:0 sc1
    s_waitcnt lgkmcnt(2)
    v_mfma_f32_32x32x16_bf16 v[80:95], v[120:123], a[48:51], v[80:95]
    ds_read_b128 v[116:119], v4 offset:59392
    v_mul_f32 v28, v28, v68
    v_mul_f32 v31, v31, v69
    v_mul_f32 v34, v34, v70
    v_mul_f32 v37, v37, v71
    v_exp_f32 v28, v28
    v_mfma_f32_32x32x16_bf16 v[96:111], v[124:127], v[8:11], v[96:111]
    ds_read_b128 v[120:123], v4 offset:60416
    buffer_load_dwordx4 v[44:47], v0, s[8:11], s64 offen offset:1024 sc1
    s_waitcnt lgkmcnt(2)
    v_mfma_f32_32x32x16_bf16 v[80:95], v[128:131], a[52:55], v[80:95]
    ds_read_b128 v[124:127], v4 offset:0
    ds_write_b128 v5, v[196:199] offset:20480
    v_exp_f32 v31, v31
    v_mfma_f32_32x32x16_bf16 v[96:111], v[112:115], v[12:15], v[96:111]
    ds_read_b128 v[128:131], v4 offset:1024
    buffer_load_dwordx4 v[8:11], v0, s[8:11], s64 offen offset:2048 sc1
    ds_write_b128 v5, v[200:203] offset:24576
    s_waitcnt lgkmcnt(4)
    v_mfma_f32_32x32x16_bf16 v[80:95], v[116:119], a[56:59], v[80:95]
    ds_read_b128 v[112:115], v4 offset:2048
    ds_write_b128 v5, v[204:207] offset:28672
    v_exp_f32 v34, v34
    v_mfma_f32_32x32x16_bf16 v[80:95], v[120:123], a[60:63], v[80:95]
    ds_read_b128 v[116:119], v4 offset:3072
    ds_write_b128 v5, v[208:211] offset:32768
    v_exp_f32 v37, v37
    s_waitcnt lgkmcnt(5)
    v_mfma_f32_32x32x16_bf16 v[96:111], v[124:127], v[132:135], v[96:111]
    ds_read_b128 v[120:123], v4 offset:4096
    buffer_load_dwordx4 v[12:15], v0, s[8:11], s64 offen offset:3072 sc1
    ds_write_b128 v5, v[212:215] offset:36864
    v_mfma_f32_32x32x16_bf16 v[80:95], v[128:131], a[64:67], v[80:95]
    ds_read_b128 v[124:127], v4 offset:5120
    ds_write_b128 v5, v[216:219] offset:40960
    v_fma_f32 v28, v28, v27, v27
    s_waitcnt vmcnt(7) lgkmcnt(5)
    v_mfma_f32_32x32x16_bf16 v[96:111], v[112:115], v[136:139], v[96:111]
    ds_read_b128 v[128:131], v4 offset:6144
    s_add_u32 s64, s22, 36864
    buffer_load_dwordx4 v[132:135], v0, s[8:11], s64 offen offset:0 sc1
    v_mfma_f32_32x32x16_bf16 v[80:95], v[116:119], a[68:71], v[80:95]
    ds_read_b128 v[112:115], v4 offset:7168
    v_fma_f32 v31, v31, v27, v27
    v_fma_f32 v34, v34, v27, v27
    v_fma_f32 v37, v37, v27, v27
    v_rcp_f32 v28, v28
    s_waitcnt vmcnt(7) lgkmcnt(3)
    v_mfma_f32_32x32x16_bf16 v[96:111], v[120:123], v[140:143], v[96:111]
    ds_read_b128 v[116:119], v4 offset:8192
    buffer_load_dwordx4 v[136:139], v0, s[8:11], s64 offen offset:1024 sc1
    v_mfma_f32_32x32x16_bf16 v[80:95], v[124:127], a[72:75], v[80:95]
    ds_read_b128 v[120:123], v4 offset:9216
    v_rcp_f32 v31, v31
    v_rcp_f32 v34, v34
    v_rcp_f32 v37, v37
    s_waitcnt lgkmcnt(2)
    v_mfma_f32_32x32x16_bf16 v[80:95], v[128:131], a[76:79], v[80:95]
    ds_read_b128 v[124:127], v4 offset:10240
    v_mul_f32 v68, v29, v28
    v_mul_f32 v69, v32, v31
    v_mul_f32 v70, v35, v34
    v_mul_f32 v71, v38, v37
    v_cvt_pk_bf16_f32 v40, v64, v65
    s_waitcnt vmcnt(7)
    v_mfma_f32_32x32x16_bf16 v[96:111], v[112:115], v[144:147], v[96:111]
    ds_read_b128 v[128:131], v4 offset:11264
    buffer_load_dwordx4 v[140:143], v0, s[8:11], s64 offen offset:2048 sc1
    s_waitcnt lgkmcnt(2)
    v_mfma_f32_32x32x16_bf16 v[80:95], v[116:119], a[80:83], v[80:95]
    ds_read_b128 v[112:115], v4 offset:12288
    v_cvt_pk_bf16_f32 v41, v66, v67
    v_cvt_pk_bf16_f32 v42, v68, v69
    v_cvt_pk_bf16_f32 v43, v70, v71
    s_add_u32 s45, s46, 65536
    buffer_store_dwordx4 v[40:43], v0, s[8:11], s45 offen sc1
    s_waitcnt vmcnt(8)
    v_mfma_f32_32x32x16_bf16 v[96:111], v[120:123], v[148:151], v[96:111]
    ds_read_b128 v[116:119], v4 offset:13312
    buffer_load_dwordx4 v[144:147], v0, s[8:11], s64 offen offset:3072 sc1
    s_waitcnt lgkmcnt(2)
    v_mfma_f32_32x32x16_bf16 v[80:95], v[124:127], a[84:87], v[80:95]
    ds_read_b128 v[120:123], v4 offset:14336
    s_waitcnt vmcnt(8)
    v_mfma_f32_32x32x16_bf16 v[96:111], v[128:131], v[152:155], v[96:111]
    ds_read_b128 v[124:127], v4 offset:15360
    s_add_u32 s64, s22, 40960
    buffer_load_dwordx4 v[148:151], v0, s[8:11], s64 offen offset:0 sc1
    s_barrier
    s_waitcnt lgkmcnt(2)
    v_mfma_f32_32x32x16_bf16 v[80:95], v[112:115], a[88:91], v[80:95]
    ds_read_b128 v[128:131], v4 offset:16384
    s_waitcnt vmcnt(8)
    v_mfma_f32_32x32x16_bf16 v[96:111], v[116:119], v[44:47], v[96:111]
    ds_read_b128 v[112:115], v4 offset:17408
    buffer_load_dwordx4 v[152:155], v0, s[8:11], s64 offen offset:1024 sc1
    s_waitcnt lgkmcnt(2)
    v_mfma_f32_32x32x16_bf16 v[80:95], v[120:123], a[92:95], v[80:95]
    ds_read_b128 v[116:119], v4 offset:18432
    ds_write_b128 v5, v[220:223] offset:45056
    v_mfma_f32_32x32x16_bf16 v[80:95], v[124:127], a[96:99], v[80:95]
    ds_read_b128 v[120:123], v4 offset:19456
    s_waitcnt vmcnt(8) lgkmcnt(3)
    v_mfma_f32_32x32x16_bf16 v[96:111], v[128:131], v[8:11], v[96:111]
    ds_read_b128 v[124:127], v4 offset:20480
    buffer_load_dwordx4 v[44:47], v0, s[8:11], s64 offen offset:2048 sc1
    v_mfma_f32_32x32x16_bf16 v[80:95], v[112:115], a[100:103], v[80:95]
    ds_read_b128 v[128:131], v4 offset:21504
    ds_write_b128 v5, v[224:227] offset:49152
    s_waitcnt vmcnt(8) lgkmcnt(3)
    v_mfma_f32_32x32x16_bf16 v[96:111], v[116:119], v[12:15], v[96:111]
    ds_read_b128 v[112:115], v4 offset:22528
    buffer_load_dwordx4 v[8:11], v0, s[8:11], s64 offen offset:3072 sc1
    buffer_load_dword v6, v2, s[8:11], s24 offen sc1
    v_mfma_f32_32x32x16_bf16 v[80:95], v[120:123], a[104:107], v[80:95]
    ds_read_b128 v[116:119], v4 offset:23552
    s_waitcnt vmcnt(9) lgkmcnt(3)
    v_mfma_f32_32x32x16_bf16 v[96:111], v[124:127], v[132:135], v[96:111]
    ds_read_b128 v[120:123], v4 offset:24576
    s_add_u32 s64, s22, 45056
    buffer_load_dwordx4 v[12:15], v0, s[8:11], s64 offen offset:0 sc1
    v_mfma_f32_32x32x16_bf16 v[80:95], v[128:131], a[108:111], v[80:95]
    ds_read_b128 v[124:127], v4 offset:25600
    s_add_u32 s58, s28, 7
    v_mov_b32 v7, s58
    s_waitcnt vmcnt(7)
    buffer_store_dword v7, off, s[8:11], s25 sc1
    s_waitcnt lgkmcnt(2)
    v_mfma_f32_32x32x16_bf16 v[80:95], v[112:115], a[112:115], v[80:95]
    ds_read_b128 v[128:131], v4 offset:26624
    v_mfma_f32_32x32x16_bf16 v[96:111], v[116:119], v[136:139], v[96:111]
    ds_read_b128 v[112:115], v4 offset:27648
    buffer_load_dwordx4 v[132:135], v0, s[8:11], s64 offen offset:1024 sc1
    s_waitcnt lgkmcnt(2)
    v_mfma_f32_32x32x16_bf16 v[80:95], v[120:123], a[116:119], v[80:95]
    ds_read_b128 v[116:119], v4 offset:28672
    ds_write_b128 v5, v[228:231] offset:53248
    v_mfma_f32_32x32x16_bf16 v[96:111], v[124:127], v[140:143], v[96:111]
    ds_read_b128 v[120:123], v4 offset:29696
    buffer_load_dwordx4 v[136:139], v0, s[8:11], s64 offen offset:2048 sc1
    ds_write_b128 v5, v[232:235] offset:57344
    s_waitcnt lgkmcnt(4)
    v_mfma_f32_32x32x16_bf16 v[80:95], v[128:131], a[120:123], v[80:95]
    ds_read_b128 v[124:127], v4 offset:30720
    ds_write_b128 v5, v[236:239] offset:0
    s_waitcnt vmcnt(9)
    v_mfma_f32_32x32x16_bf16 v[96:111], v[112:115], v[144:147], v[96:111]
    ds_read_b128 v[128:131], v4 offset:31744
    buffer_load_dwordx4 v[140:143], v0, s[8:11], s64 offen offset:3072 sc1
    ds_write_b128 v5, v[240:243] offset:4096
    s_waitcnt lgkmcnt(5)
    v_mfma_f32_32x32x16_bf16 v[80:95], v[116:119], a[124:127], v[80:95]
    ds_read_b128 v[112:115], v4 offset:32768
    ds_write_b128 v5, v[244:247] offset:8192
    v_mfma_f32_32x32x16_bf16 v[80:95], v[120:123], v[16:19], v[80:95]
    ds_read_b128 v[116:119], v4 offset:33792
    s_waitcnt vmcnt(9) lgkmcnt(4)
    v_mfma_f32_32x32x16_bf16 v[96:111], v[124:127], v[148:151], v[96:111]
    ds_read_b128 v[120:123], v4 offset:34816
    s_add_u32 s62, s28, 6
    s_waitcnt vmcnt(5)
    v_cmp_gt_u32 vcc, s62, v6
    s_cbranch_vccnz ob280
or281:
    s_add_u32 s64, s22, 49152
    buffer_load_dwordx4 v[144:147], v0, s[8:11], s64 offen offset:0 sc1
    v_mfma_f32_32x32x16_bf16 v[96:111], v[128:131], v[152:155], v[96:111]
    ds_read_b128 v[124:127], v4 offset:35840
    buffer_load_dwordx4 v[148:151], v0, s[8:11], s64 offen offset:1024 sc1
    s_waitcnt lgkmcnt(2)
    v_mfma_f32_32x32x16_bf16 v[96:111], v[112:115], v[44:47], v[96:111]
    ds_read_b128 v[128:131], v4 offset:36864
    buffer_load_dwordx4 v[152:155], v0, s[8:11], s64 offen offset:2048 sc1
    v_mfma_f32_32x32x16_bf16 v[96:111], v[116:119], v[8:11], v[96:111]
    ds_read_b128 v[112:115], v4 offset:37888
    buffer_load_dwordx4 v[44:47], v0, s[8:11], s64 offen offset:3072 sc1
    s_waitcnt vmcnt(8) lgkmcnt(2)
    v_mfma_f32_32x32x16_bf16 v[96:111], v[120:123], v[12:15], v[96:111]
    ds_read_b128 v[116:119], v4 offset:38912
    s_add_u32 s64, s22, 53248
    buffer_load_dwordx4 v[8:11], v0, s[8:11], s64 offen offset:0 sc1
    buffer_load_dword v6, v2, s[8:11], s24 offen sc1
    s_waitcnt vmcnt(8)
    v_mfma_f32_32x32x16_bf16 v[96:111], v[124:127], v[132:135], v[96:111]
    ds_read_b128 v[120:123], v4 offset:39936
    buffer_load_dwordx4 v[12:15], v0, s[8:11], s64 offen offset:1024 sc1
    s_waitcnt vmcnt(8) lgkmcnt(2)
    v_mfma_f32_32x32x16_bf16 v[96:111], v[128:131], v[136:139], v[96:111]
    ds_read_b128 v[124:127], v4 offset:40960
    buffer_load_dwordx4 v[132:135], v0, s[8:11], s64 offen offset:2048 sc1
    s_waitcnt vmcnt(8)
    v_mfma_f32_32x32x16_bf16 v[96:111], v[112:115], v[140:143], v[96:111]
    ds_read_b128 v[128:131], v4 offset:41984
    buffer_load_dwordx4 v[136:139], v0, s[8:11], s64 offen offset:3072 sc1
    s_waitcnt vmcnt(8) lgkmcnt(2)
    v_mfma_f32_32x32x16_bf16 v[96:111], v[116:119], v[144:147], v[96:111]
    ds_read_b128 v[112:115], v4 offset:43008
    s_add_u32 s64, s22, 57344
    buffer_load_dwordx4 v[140:143], v0, s[8:11], s64 offen offset:0 sc1
    s_waitcnt vmcnt(8)
    v_mfma_f32_32x32x16_bf16 v[96:111], v[120:123], v[148:151], v[96:111]
    ds_read_b128 v[116:119], v4 offset:44032
    buffer_load_dwordx4 v[144:147], v0, s[8:11], s64 offen offset:1024 sc1
    s_barrier
    s_waitcnt vmcnt(8) lgkmcnt(2)
    v_mfma_f32_32x32x16_bf16 v[96:111], v[124:127], v[152:155], v[96:111]
    ds_read_b128 v[120:123], v4 offset:45056
    buffer_load_dwordx4 v[148:151], v0, s[8:11], s64 offen offset:2048 sc1
    s_waitcnt vmcnt(8)
    v_mfma_f32_32x32x16_bf16 v[96:111], v[128:131], v[44:47], v[96:111]
    ds_read_b128 v[124:127], v4 offset:46080
    buffer_load_dwordx4 v[152:155], v0, s[8:11], s64 offen offset:3072 sc1
    s_waitcnt vmcnt(8) lgkmcnt(2)
    v_mfma_f32_32x32x16_bf16 v[96:111], v[112:115], v[8:11], v[96:111]
    ds_read_b128 v[128:131], v4 offset:47104
    s_add_u32 s64, s22, 61440
    buffer_load_dwordx4 v[44:47], v0, s[8:11], s64 offen offset:0 sc1
    s_waitcnt vmcnt(7)
    v_mfma_f32_32x32x16_bf16 v[96:111], v[116:119], v[12:15], v[96:111]
    ds_read_b128 v[112:115], v4 offset:48128
    buffer_load_dwordx4 v[8:11], v0, s[8:11], s64 offen offset:1024 sc1
    s_waitcnt vmcnt(7) lgkmcnt(2)
    v_mfma_f32_32x32x16_bf16 v[96:111], v[120:123], v[132:135], v[96:111]
    ds_read_b128 v[116:119], v4 offset:49152
    buffer_load_dwordx4 v[12:15], v0, s[8:11], s64 offen offset:2048 sc1
    s_waitcnt vmcnt(7)
    v_mfma_f32_32x32x16_bf16 v[96:111], v[124:127], v[136:139], v[96:111]
    ds_read_b128 v[120:123], v4 offset:50176
    buffer_load_dwordx4 v[132:135], v0, s[8:11], s64 offen offset:3072 sc1
    s_waitcnt vmcnt(7) lgkmcnt(2)
    v_mfma_f32_32x32x16_bf16 v[96:111], v[128:131], v[140:143], v[96:111]
    ds_read_b128 v[124:127], v4 offset:51200
    s_add_u32 s62, s28, 7
    v_cmp_gt_u32 vcc, s62, v6
    s_cbranch_vccnz ob282
or283:
    s_add_u32 s64, s22, 65536
    buffer_load_dwordx4 v[136:139], v0, s[8:11], s64 offen offset:0 sc1
    s_waitcnt vmcnt(7)
    v_mfma_f32_32x32x16_bf16 v[96:111], v[112:115], v[144:147], v[96:111]
    ds_read_b128 v[128:131], v4 offset:52224
    buffer_load_dwordx4 v[140:143], v0, s[8:11], s64 offen offset:1024 sc1
    s_waitcnt vmcnt(7) lgkmcnt(2)
    v_mfma_f32_32x32x16_bf16 v[96:111], v[116:119], v[148:151], v[96:111]
    ds_read_b128 v[112:115], v4 offset:53248
    buffer_load_dwordx4 v[144:147], v0, s[8:11], s64 offen offset:2048 sc1
    s_waitcnt vmcnt(7)
    v_mfma_f32_32x32x16_bf16 v[96:111], v[120:123], v[152:155], v[96:111]
    ds_read_b128 v[116:119], v4 offset:54272
    buffer_load_dwordx4 v[148:151], v0, s[8:11], s64 offen offset:3072 sc1
    s_waitcnt vmcnt(7) lgkmcnt(2)
    v_mfma_f32_32x32x16_bf16 v[96:111], v[124:127], v[44:47], v[96:111]
    ds_read_b128 v[120:123], v4 offset:55296
    s_add_u32 s64, s22, 69632
    buffer_load_dwordx4 v[152:155], v0, s[8:11], s64 offen offset:0 sc1
    v_mul_f32 v28, v80, v80
    v_mul_f32 v31, v81, v81
    v_mul_f32 v34, v82, v82
    v_mul_f32 v37, v83, v83
    v_mul_f32 v29, v80, v88
    v_mul_f32 v32, v81, v89
    v_mul_f32 v35, v82, v90
    v_mul_f32 v38, v83, v91
    v_fma_f32 v28, v28, v26, v25
    v_fma_f32 v31, v31, v26, v25
    v_fma_f32 v34, v34, v26, v25
    v_fma_f32 v37, v37, v26, v25
    v_mul_f32 v28, v28, v80
    v_mul_f32 v31, v31, v81
    v_mul_f32 v34, v34, v82
    v_mul_f32 v37, v37, v83
    v_exp_f32 v28, v28
    v_exp_f32 v31, v31
    v_exp_f32 v34, v34
    v_exp_f32 v37, v37
    v_fma_f32 v28, v28, v27, v27
    v_fma_f32 v31, v31, v27, v27
    v_fma_f32 v34, v34, v27, v27
    v_fma_f32 v37, v37, v27, v27
    v_rcp_f32 v28, v28
    v_rcp_f32 v31, v31
    v_rcp_f32 v34, v34
    v_rcp_f32 v37, v37
    v_mul_f32 v80, v29, v28
    v_mul_f32 v81, v32, v31
    v_mul_f32 v82, v35, v34
    v_mul_f32 v83, v38, v37
    v_mul_f32 v28, v84, v84
    v_mul_f32 v31, v85, v85
    v_mul_f32 v34, v86, v86
    v_mul_f32 v37, v87, v87
    v_mul_f32 v29, v84, v92
    v_mul_f32 v32, v85, v93
    v_mul_f32 v35, v86, v94
    v_mul_f32 v38, v87, v95
    v_fma_f32 v28, v28, v26, v25
    v_fma_f32 v31, v31, v26, v25
    v_fma_f32 v34, v34, v26, v25
    v_fma_f32 v37, v37, v26, v25
    v_mul_f32 v28, v28, v84
    v_mul_f32 v31, v31, v85
    v_mul_f32 v34, v34, v86
    v_mul_f32 v37, v37, v87
    v_exp_f32 v28, v28
    v_exp_f32 v31, v31
    v_exp_f32 v34, v34
    v_exp_f32 v37, v37
    v_fma_f32 v28, v28, v27, v27
    v_fma_f32 v31, v31, v27, v27
    v_fma_f32 v34, v34, v27, v27
    v_fma_f32 v37, v37, v27, v27
    v_rcp_f32 v28, v28
    v_rcp_f32 v31, v31
    v_rcp_f32 v34, v34
    v_rcp_f32 v37, v37
    v_mul_f32 v84, v29, v28
    v_mul_f32 v85, v32, v31
    v_mul_f32 v86, v35, v34
    v_mul_f32 v87, v38, v37
    v_cvt_pk_bf16_f32 v40, v80, v81
    v_cvt_pk_bf16_f32 v41, v82, v83
    v_cvt_pk_bf16_f32 v42, v84, v85
    v_cvt_pk_bf16_f32 v43, v86, v87
    s_add_u32 s45, s46, 81920
    buffer_store_dwordx4 v[40:43], v0, s[8:11], s45 offen sc1
    s_add_u32 s58, s28, 8
    v_mov_b32 v7, s58
    s_waitcnt vmcnt(0)
    buffer_store_dword v7, off, s[8:11], s25 sc1
    buffer_load_dword v6, v2, s[8:11], s24 offen sc1
    v_mfma_f32_32x32x16_bf16 v[96:111], v[128:131], v[8:11], v[96:111]
    ds_read_b128 v[124:127], v4 offset:56320
    buffer_load_dwordx4 v[44:47], v0, s[8:11], s64 offen offset:1024 sc1
    s_waitcnt lgkmcnt(2)
    v_mfma_f32_32x32x16_bf16 v[96:111], v[112:115], v[12:15], v[96:111]
    ds_read_b128 v[128:131], v4 offset:57344
    buffer_load_dwordx4 v[8:11], v0, s[8:11], s64 offen offset:2048 sc1
    ds_write_b128 v5, v[248:251] offset:12288
    v_mfma_f32_32x32x16_bf16 v[96:111], v[116:119], v[132:135], v[96:111]
    ds_read_b128 v[112:115], v4 offset:58368
    buffer_load_dwordx4 v[12:15], v0, s[8:11], s64 offen offset:3072 sc1
    s_waitcnt lgkmcnt(3)
    v_mfma_f32_32x32x16_bf16 v[96:111], v[120:123], v[136:139], v[96:111]
    ds_read_b128 v[116:119], v4 offset:59392
    s_add_u32 s64, s22, 73728
    buffer_load_dwordx4 v[132:135], v0, s[8:11], s64 offen offset:0 sc1
    v_mfma_f32_32x32x16_bf16 v[96:111], v[124:127], v[140:143], v[96:111]
    ds_read_b128 v[120:123], v4 offset:60416
    buffer_load_dwordx4 v[136:139], v0, s[8:11], s64 offen offset:1024 sc1
    s_waitcnt lgkmcnt(2)
    v_mfma_f32_32x32x16_bf16 v[96:111], v[128:131], v[144:147], v[96:111]
    ds_read_b128 v[124:127], v4 offset:0
    buffer_load_dwordx4 v[140:143], v0, s[8:11], s64 offen offset:2048 sc1
    v_mfma_f32_32x32x16_bf16 v[96:111], v[112:115], v[148:151], v[96:111]
    ds_read_b128 v[128:131], v4 offset:1024
    buffer_load_dwordx4 v[144:147], v0, s[8:11], s64 offen offset:3072 sc1
    s_waitcnt lgkmcnt(2)
    v_mfma_f32_32x32x16_bf16 v[96:111], v[116:119], v[152:155], v[96:111]
    ds_read_b128 v[112:115], v4 offset:2048
    s_add_u32 s64, s22, 77824
    buffer_load_dwordx4 v[148:151], v0, s[8:11], s64 offen offset:0 sc1
    s_waitcnt vmcnt(7)
    v_mfma_f32_32x32x16_bf16 v[96:111], v[120:123], v[44:47], v[96:111]
    ds_read_b128 v[116:119], v4 offset:3072
    buffer_load_dwordx4 v[152:155], v0, s[8:11], s64 offen offset:1024 sc1
    s_waitcnt vmcnt(7) lgkmcnt(2)
    v_mfma_f32_32x32x16_bf16 v[96:111], v[124:127], v[8:11], v[96:111]
    ds_read_b128 v[120:123], v4 offset:4096
    buffer_load_dwordx4 v[44:47], v0, s[8:11], s64 offen offset:2048 sc1
    s_waitcnt vmcnt(7)
    v_mfma_f32_32x32x16_bf16 v[96:111], v[128:131], v[12:15], v[96:111]
    ds_read_b128 v[124:127], v4 offset:5120
    buffer_load_dwordx4 v[8:11], v0, s[8:11], s64 offen offset:3072 sc1
    s_waitcnt vmcnt(7) lgkmcnt(2)
    v_mfma_f32_32x32x16_bf16 v[96:111], v[112:115], v[132:135], v[96:111]
    ds_read_b128 v[128:131], v4 offset:6144
    s_add_u32 s62, s28, 8
    v_cmp_gt_u32 vcc, s62, v6
    s_cbranch_vccnz ob284
or285:
    s_add_u32 s64, s22, 81920
    buffer_load_dwordx4 v[12:15], v0, s[8:11], s64 offen offset:0 sc1
    s_lshl_b32 s47, s17, 11
    s_add_u32 s47, s47, s20
    buffer_load_dwordx4 v[48:51], v0, s[8:11], s47 offen sc1
    buffer_load_dwordx4 v[52:55], v0, s[8:11], s47 offen offset:1024 sc1
    s_waitcnt vmcnt(9)
    v_mfma_f32_32x32x16_bf16 v[96:111], v[116:119], v[136:139], v[96:111]
    ds_read_b128 v[112:115], v4 offset:7168
    buffer_load_dwordx4 v[132:135], v0, s[8:11], s64 offen offset:1024 sc1
    s_waitcnt vmcnt(9) lgkmcnt(2)
    v_mfma_f32_32x32x16_bf16 v[96:111], v[120:123], v[140:143], v[96:111]
    ds_read_b128 v[116:119], v4 offset:8192
    buffer_load_dwordx4 v[136:139], v0, s[8:11], s64 offen offset:2048 sc1
    s_waitcnt vmcnt(9)
    v_mfma_f32_32x32x16_bf16 v[96:111], v[124:127], v[144:147], v[96:111]
    ds_read_b128 v[120:123], v4 offset:9216
    buffer_load_dwordx4 v[140:143], v0, s[8:11], s64 offen offset:3072 sc1
    s_waitcnt vmcnt(9) lgkmcnt(2)
    v_mfma_f32_32x32x16_bf16 v[96:111], v[128:131], v[148:151], v[96:111]
    ds_read_b128 v[124:127], v4 offset:10240
    s_add_u32 s64, s22, 86016
    buffer_load_dwordx4 v[144:147], v0, s[8:11], s64 offen offset:0 sc1
    s_waitcnt vmcnt(9)
    v_mfma_f32_32x32x16_bf16 v[96:111], v[112:115], v[152:155], v[96:111]
    ds_read_b128 v[128:131], v4 offset:11264
    buffer_load_dwordx4 v[148:151], v0, s[8:11], s64 offen offset:1024 sc1
    s_barrier
    s_waitcnt vmcnt(9) lgkmcnt(2)
    v_mfma_f32_32x32x16_bf16 v[96:111], v[116:119], v[44:47], v[96:111]
    ds_read_b128 v[112:115], v4 offset:12288
    s_waitcnt vmcnt(8)
    v_mfma_f32_32x32x16_bf16 v[96:111], v[120:123], v[8:11], v[96:111]
    ds_read_b128 v[116:119], v4 offset:13312
    s_waitcnt vmcnt(7) lgkmcnt(2)
    v_mfma_f32_32x32x16_bf16 v[96:111], v[124:127], v[12:15], v[96:111]
    ds_read_b128 v[120:123], v4 offset:14336
    s_waitcnt vmcnt(4)
    v_mfma_f32_32x32x16_bf16 v[96:111], v[128:131], v[132:135], v[96:111]
    ds_read_b128 v[124:127], v4 offset:15360
    s_waitcnt vmcnt(3) lgkmcnt(2)
    v_mfma_f32_32x32x16_bf16 v[96:111], v[112:115], v[136:139], v[96:111]
    s_waitcnt vmcnt(2)
    v_mfma_f32_32x32x16_bf16 v[96:111], v[116:119], v[140:143], v[96:111]
    s_waitcnt vmcnt(1) lgkmcnt(0)
    v_mfma_f32_32x32x16_bf16 v[96:111], v[120:123], v[144:147], v[96:111]
    s_waitcnt vmcnt(0)
    v_mfma_f32_32x32x16_bf16 v[96:111], v[124:127], v[148:151], v[96:111]
    s_barrier
    v_lshlrev_b32 v64, 16, v48
    v_and_b32 v65, 0xffff0000, v48
    v_lshlrev_b32 v66, 16, v49
    v_and_b32 v67, 0xffff0000, v49
    v_lshlrev_b32 v68, 16, v50
    v_and_b32 v69, 0xffff0000, v50
    v_lshlrev_b32 v70, 16, v51
    v_and_b32 v71, 0xffff0000, v51
    v_lshlrev_b32 v72, 16, v52
    v_and_b32 v73, 0xffff0000, v52
    v_lshlrev_b32 v74, 16, v53
    v_and_b32 v75, 0xffff0000, v53
    v_lshlrev_b32 v76, 16, v54
    v_and_b32 v77, 0xffff0000, v54
    v_lshlrev_b32 v78, 16, v55
    v_and_b32 v79, 0xffff0000, v55
    v_add_f32 v96, v96, v64
    v_add_f32 v97, v97, v65
    v_add_f32 v98, v98, v66
    v_add_f32 v99, v99, v67
    v_add_f32 v100, v100, v68
    v_add_f32 v101, v101, v69
    v_add_f32 v102, v102, v70
    v_add_f32 v103, v103, v71
    v_add_f32 v104, v104, v72
    v_add_f32 v105, v105, v73
    v_add_f32 v106, v106, v74
    v_add_f32 v107, v107, v75
    v_add_f32 v108, v108, v76
    v_add_f32 v109, v109, v77
    v_add_f32 v110, v110, v78
    v_add_f32 v111, v111, v79
    v_cvt_pk_bf16_f32 v8, v96, v97
    v_cvt_pk_bf16_f32 v9, v98, v99
    v_cvt_pk_bf16_f32 v10, v100, v101
    v_cvt_pk_bf16_f32 v11, v102, v103
    v_cvt_pk_bf16_f32 v12, v104, v105
    v_cvt_pk_bf16_f32 v13, v106, v107
    v_cvt_pk_bf16_f32 v14, v108, v109
    v_cvt_pk_bf16_f32 v15, v110, v111
    s_cmp_eq_u32 s27, 1
    s_cbranch_scc1 main_fin_slow
    s_lshl_b32 s40, s17, 11
    s_add_u32 s40, s40, s20
    buffer_store_dwordx4 v[8:11], v0, s[8:11], s40 offen sc1
    buffer_store_dwordx4 v[12:15], v0, s[8:11], s40 offen offset:1024 sc1
    v_mov_b32 v30, 0
    v_mov_b32 v31, 0
    v_mov_b32 v34, 0x3f803f80
    v_dot2_f32_bf16 v30, v8, v34, v30
    v_dot2_f32_bf16 v31, v8, v8, v31
    v_dot2_f32_bf16 v30, v9, v34, v30
    v_dot2_f32_bf16 v31, v9, v9, v31
    v_dot2_f32_bf16 v30, v10, v34, v30
    v_dot2_f32_bf16 v31, v10, v10, v31
    v_dot2_f32_bf16 v30, v11, v34, v30
    v_dot2_f32_bf16 v31, v11, v11, v31
    v_dot2_f32_bf16 v30, v12, v34, v30
    v_dot2_f32_bf16 v31, v12, v12, v31
    v_dot2_f32_bf16 v30, v13, v34, v30
    v_dot2_f32_bf16 v31, v13, v13, v31
    v_dot2_f32_bf16 v30, v14, v34, v30
    v_dot2_f32_bf16 v31, v14, v14, v31
    v_dot2_f32_bf16 v30, v15, v34, v30
    v_dot2_f32_bf16 v31, v15, v15, v31
    v_and_b32 v6, 0x1ff, v0
    s_nop 0
    v_mov_b32 v32, v30
    v_mov_b32 v33, v31
    s_nop 0
    v_permlane32_swap_b32 v30, v32
    v_permlane32_swap_b32 v31, v33
    s_nop 0
    v_add_f32 v30, v30, v32
    v_add_f32 v31, v31, v33
    buffer_store_dwordx2 v[30:31], v6, s[8:11], s73 offen sc1
    s_add_u32 s58, s28, 9
    v_mov_b32 v7, s58
    s_waitcnt vmcnt(0)
    buffer_store_dword v7, off, s[8:11], s25 sc1
    buffer_load_dword v6, v2, s[8:11], s24 offen sc1
    s_add_u32 s62, s28, 9
    s_waitcnt vmcnt(0)
    v_cmp_gt_u32 vcc, s62, v6
    s_cbranch_vccnz ob286
or287:
    s_add_u32 s27, s27, 1
    s_add_u32 s28, s28, 9
    s_add_u32 s35, s35, 1048576
    s_add_u32 s36, s36, 1048576
    s_add_u32 s68, s20, s96
    buffer_load_dwordx4 a[0:3], v0, s[8:11], s68 offen offset:0 sc1
    buffer_load_dwordx4 a[4:7], v0, s[8:11], s68 offen offset:1024 sc1
    buffer_load_dwordx4 a[8:11], v0, s[8:11], s68 offen offset:2048 sc1
    buffer_load_dwordx4 a[12:15], v0, s[8:11], s68 offen offset:3072 sc1
    s_add_u32 s68, s20, s97
    buffer_load_dwordx4 a[16:19], v0, s[8:11], s68 offen offset:0 sc1
    s_branch main_loop_slow
main_fin_slow:
    v_permlane32_swap_b32 v8, v10
    v_permlane32_swap_b32 v9, v11
    v_permlane32_swap_b32 v12, v14
    v_permlane32_swap_b32 v13, v15
    s_nop 1
    buffer_store_dwordx4 v[8:11], v22, s[12:15], s70 offen offset:0
    buffer_store_dwordx4 v[12:15], v22, s[12:15], s70 offen offset:32
    s_waitcnt vmcnt(0)
    s_endpgm
ob265:
psp288:
    buffer_load_dword v6, v2, s[8:11], s24 offen sc1
    s_cmp_eq_u32 s34, 0
    s_cbranch_scc1 pex289
    s_sub_u32 s34, s34, 1
    s_waitcnt vmcnt(0)
    v_cmp_gt_u32 vcc, s62, v6
    s_cbranch_vccnz psp288
pex289:
    s_waitcnt vmcnt(0)
    s_branch or266
ob268:
psp290:
    buffer_load_dword v6, v2, s[8:11], s24 offen sc1
    s_cmp_eq_u32 s34, 0
    s_cbranch_scc1 pex291
    s_sub_u32 s34, s34, 1
    s_waitcnt vmcnt(0)
    v_cmp_gt_u32 vcc, s62, v6
    s_cbranch_vccnz psp290
pex291:
    s_waitcnt vmcnt(0)
    s_branch or269
ob270:
    s_bitcmp1_b32 s16, 0
    s_cbranch_scc1 po292
    s_add_u32 s49, s65, 167936
    buffer_load_dwordx4 v[192:195], v0, s[8:11], s49 offen
    s_add_u32 s49, s65, 172032
    buffer_load_dwordx4 v[196:199], v0, s[8:11], s49 offen
    s_add_u32 s49, s65, 176128
    buffer_load_dwordx4 v[200:203], v0, s[8:11], s49 offen
    s_cmp_eq_u32 s18, 1
    s_cbranch_scc1 bo294
    s_add_u32 s49, s65, 180224
    buffer_load_dwordx4 v[204:207], v0, s[8:11], s49 offen
bo294:
    s_add_u32 s49, s65, 184320
    buffer_load_dwordx4 v[208:211], v0, s[8:11], s49 offen
    s_add_u32 s49, s65, 188416
    buffer_load_dwordx4 v[212:215], v0, s[8:11], s49 offen
    s_add_u32 s49, s65, 192512
    buffer_load_dwordx4 v[216:219], v0, s[8:11], s49 offen
    v_lshrrev_b32 v244, 7, v0
    v_lshlrev_b32 v244, 14, v244
    v_and_b32 v245, 0x70, v0
    v_lshlrev_b32 v245, 3, v245
    v_add_u32 v244, v244, v245
    s_lshl_b32 s49, s17, 10
    s_add_u32 s49, s49, s22
    s_mov_b32 exec_hi, 0xffff
    buffer_load_dword v246, v244, s[8:11], s49 offen
    s_mov_b64 exec, -1
    s_branch pd293
po292:
    s_add_u32 s49, s65, 184320
    buffer_load_dwordx4 v[208:211], v0, s[8:11], s49 offen
    s_add_u32 s49, s65, 188416
    buffer_load_dwordx4 v[212:215], v0, s[8:11], s49 offen
    s_add_u32 s49, s65, 192512
    buffer_load_dwordx4 v[216:219], v0, s[8:11], s49 offen
    s_add_u32 s49, s65, 163840
    buffer_load_dwordx4 v[188:191], v0, s[8:11], s49 offen
    s_add_u32 s49, s65, 167936
    buffer_load_dwordx4 v[192:195], v0, s[8:11], s49 offen
    s_add_u32 s49, s65, 172032
    buffer_load_dwordx4 v[196:199], v0, s[8:11], s49 offen
    s_add_u32 s49, s65, 176128
    buffer_load_dwordx4 v[200:203], v0, s[8:11], s49 offen
    v_lshrrev_b32 v244, 7, v0
    v_lshlrev_b32 v244, 14, v244
    v_and_b32 v245, 0x70, v0
    v_lshlrev_b32 v245, 3, v245
    v_add_u32 v244, v244, v245
    s_lshl_b32 s49, s17, 10
    s_add_u32 s49, s49, s22
    s_mov_b32 exec_hi, 0xffff
    buffer_load_dword v246, v244, s[8:11], s49 offen
    s_mov_b64 exec, -1
pd293:
    s_branch or271
ob272:
    s_bitcmp1_b32 s16, 0
    s_cbranch_scc1 po295
    s_add_u32 s49, s65, 196608
    buffer_load_dwordx4 v[220:223], v0, s[8:11], s49 offen
    s_add_u32 s49, s65, 200704
    buffer_load_dwordx4 v[224:227], v0, s[8:11], s49 offen
    s_add_u32 s49, s65, 204800
    buffer_load_dwordx4 v[228:231], v0, s[8:11], s49 offen
    s_add_u32 s49, s65, 208896
    buffer_load_dwordx4 v[232:235], v0, s[8:11], s49 offen
    s_add_u32 s49, s65, 212992
    buffer_load_dwordx4 v[236:239], v0, s[8:11], s49 offen
    s_add_u32 s49, s65, 217088
    buffer_load_dwordx4 v[240:243], v0, s[8:11], s49 offen
    s_add_u32 s49, s65, 221184
    buffer_load_dwordx4 v[244:247], v0, s[8:11], s49 offen
    s_add_u32 s49, s65, 225280
    buffer_load_dwordx4 v[248:251], v0, s[8:11], s49 offen
    s_branch pd296
po295:
    s_add_u32 s49, s65, 212992
    buffer_load_dwordx4 v[236:239], v0, s[8:11], s49 offen
    s_add_u32 s49, s65, 217088
    buffer_load_dwordx4 v[240:243], v0, s[8:11], s49 offen
    s_add_u32 s49, s65, 221184
    buffer_load_dwordx4 v[244:247], v0, s[8:11], s49 offen
    s_add_u32 s49, s65, 225280
    buffer_load_dwordx4 v[248:251], v0, s[8:11], s49 offen
    s_add_u32 s49, s65, 196608
    buffer_load_dwordx4 v[220:223], v0, s[8:11], s49 offen
    s_add_u32 s49, s65, 200704
    buffer_load_dwordx4 v[224:227], v0, s[8:11], s49 offen
    s_add_u32 s49, s65, 204800
    buffer_load_dwordx4 v[228:231], v0, s[8:11], s49 offen
    s_add_u32 s49, s65, 208896
    buffer_load_dwordx4 v[232:235], v0, s[8:11], s49 offen
pd296:
    s_branch or273
ob274:
psp297:
    buffer_load_dword v6, v2, s[8:11], s24 offen sc1
    s_cmp_eq_u32 s34, 0
    s_cbranch_scc1 pex298
    s_sub_u32 s34, s34, 1
    s_waitcnt vmcnt(0)
    v_cmp_gt_u32 vcc, s62, v6
    s_cbranch_vccnz psp297
pex298:
    s_waitcnt vmcnt(0)
    s_branch or275
ob276:
psp299:
    buffer_load_dword v6, v2, s[8:11], s24 offen sc1
    s_cmp_eq_u32 s34, 0
    s_cbranch_scc1 pex300
    s_sub_u32 s34, s34, 1
    s_waitcnt vmcnt(0)
    v_cmp_gt_u32 vcc, s62, v6
    s_cbranch_vccnz psp299
pex300:
    s_waitcnt vmcnt(0)
    s_branch or277
ob278:
psp301:
    buffer_load_dword v6, v2, s[8:11], s24 offen sc1
    s_cmp_eq_u32 s34, 0
    s_cbranch_scc1 pex302
    s_sub_u32 s34, s34, 1
    s_waitcnt vmcnt(0)
    v_cmp_gt_u32 vcc, s62, v6
    s_cbranch_vccnz psp301
pex302:
    s_waitcnt vmcnt(0)
    s_branch or279
ob280:
psp303:
    buffer_load_dword v6, v2, s[8:11], s24 offen sc1
    s_cmp_eq_u32 s34, 0
    s_cbranch_scc1 pex304
    s_sub_u32 s34, s34, 1
    s_waitcnt vmcnt(0)
    v_cmp_gt_u32 vcc, s62, v6
    s_cbranch_vccnz psp303
pex304:
    s_waitcnt vmcnt(0)
    s_branch or281
ob282:
psp305:
    buffer_load_dword v6, v2, s[8:11], s24 offen sc1
    s_cmp_eq_u32 s34, 0
    s_cbranch_scc1 pex306
    s_sub_u32 s34, s34, 1
    s_waitcnt vmcnt(0)
    v_cmp_gt_u32 vcc, s62, v6
    s_cbranch_vccnz psp305
pex306:
    s_waitcnt vmcnt(0)
    s_branch or283
ob284:
psp307:
    buffer_load_dword v6, v2, s[8:11], s24 offen sc1
    s_cmp_eq_u32 s34, 0
    s_cbranch_scc1 pex308
    s_sub_u32 s34, s34, 1
    s_waitcnt vmcnt(0)
    v_cmp_gt_u32 vcc, s62, v6
    s_cbranch_vccnz psp307
pex308:
    s_waitcnt vmcnt(0)
    s_branch or285
ob286:
psp309:
    buffer_load_dword v6, v2, s[8:11], s24 offen sc1
    s_cmp_eq_u32 s34, 0
    s_cbranch_scc1 pex310
    s_sub_u32 s34, s34, 1
    s_waitcnt vmcnt(0)
    v_cmp_gt_u32 vcc, s62, v6
    s_cbranch_vccnz psp309
pex310:
    s_waitcnt vmcnt(0)
    s_branch or287
main_exit:
    s_endpgm
.p2align 2
main_tab:
.long 131, 133, 135, 137, 139, 141, 143, 145, 147, 149, 151, 153, 155, 157, 159, 161
.long 163, 165, 167, 169, 171, 173, 175, 177, 179, 181, 183, 185, 187, 189, 191, 193
.long 195, 132, 134, 136, 138, 140, 142, 144, 146, 148, 150, 152, 154, 156, 158, 160
.long 162, 164, 166, 168, 170, 172, 174, 176, 178, 180, 182, 184, 186, 188, 190, 192
.long 194, 196, 197, 198, 199, 200, 201, 202, 203, 204, 205, 206, 207, 208, 209, 210
.long 211, 212, 213, 214, 215, 216, 217, 218, 219, 220, 221, 222, 223, 224, 225, 226
.long 227, 228, 229, 230, 231, 232, 233, 234, 235, 236, 237, 238, 239, 240, 241, 242
.long 243, 244, 245, 246, 247, 248, 249, 250, 251, 252, 253, 254, 255, 256, 257, 258
.long 259, 260, 261, 262, 263, 264, 265, 266, 267, 268, 269, 270, 271, 272, 273, 274
.long 275, 276, 278, 280, 282, 284, 285, 287, 289, 291, 292, 294, 296, 298, 299, 301
.long 303, 305, 307, 308, 310, 312, 314, 315, 317, 319, 321, 322, 324, 326, 328, 330
.long 331, 333, 335, 337, 338, 340, 342, 344, 345, 347, 349, 351, 353, 354, 356, 358
.long 360, 361, 363, 365, 367, 368, 277, 279, 281, 283, 286, 288, 290, 293, 295, 297
.long 300, 302, 304, 306, 309, 311, 313, 316, 318, 320, 323, 325, 327, 329, 332, 334
.long 336, 339, 341, 343, 346, 348, 350, 352, 355, 357, 359, 362, 364, 366, 369, 370
.long 371, 372, 373, 374, 375, 376, 377, 378, 379, 380, 381, 382, 383, 384, 385, 386
.long 387, 388, 389, 390, 391, 392, 393, 394, 395, 396, 397, 398, 399, 400, 401, 402
.long 403, 404, 405, 406, 407, 408, 409, 410, 411, 412, 413, 414
main_end:

.section .rodata,"a"
.p2align 6
.amdhsa_kernel interleave_layers__linear_attn_block__glu_gated_geglu__prompt_kernel
  .amdhsa_next_free_vgpr 512
  .amdhsa_next_free_sgpr 102
  .amdhsa_accum_offset 256
  .amdhsa_group_segment_fixed_size 0
  .amdhsa_kernarg_size 80
  .amdhsa_user_sgpr_count 2
  .amdhsa_user_sgpr_kernarg_segment_ptr 1
  .amdhsa_system_sgpr_workgroup_id_x 1
  .amdhsa_float_denorm_mode_32 3
.end_amdhsa_kernel
```
